```python
import torch

def _softmax(x, axis=-1):
    return torch.softmax(x, dim=axis)
def _gelu(x):
    return torch.nn.functional.gelu(x, approximate="tanh")
def _silu(x):
    return torch.nn.functional.silu(x)
def _sigmoid(x):
    return torch.sigmoid(x)
def _layernorm(x, axis=-1, eps=1e-5):
    m = x.mean(dim=axis, keepdim=True)
    v = x.var(dim=axis, keepdim=True, unbiased=False)
    return (x - m) / torch.sqrt(v + eps)
def _scatter_add(tgt, idx, src, axis=0):
    return tgt.clone().index_add_(axis, idx, src)
def _segment_sum(src, seg, n):
    out = torch.zeros((n,) + src.shape[1:], dtype=src.dtype)
    return out.index_add_(0, seg, src)
def _pad(x, pw):
    flat = tuple(v for pair in reversed(pw) for v in pair)
    return torch.nn.functional.pad(x, flat)

kernel_name = 'standalone__convnext_block__vision'

def setup_inputs():

    _w = (lambda a: (lambda t: t.to(torch.bfloat16) if t.is_floating_point() else t)(torch.as_tensor(a)))
    H = W = 512
    C = 192
    return {
        "x": _w((lambda *s: torch.randn(*s, dtype=torch.bfloat16) * 0.05)(1, H, W, C)),
        "dw": _w((lambda *s: torch.randn(*s, dtype=torch.bfloat16) * 0.05)(7, 7, C)),
        "w1": _w((lambda *s: torch.randn(*s, dtype=torch.bfloat16) * 0.05)(C, 4 * C)),
        "w2": _w((lambda *s: torch.randn(*s, dtype=torch.bfloat16) * 0.05)(4 * C, C)),
    }

def reference(x, dw, w1, w2):
    B, H, W, C = x.shape
    pad = 3
    xp = _pad(x, ((0,0),(pad,pad),(pad,pad),(0,0)))
    out = torch.zeros_like(x)
    for i in range(7):
        for j in range(7):
            out = out + xp[:, i:i+H, j:j+W, :] * dw[i, j][None, None, None, :]
    h = _layernorm(out, axis=-1)
    return x + _gelu(h @ w1) @ w2
```

```asm
; @launch kernel=prep_kernel grid=(156,1,1) block=(256,1,1) lds=0
; @launch kernel=standalone__convnext_block__vision_kernel grid=(256,1,1) block=(256,1,1) lds=163840
.amdgcn_target "amdgcn-amd-amdhsa--gfx950"
.text
.globl prep_kernel
.p2align 8
.type prep_kernel,@function
prep_kernel:
  s_cmp_ge_u32 s2, 156
  s_cbranch_scc1 prep_end
  s_load_dwordx2 s[4:5], s[0:1], 8
  s_load_dwordx4 s[8:11], s[0:1], 16
  s_load_dwordx2 s[6:7], s[0:1], 48
  v_lshrrev_b32 v1, 6, v0
  v_and_b32 v2, 63, v0
  s_nop 0
  v_readfirstlane_b32 s3, v1
  v_and_b32 v3, 15, v2
  v_lshrrev_b32 v4, 4, v2
  s_waitcnt lgkmcnt(0)
  s_mov_b32 s20, s4
  s_and_b32 s21, s5, 0xffff
  s_mov_b32 s22, 18816
  s_mov_b32 s23, 0x00020000
  s_mov_b32 s24, s8
  s_and_b32 s25, s9, 0xffff
  s_mov_b32 s26, 294912
  s_mov_b32 s27, 0x00020000
  s_mov_b32 s28, s10
  s_and_b32 s29, s11, 0xffff
  s_mov_b32 s30, 294912
  s_mov_b32 s31, 0x00020000
  s_mov_b32 s32, s6
  s_and_b32 s33, s7, 0xffff
  s_mov_b32 s34, 688128
  s_mov_b32 s35, 0x00020000
  s_cmp_ge_u32 s2, 144
  s_cbranch_scc1 prep_atab
  s_cmp_ge_u32 s2, 72
  s_cbranch_scc1 prep_w2
  s_lshl_b32 s12, s2, 2
  s_add_u32 s12, s12, s3
  s_mul_hi_u32 s13, s12, 0x15555556
  s_mul_i32 s14, s13, 12
  s_sub_u32 s14, s12, s14
  s_cmp_ge_u32 s14, 6
  s_cselect_b32 s15, 1, 0
  s_mul_i32 s16, s15, 6
  s_sub_u32 s16, s14, s16
  s_mul_i32 s17, s16, 49152
  s_lshl_b32 s18, s13, 6
  s_add_u32 s17, s17, s18
  s_lshl_b32 s18, s15, 5
  s_add_u32 s17, s17, s18
  v_mul_u32_u24 v5, 12288, v4
  v_lshl_add_u32 v5, v3, 1, v5
  buffer_load_ushort v8, v5, s[24:27], s17 offen
  s_add_u32 s17, s17, 1536
  buffer_load_ushort v9, v5, s[24:27], s17 offen
  s_add_u32 s17, s17, 1536
  buffer_load_ushort v10, v5, s[24:27], s17 offen
  s_add_u32 s17, s17, 1536
  buffer_load_ushort v11, v5, s[24:27], s17 offen
  s_add_u32 s17, s17, 1536
  buffer_load_ushort v12, v5, s[24:27], s17 offen
  s_add_u32 s17, s17, 1536
  buffer_load_ushort v13, v5, s[24:27], s17 offen
  s_add_u32 s17, s17, 1536
  buffer_load_ushort v14, v5, s[24:27], s17 offen
  s_add_u32 s17, s17, 1536
  buffer_load_ushort v15, v5, s[24:27], s17 offen
  s_mul_i32 s18, s13, 24576
  s_lshl_b32 s19, s14, 10
  s_add_u32 s18, s18, s19
  v_lshlrev_b32 v6, 4, v2
  s_waitcnt vmcnt(0)
  v_lshl_or_b32 v16, v9, 16, v8
  v_lshl_or_b32 v17, v11, 16, v10
  v_lshl_or_b32 v18, v13, 16, v12
  v_lshl_or_b32 v19, v15, 16, v14
  buffer_store_dwordx4 v[16:19], v6, s[32:35], s18 offen
  s_endpgm
prep_w2:
  s_sub_u32 s12, s2, 72
  s_lshl_b32 s12, s12, 2
  s_add_u32 s12, s12, s3
  s_mul_hi_u32 s13, s12, 0x15555556
  s_mul_i32 s14, s13, 12
  s_sub_u32 s14, s12, s14
  s_cmp_lt_u32 s14, 8
  s_cselect_b32 s15, 0, 120
  s_cselect_b32 s16, 4, 3
  s_add_u32 s15, s15, s14
  s_lshl_b32 s15, s15, 1
  s_mul_i32 s17, s13, 32*384
  s_add_u32 s17, s17, s15
  v_lshlrev_b32 v5, s16, v3
  v_mul_u32_u24 v7, 1536, v4
  v_add_u32 v5, v5, v7
  s_add_u32 s19, s17, 0
  buffer_load_ushort v8, v5, s[28:31], s19 offen
  s_add_u32 s19, s17, 384
  buffer_load_ushort v9, v5, s[28:31], s19 offen
  s_add_u32 s19, s17, 768
  buffer_load_ushort v10, v5, s[28:31], s19 offen
  s_add_u32 s19, s17, 1152
  buffer_load_ushort v11, v5, s[28:31], s19 offen
  s_add_u32 s19, s17, 6144
  buffer_load_ushort v12, v5, s[28:31], s19 offen
  s_add_u32 s19, s17, 6528
  buffer_load_ushort v13, v5, s[28:31], s19 offen
  s_add_u32 s19, s17, 6912
  buffer_load_ushort v14, v5, s[28:31], s19 offen
  s_add_u32 s19, s17, 7296
  buffer_load_ushort v15, v5, s[28:31], s19 offen
  s_add_u32 s18, s13, 2
  s_mul_i32 s18, s18, 24576
  s_lshl_b32 s19, s14, 10
  s_add_u32 s18, s18, s19
  s_add_u32 s18, s18, 12288
  v_lshlrev_b32 v6, 4, v2
  s_waitcnt vmcnt(0)
  v_lshlrev_b32 v8, 16, v8
  v_lshlrev_b32 v9, 16, v9
  v_lshlrev_b32 v10, 16, v10
  v_lshlrev_b32 v11, 16, v11
  v_lshlrev_b32 v12, 16, v12
  v_lshlrev_b32 v13, 16, v13
  v_lshlrev_b32 v14, 16, v14
  v_lshlrev_b32 v15, 16, v15
  v_cvt_pk_f16_f32 v16, v8, v9
  v_cvt_pk_f16_f32 v17, v10, v11
  v_cvt_pk_f16_f32 v18, v12, v13
  v_cvt_pk_f16_f32 v19, v14, v15
  buffer_store_dwordx4 v[16:19], v6, s[32:35], s18 offen
  s_endpgm
prep_atab:
  s_sub_u32 s12, s2, 144
  s_lshl_b32 s12, s12, 8
  v_add_u32 v5, s12, v0
  v_lshrrev_b32 v6, 5, v5
  v_bfe_u32 v7, v5, 4, 1
  v_bfe_u32 v20, v5, 1, 3
  v_and_b32 v21, 1, v5
  v_lshl_add_u32 v20, v7, 2, v20
  v_and_b32 v20, 7, v20
  v_lshl_add_u32 v22, v6, 1, v7
  v_mul_u32_u24 v23, 7*192, v20
  v_add_u32 v23, v23, v22
  v_lshlrev_b32 v23, 1, v23
  v_mov_b32 v25, 0x40000000
  v_cmp_eq_u32 vcc, 7, v20
  s_nop 1
  v_cndmask_b32 v23, v23, v25, vcc
  v_mul_u32_u24 v24, 384, v21
  v_sub_u32 v28, v23, v24
  v_add_u32 v28, 384, v28
  v_cmp_eq_u32 vcc, 1, v21
  s_nop 1
  v_cndmask_b32 v26, v23, v25, vcc
  v_cndmask_b32 v27, v25, v28, vcc
  buffer_load_ushort v8, v26, s[20:23], 0 offen
  buffer_load_ushort v9, v28, s[20:23], 0 offen offset:0
  buffer_load_ushort v10, v28, s[20:23], 0 offen offset:384
  buffer_load_ushort v11, v28, s[20:23], 0 offen offset:768
  buffer_load_ushort v12, v28, s[20:23], 0 offen offset:1152
  buffer_load_ushort v13, v28, s[20:23], 0 offen offset:1536
  buffer_load_ushort v14, v28, s[20:23], 0 offen offset:1920
  buffer_load_ushort v15, v27, s[20:23], 0 offen offset:2304
  v_lshlrev_b32 v6, 4, v5
  s_mov_b32 s18, 638976
  s_waitcnt vmcnt(0)
  v_lshl_or_b32 v16, v9, 16, v8
  v_lshl_or_b32 v17, v11, 16, v10
  v_lshl_or_b32 v18, v13, 16, v12
  v_lshl_or_b32 v19, v15, 16, v14
  buffer_store_dwordx4 v[16:19], v6, s[32:35], s18 offen
prep_end:
  s_endpgm
.section .rodata,"a"
.p2align 6
.amdhsa_kernel prep_kernel
  .amdhsa_next_free_vgpr 32
  .amdhsa_next_free_sgpr 48
  .amdhsa_accum_offset 32
  .amdhsa_group_segment_fixed_size 0
  .amdhsa_kernarg_size 56
  .amdhsa_user_sgpr_count 2
  .amdhsa_user_sgpr_kernarg_segment_ptr 1
  .amdhsa_system_sgpr_workgroup_id_x 1
  .amdhsa_float_denorm_mode_32 3
  .amdhsa_float_denorm_mode_16_64 3
.end_amdhsa_kernel
.text
.globl standalone__convnext_block__vision_kernel
.p2align 8
.type standalone__convnext_block__vision_kernel,@function
standalone__convnext_block__vision_kernel:
  s_cmp_ge_u32 s2, 256
  s_cbranch_scc1 main_end
  s_load_dwordx2 s[4:5], s[0:1], 0
  s_load_dwordx2 s[6:7], s[0:1], 32
  s_load_dwordx2 s[44:45], s[0:1], 48
  v_lshrrev_b32 v16, 6, v0
  v_and_b32 v17, 63, v0
  v_lshlrev_b32 v1, 4, v17
  v_readfirstlane_b32 s32, v16
  s_waitcnt lgkmcnt(0)
  s_mov_b32 s8, s4
  s_and_b32 s9, s5, 0xffff
  s_mov_b32 s10, 100663296
  s_mov_b32 s11, 0x00020000
  s_mov_b32 s12, s6
  s_and_b32 s13, s7, 0xffff
  s_mov_b32 s14, 100663296
  s_mov_b32 s15, 0x00020000
  s_mov_b32 s16, s44
  s_and_b32 s17, s45, 0xffff
  s_mov_b32 s18, 688128
  s_mov_b32 s19, 0x00020000
  s_mul_i32 s29, s32, 6144
  s_mov_b32 s24, 0
  s_mov_b32 s25, 196608
  s_mov_b32 s26, 393216
  s_mov_b32 s27, 589824
  s_mov_b32 s28, 0x44ea44ea
  s_mov_b32 s56, 0xb77fb77f
  s_mov_b32 s33, 0x00003f80
  s_mov_b32 s34, 0x3f800000
  s_mov_b32 s35, 0x3f803f80
  s_mov_b32 s50, 0xffff0000
  s_mov_b32 s51, 0x3baaaaab
  s_mov_b32 s52, 0x3727c5ac
  s_mov_b32 s53, 0xbeefe000
  s_and_b32 s36, s2, 7
  s_lshl_b32 s36, s36, 6
  s_lshr_b32 s40, s2, 6
  s_lshl_b32 s40, s40, 4
  s_add_u32 s36, s36, s40
  s_bfe_u32 s37, s2, 0x30003
  s_lshl_b32 s37, s37, 4
  s_mul_i32 s40, s32, 12288
  s_add_u32 s41, s40, 638976
  s_add_u32 s40, s40, 49152
  s_add_u32 m0, s40, 0
  s_add_u32 s42, s41, 0
  buffer_load_dwordx4 v1, s[16:19], s42 offen offset:0 lds
  buffer_load_dwordx4 v1, s[16:19], s42 offen offset:1024 lds
  buffer_load_dwordx4 v1, s[16:19], s42 offen offset:2048 lds
  buffer_load_dwordx4 v1, s[16:19], s42 offen offset:3072 lds
  s_add_u32 m0, s40, 4096
  s_add_u32 s42, s41, 4096
  buffer_load_dwordx4 v1, s[16:19], s42 offen offset:0 lds
  buffer_load_dwordx4 v1, s[16:19], s42 offen offset:1024 lds
  buffer_load_dwordx4 v1, s[16:19], s42 offen offset:2048 lds
  buffer_load_dwordx4 v1, s[16:19], s42 offen offset:3072 lds
  s_add_u32 m0, s40, 8192
  s_add_u32 s42, s41, 8192
  buffer_load_dwordx4 v1, s[16:19], s42 offen offset:0 lds
  buffer_load_dwordx4 v1, s[16:19], s42 offen offset:1024 lds
  buffer_load_dwordx4 v1, s[16:19], s42 offen offset:2048 lds
  buffer_load_dwordx4 v1, s[16:19], s42 offen offset:3072 lds
  v_lshrrev_b32 v16, 4, v1
  s_lshl_b32 s40, s32, 6
  v_add_u32 v16, s40, v16
  v_and_b32 v17, 3, v16
  v_lshrrev_b32 v18, 2, v16
  s_sub_u32 s40, s36, 3
  s_mul_i32 s40, s40, 196608
  s_sub_u32 s41, s37, 3
  s_mov_b32 s42, 745
  v_mov_b32 v27, 0x80000000
  v_add_u32 v19, 0, v18
  v_mul_lo_u32 v20, v19, s42
  v_lshrrev_b32 v20, 13, v20
  v_mul_u32_u24 v21, 11, v20
  v_sub_u32 v21, v19, v21
  v_mul_u32_u24 v22, 8096, v17
  v_mul_u32_u24 v23, 368, v20
  v_add_u32 v22, v22, v23
  v_lshl_add_u32 v10, v21, 2, v22
  v_add_u32 v24, s41, v21
  v_mov_b32 v25, 196608
  v_mul_lo_u32 v25, v20, v25
  v_lshl_add_u32 v25, v17, 4, v25
  v_add_u32 v25, s40, v25
  v_mul_u32_u24 v26, 384, v24
  v_add_u32 v26, v26, v25
  v_cmp_gt_u32 vcc, 512, v24
  s_nop 1
  v_cndmask_b32 v2, v27, v26, vcc
  v_add_u32 v24, 11, v24
  v_mul_u32_u24 v26, 384, v24
  v_add_u32 v26, v26, v25
  v_cmp_gt_u32 vcc, 512, v24
  s_nop 1
  v_cndmask_b32 v6, v27, v26, vcc
  v_add_u32 v19, 64, v18
  v_mul_lo_u32 v20, v19, s42
  v_lshrrev_b32 v20, 13, v20
  v_mul_u32_u24 v21, 11, v20
  v_sub_u32 v21, v19, v21
  v_mul_u32_u24 v22, 8096, v17
  v_mul_u32_u24 v23, 368, v20
  v_add_u32 v22, v22, v23
  v_lshl_add_u32 v11, v21, 2, v22
  v_add_u32 v24, s41, v21
  v_mov_b32 v25, 196608
  v_mul_lo_u32 v25, v20, v25
  v_lshl_add_u32 v25, v17, 4, v25
  v_add_u32 v25, s40, v25
  v_mul_u32_u24 v26, 384, v24
  v_add_u32 v26, v26, v25
  v_cmp_gt_u32 vcc, 512, v24
  s_nop 1
  v_cndmask_b32 v3, v27, v26, vcc
  v_add_u32 v24, 11, v24
  v_mul_u32_u24 v26, 384, v24
  v_add_u32 v26, v26, v25
  v_cmp_gt_u32 vcc, 512, v24
  s_nop 1
  v_cndmask_b32 v7, v27, v26, vcc
  v_add_u32 v19, 128, v18
  v_mul_lo_u32 v20, v19, s42
  v_lshrrev_b32 v20, 13, v20
  v_mul_u32_u24 v21, 11, v20
  v_sub_u32 v21, v19, v21
  v_mul_u32_u24 v22, 8096, v17
  v_mul_u32_u24 v23, 368, v20
  v_add_u32 v22, v22, v23
  v_lshl_add_u32 v12, v21, 2, v22
  v_add_u32 v24, s41, v21
  v_mov_b32 v25, 196608
  v_mul_lo_u32 v25, v20, v25
  v_lshl_add_u32 v25, v17, 4, v25
  v_add_u32 v25, s40, v25
  v_mul_u32_u24 v26, 384, v24
  v_add_u32 v26, v26, v25
  v_cmp_gt_u32 vcc, 512, v24
  s_nop 1
  v_cndmask_b32 v4, v27, v26, vcc
  v_add_u32 v24, 11, v24
  v_mul_u32_u24 v26, 384, v24
  v_add_u32 v26, v26, v25
  v_cmp_gt_u32 vcc, 512, v24
  s_nop 1
  v_cndmask_b32 v8, v27, v26, vcc
  v_add_u32 v19, 192, v18
  v_mul_lo_u32 v20, v19, s42
  v_lshrrev_b32 v20, 13, v20
  v_mul_u32_u24 v21, 11, v20
  v_sub_u32 v21, v19, v21
  v_mul_u32_u24 v22, 8096, v17
  v_mul_u32_u24 v23, 368, v20
  v_add_u32 v22, v22, v23
  v_lshl_add_u32 v13, v21, 2, v22
  v_add_u32 v24, s41, v21
  v_mov_b32 v25, 196608
  v_mul_lo_u32 v25, v20, v25
  v_lshl_add_u32 v25, v17, 4, v25
  v_add_u32 v25, s40, v25
  v_mul_u32_u24 v26, 384, v24
  v_add_u32 v26, v26, v25
  v_cmp_gt_u32 vcc, 512, v24
  s_nop 1
  v_cndmask_b32 v5, v27, v26, vcc
  v_add_u32 v24, 11, v24
  v_mul_u32_u24 v26, 384, v24
  v_add_u32 v26, v26, v25
  v_cmp_gt_u32 vcc, 512, v24
  s_nop 1
  v_cndmask_b32 v9, v27, v26, vcc
  v_cmp_gt_u32 vcc, 242, v19
  s_nop 1
  s_mov_b64 s[38:39], vcc
  v_cndmask_b32 v5, v27, v5, vcc
  v_cndmask_b32 v9, v27, v9, vcc
  s_mov_b32 s31, 0
  buffer_load_dwordx4 v[48:51], v2, s[8:11], 0 offen offset:0
  buffer_load_dwordx4 v[52:55], v6, s[8:11], 0 offen offset:0
  buffer_load_dwordx4 v[56:59], v3, s[8:11], 0 offen offset:0
  buffer_load_dwordx4 v[60:63], v7, s[8:11], 0 offen offset:0
  buffer_load_dwordx4 v[64:67], v4, s[8:11], 0 offen offset:0
  buffer_load_dwordx4 v[68:71], v8, s[8:11], 0 offen offset:0
  buffer_load_dwordx4 v[72:75], v5, s[8:11], 0 offen offset:0
  buffer_load_dwordx4 v[76:79], v9, s[8:11], 0 offen offset:0
  buffer_load_dwordx4 v[80:83], v2, s[8:11], 0 offen offset:64
  buffer_load_dwordx4 v[84:87], v6, s[8:11], 0 offen offset:64
  buffer_load_dwordx4 v[88:91], v3, s[8:11], 0 offen offset:64
  buffer_load_dwordx4 v[92:95], v7, s[8:11], 0 offen offset:64
  buffer_load_dwordx4 v[96:99], v4, s[8:11], 0 offen offset:64
  buffer_load_dwordx4 v[100:103], v8, s[8:11], 0 offen offset:64
  buffer_load_dwordx4 v[104:107], v5, s[8:11], 0 offen offset:64
  buffer_load_dwordx4 v[108:111], v9, s[8:11], 0 offen offset:64
  buffer_load_dwordx4 a[224:227], v2, s[8:11], 0 offen offset:128
  buffer_load_dwordx4 a[228:231], v6, s[8:11], 0 offen offset:128
  buffer_load_dwordx4 a[232:235], v3, s[8:11], 0 offen offset:128
  buffer_load_dwordx4 a[236:239], v7, s[8:11], 0 offen offset:128
  buffer_load_dwordx4 a[240:243], v4, s[8:11], 0 offen offset:128
  buffer_load_dwordx4 a[244:247], v8, s[8:11], 0 offen offset:128
  buffer_load_dwordx4 a[248:251], v5, s[8:11], 0 offen offset:128
  buffer_load_dwordx4 a[252:255], v9, s[8:11], 0 offen offset:128
  buffer_load_dwordx4 a[160:163], v2, s[8:11], 0 offen offset:192
  buffer_load_dwordx4 a[164:167], v6, s[8:11], 0 offen offset:192
  buffer_load_dwordx4 a[168:171], v3, s[8:11], 0 offen offset:192
  buffer_load_dwordx4 a[172:175], v7, s[8:11], 0 offen offset:192
  buffer_load_dwordx4 a[176:179], v4, s[8:11], 0 offen offset:192
  buffer_load_dwordx4 a[180:183], v8, s[8:11], 0 offen offset:192
  buffer_load_dwordx4 a[184:187], v5, s[8:11], 0 offen offset:192
  buffer_load_dwordx4 a[188:191], v9, s[8:11], 0 offen offset:192
  v_lshrrev_b32 v112, 4, v1
  v_and_b32 v113, 15, v112
  v_lshrrev_b32 v114, 4, v112
  v_lshrrev_b32 v115, 3, v113
  v_lshlrev_b32 v115, 3, v115
  v_lshrrev_b32 v116, 1, v114
  v_add_u32 v115, v115, v116
  v_mul_u32_u24 v115, 368, v115
  v_and_b32 v116, 7, v113
  v_lshlrev_b32 v116, 3, v116
  v_add_u32 v115, v115, v116
  v_and_b32 v116, 1, v114
  v_lshlrev_b32 v116, 4, v116
  v_add_u32 v115, v115, v116
  s_mul_i32 s40, s32, 8096
  s_add_u32 s41, s40, 98304
  v_add_u32 v160, s41, v115
  s_add_u32 s41, s40, 130688
  v_add_u32 v161, s41, v115
  s_add_u32 s41, s40, 0
  v_add_u32 v162, s41, v115
  v_lshrrev_b32 v115, 2, v113
  v_sub_u32 v115, v114, v115
  v_and_b32 v116, 1, v113
  s_lshl_b32 s40, s32, 11
  s_add_u32 s40, s40, 49152
  v_add_u32 v163, 0, v115
  v_min_u32 v163, 7, v163
  v_lshl_add_u32 v163, v116, 2, v163
  v_and_b32 v163, 7, v163
  v_lshlrev_b32 v163, 5, v163
  v_lshl_add_u32 v163, v116, 8, v163
  v_bfe_u32 v112, v113, 1, 1
  v_lshl_add_u32 v163, v112, 4, v163
  v_add_u32 v163, s40, v163
  v_add_u32 v164, 4, v115
  v_min_u32 v164, 7, v164
  v_lshl_add_u32 v164, v116, 2, v164
  v_and_b32 v164, 7, v164
  v_lshlrev_b32 v164, 5, v164
  v_lshl_add_u32 v164, v116, 8, v164
  v_bfe_u32 v112, v113, 1, 1
  v_lshl_add_u32 v164, v112, 4, v164
  v_add_u32 v164, s40, v164
  v_add_u32 v165, 8, v115
  v_min_u32 v165, 7, v165
  v_lshl_add_u32 v165, v116, 2, v165
  v_and_b32 v165, 7, v165
  v_lshlrev_b32 v165, 5, v165
  v_lshl_add_u32 v165, v116, 8, v165
  v_bfe_u32 v112, v113, 1, 1
  v_lshl_add_u32 v165, v112, 4, v165
  v_add_u32 v165, s40, v165
  v_mul_u32_u24 v166, 0x5555, v116
  v_add_u32 v166, 0x8888, v166
  s_lshl_b32 s40, s32, 12
  s_add_u32 s40, s40, 32768
  v_add_u32 v167, s40, v1
  s_lshl_b32 s40, s32, 10
  s_add_u32 s40, s40, 32768
  v_lshlrev_b32 v0, 12, v114
  v_lshl_add_u32 v0, v113, 4, v0
  v_add_u32 v0, s40, v0
  v_mov_b32 v140, 0
  v_mov_b32 v141, 0
  v_mov_b32 v142, 0
  v_mov_b32 v143, 0
  s_waitcnt vmcnt(30)
  v_add_u32 v228, 98304, v10
  ds_write2_b32 v228, v48, v52 offset0:0 offset1:11
  ds_write2_b32 v228, v49, v53 offset0:22 offset1:33
  ds_write2_b32 v228, v50, v54 offset0:44 offset1:55
  ds_write2_b32 v228, v51, v55 offset0:66 offset1:77
  s_waitcnt vmcnt(28)
  v_add_u32 v228, 98304, v11
  ds_write2_b32 v228, v56, v60 offset0:0 offset1:11
  ds_write2_b32 v228, v57, v61 offset0:22 offset1:33
  ds_write2_b32 v228, v58, v62 offset0:44 offset1:55
  ds_write2_b32 v228, v59, v63 offset0:66 offset1:77
  s_waitcnt vmcnt(26)
  v_add_u32 v228, 98304, v12
  ds_write2_b32 v228, v64, v68 offset0:0 offset1:11
  ds_write2_b32 v228, v65, v69 offset0:22 offset1:33
  ds_write2_b32 v228, v66, v70 offset0:44 offset1:55
  ds_write2_b32 v228, v67, v71 offset0:66 offset1:77
  s_waitcnt vmcnt(24)
  v_add_u32 v228, 98304, v13
  s_mov_b64 exec, s[38:39]
  ds_write2_b32 v228, v72, v76 offset0:0 offset1:11
  ds_write2_b32 v228, v73, v77 offset0:22 offset1:33
  ds_write2_b32 v228, v74, v78 offset0:44 offset1:55
  ds_write2_b32 v228, v75, v79 offset0:66 offset1:77
  s_mov_b64 exec, -1
  s_waitcnt lgkmcnt(0)
  s_barrier
  v_mov_b32 v224, 0
  v_mov_b32 v225, 0
  v_mov_b32 v226, 0
  v_mov_b32 v227, 0
  s_nop 1
  v_mfma_f32_16x16x32_bf16 v[192:195], v[224:227], v[224:227], 0
  s_nop 0
  v_mfma_f32_16x16x32_bf16 v[196:199], v[224:227], v[224:227], 0
  ds_read_b128 v[168:171], v163 offset:0
  ds_read_b64 v[112:113], v160 offset:0
  ds_read_b64 v[114:115], v160 offset:8
  ds_read_b64 v[116:117], v160 offset:736
  ds_read_b64 v[118:119], v160 offset:744
  ds_read_b128 v[172:175], v164 offset:0
  ds_read_b64 v[120:121], v160 offset:1472
  ds_read_b64 v[122:123], v160 offset:1480
  ds_read_b64 v[124:125], v160 offset:2208
  ds_read_b64 v[126:127], v160 offset:2216
  ds_read_b128 v[176:179], v165 offset:0
  ds_read_b64 v[128:129], v160 offset:2944
  ds_read_b64 v[130:131], v160 offset:2952
  ds_read_b64 v[132:133], v160 offset:3680
  ds_read_b64 v[134:135], v160 offset:3688
  s_waitcnt lgkmcnt(10)
  v_smfmac_f32_16x16x64_bf16 v[192:195], v[168:171], v[112:119], v166
  s_waitcnt lgkmcnt(5)
  ds_read_b64 v[136:137], v160 offset:4416
  ds_read_b64 v[138:139], v160 offset:4424
  ds_read_b128 v[180:183], v163 offset:512
  ds_read_b64 v[144:145], v160 offset:88
  s_waitcnt vmcnt(22)
  v_add_u32 v230, 130688, v10
  ds_write2_b32 v230, v80, v84 offset0:0 offset1:11
  buffer_load_dwordx4 a[192:195], v2, s[8:11], 0 offen offset:256
  v_smfmac_f32_16x16x64_bf16 v[192:195], v[172:175], v[120:127], v166
  ds_read_b64 v[146:147], v160 offset:96
  ds_read_b64 v[148:149], v160 offset:824
  ds_read_b64 v[150:151], v160 offset:832
  ds_read_b128 v[184:187], v164 offset:512
  ds_write2_b32 v230, v81, v85 offset0:22 offset1:33
  v_smfmac_f32_16x16x64_bf16 v[196:199], v[168:171], v[120:127], v166
  s_waitcnt lgkmcnt(10)
  ds_read_b64 v[152:153], v160 offset:1560
  ds_read_b64 v[154:155], v160 offset:1568
  ds_read_b64 v[156:157], v160 offset:2296
  ds_read_b64 v[158:159], v160 offset:2304
  ds_write2_b32 v230, v82, v86 offset0:44 offset1:55
  buffer_load_dwordx4 a[196:199], v6, s[8:11], 0 offen offset:256
  v_smfmac_f32_16x16x64_bf16 v[192:195], v[176:179], v[128:135], v166
  ds_write2_b32 v230, v83, v87 offset0:66 offset1:77
  v_mfma_f32_16x16x32_bf16 v[200:203], v[224:227], v[224:227], 0
  v_smfmac_f32_16x16x64_bf16 v[196:199], v[172:175], v[128:135], v166
  s_waitcnt lgkmcnt(14)
  ds_read_b128 v[188:191], v165 offset:512
  s_waitcnt vmcnt(22)
  v_add_u32 v230, 130688, v11
  ds_write2_b32 v230, v88, v92 offset0:0 offset1:11
  buffer_load_dwordx4 a[200:203], v3, s[8:11], 0 offen offset:256
  v_mfma_f32_16x16x32_bf16 v[204:207], v[224:227], v[224:227], 0
  v_smfmac_f32_16x16x64_bf16 v[196:199], v[176:179], v[136:143], v166
  s_waitcnt lgkmcnt(10)
  ds_read_b64 v[112:113], v160 offset:3032
  ds_read_b64 v[114:115], v160 offset:3040
  ds_read_b64 v[116:117], v160 offset:3768
  ds_read_b64 v[118:119], v160 offset:3776
  ds_write2_b32 v230, v89, v93 offset0:22 offset1:33
  v_smfmac_f32_16x16x64_bf16 v[200:203], v[180:183], v[144:151], v166
  s_waitcnt lgkmcnt(9)
  ds_read_b64 v[120:121], v160 offset:4504
  ds_read_b64 v[122:123], v160 offset:4512
  ds_read_b128 v[168:171], v163 offset:1024
  ds_read_b64 v[128:129], v160 offset:176
  ds_write2_b32 v230, v90, v94 offset0:44 offset1:55
  buffer_load_dwordx4 a[204:207], v7, s[8:11], 0 offen offset:256
  v_cvt_pk_bf16_f32 v208, v192, v193
  v_cvt_pk_bf16_f32 v212, v194, v195
  v_smfmac_f32_16x16x64_bf16 v[200:203], v[184:187], v[152:159], v166
  ds_read_b64 v[130:131], v160 offset:184
  ds_write2_b32 v230, v91, v95 offset0:66 offset1:77
  v_smfmac_f32_16x16x64_bf16 v[204:207], v[180:183], v[152:159], v166
  s_waitcnt lgkmcnt(8)
  ds_read_b64 v[132:133], v160 offset:912
  ds_read_b64 v[134:135], v160 offset:920
  ds_read_b128 v[172:175], v164 offset:1024
  ds_read_b64 v[136:137], v160 offset:1648
  s_waitcnt vmcnt(22)
  v_add_u32 v230, 130688, v12
  ds_write2_b32 v230, v96, v100 offset0:0 offset1:11
  v_add_u32 v228, 0, v10
  buffer_load_dwordx4 a[208:211], v4, s[8:11], 0 offen offset:256
  v_cvt_pk_bf16_f32 v216, v196, v197
  v_cvt_pk_bf16_f32 v220, v198, v199
  v_smfmac_f32_16x16x64_bf16 v[200:203], v[188:191], v[112:119], v166
  ds_read_b64 v[138:139], v160 offset:1656
  ds_read_b64 v[140:141], v160 offset:2384
  ds_write2_b32 v230, v97, v101 offset0:22 offset1:33
  s_waitcnt vmcnt(19)
  ds_write2_b32 v228, a224, a228 offset0:0 offset1:11
  v_mfma_f32_16x16x32_bf16 v[192:195], v[224:227], v[224:227], 0
  v_smfmac_f32_16x16x64_bf16 v[204:207], v[184:187], v[112:119], v166
  s_waitcnt lgkmcnt(14)
  ds_read_b64 v[142:143], v160 offset:2392
  ds_write2_b32 v230, v98, v102 offset0:44 offset1:55
  ds_write2_b32 v228, a225, a229 offset0:22 offset1:33
  buffer_load_dwordx4 a[212:215], v8, s[8:11], 0 offen offset:256
  v_mfma_f32_16x16x32_bf16 v[196:199], v[224:227], v[224:227], 0
  v_smfmac_f32_16x16x64_bf16 v[204:207], v[188:191], v[120:127], v166
  s_waitcnt lgkmcnt(10)
  ds_read_b128 v[176:179], v165 offset:1024
  ds_read_b64 v[144:145], v160 offset:3120
  ds_read_b64 v[146:147], v160 offset:3128
  ds_read_b64 v[148:149], v160 offset:3856
  ds_write2_b32 v230, v99, v103 offset0:66 offset1:77
  ds_write2_b32 v228, a226, a230 offset0:44 offset1:55
  v_smfmac_f32_16x16x64_bf16 v[192:195], v[168:171], v[128:135], v166
  s_waitcnt lgkmcnt(8)
  ds_read_b64 v[150:151], v160 offset:3864
  ds_read_b64 v[152:153], v160 offset:4592
  ds_read_b64 v[154:155], v160 offset:4600
  ds_read_b128 v[180:183], v163 offset:1536
  v_add_u32 v230, 130688, v13
  s_mov_b64 exec, s[38:39]
  ds_write2_b32 v230, v104, v108 offset0:0 offset1:11
  s_mov_b64 exec, -1
  ds_write2_b32 v228, a227, a231 offset0:66 offset1:77
  v_add_u32 v229, 0, v11
  buffer_load_dwordx4 a[216:219], v5, s[8:11], 0 offen offset:256
  v_cvt_pk_bf16_f32 v209, v200, v201
  v_cvt_pk_bf16_f32 v213, v202, v203
  v_smfmac_f32_16x16x64_bf16 v[192:195], v[172:175], v[136:143], v166
  ds_read_b64 v[112:113], v160 offset:264
  s_mov_b64 exec, s[38:39]
  ds_write2_b32 v230, v105, v109 offset0:22 offset1:33
  s_mov_b64 exec, -1
  s_waitcnt vmcnt(19)
  ds_write2_b32 v229, a232, a236 offset0:0 offset1:11
  v_smfmac_f32_16x16x64_bf16 v[196:199], v[168:171], v[136:143], v166
  s_waitcnt lgkmcnt(8)
  ds_read_b64 v[114:115], v160 offset:272
  ds_read_b64 v[116:117], v160 offset:1000
  ds_read_b64 v[118:119], v160 offset:1008
  ds_read_b128 v[184:187], v164 offset:1536
  s_mov_b64 exec, s[38:39]
  ds_write2_b32 v230, v106, v110 offset0:44 offset1:55
  s_mov_b64 exec, -1
  ds_write2_b32 v229, a233, a237 offset0:22 offset1:33
  buffer_load_dwordx4 a[220:223], v9, s[8:11], 0 offen offset:256
  v_cvt_pk_bf16_f32 v217, v204, v205
  v_cvt_pk_bf16_f32 v221, v206, v207
  v_smfmac_f32_16x16x64_bf16 v[192:195], v[176:179], v[144:151], v166
  ds_read_b64 v[120:121], v160 offset:1736
  s_mov_b64 exec, s[38:39]
  ds_write2_b32 v230, v107, v111 offset0:66 offset1:77
  s_mov_b64 exec, -1
  ds_write2_b32 v229, a234, a238 offset0:44 offset1:55
  v_mfma_f32_16x16x32_bf16 v[200:203], v[224:227], v[224:227], 0
  v_smfmac_f32_16x16x64_bf16 v[196:199], v[172:175], v[144:151], v166
  s_waitcnt lgkmcnt(15)
  ds_write2_b32 v229, a235, a239 offset0:66 offset1:77
  v_add_u32 v228, 0, v12
  v_mfma_f32_16x16x32_bf16 v[204:207], v[224:227], v[224:227], 0
  v_smfmac_f32_16x16x64_bf16 v[196:199], v[176:179], v[152:159], v166
  s_waitcnt lgkmcnt(7)
  ds_read_b64 v[122:123], v160 offset:1744
  ds_read_b64 v[124:125], v160 offset:2472
  ds_read_b64 v[126:127], v160 offset:2480
  ds_read_b128 v[188:191], v165 offset:1536
  s_waitcnt lgkmcnt(6)
  s_barrier
  s_waitcnt vmcnt(18)
  ds_write2_b32 v228, a240, a244 offset0:0 offset1:11
  v_smfmac_f32_16x16x64_bf16 v[200:203], v[180:183], v[112:119], v166
  s_waitcnt lgkmcnt(2)
  ds_read_b64 v[128:129], v160 offset:3208
  ds_read_b64 v[130:131], v160 offset:3216
  ds_read_b64 v[132:133], v160 offset:3944
  ds_read_b64 v[134:135], v160 offset:3952
  ds_write2_b32 v228, a241, a245 offset0:22 offset1:33
  v_cvt_pk_bf16_f32 v210, v192, v193
  v_cvt_pk_bf16_f32 v214, v194, v195
  v_smfmac_f32_16x16x64_bf16 v[200:203], v[184:187], v[120:127], v166
  ds_read_b64 v[136:137], v160 offset:4680
  ds_read_b64 v[138:139], v160 offset:4688
  ds_read_b128 v[168:171], v163 offset:8192
  ds_read_b64 v[144:145], v161 offset:0
  ds_write2_b32 v228, a242, a246 offset0:44 offset1:55
  v_smfmac_f32_16x16x64_bf16 v[204:207], v[180:183], v[120:127], v166
  s_waitcnt lgkmcnt(6)
  ds_read_b64 v[146:147], v161 offset:8
  ds_read_b64 v[148:149], v161 offset:736
  ds_read_b64 v[150:151], v161 offset:744
  ds_read_b128 v[172:175], v164 offset:8192
  ds_write2_b32 v228, a243, a247 offset0:66 offset1:77
  v_add_u32 v229, 0, v13
  v_cvt_pk_bf16_f32 v218, v196, v197
  v_cvt_pk_bf16_f32 v222, v198, v199
  v_smfmac_f32_16x16x64_bf16 v[200:203], v[188:191], v[128:135], v166
  ds_read_b64 v[152:153], v161 offset:1472
  ds_read_b64 v[154:155], v161 offset:1480
  ds_read_b64 v[156:157], v161 offset:2208
  ds_read_b64 v[158:159], v161 offset:2216
  s_waitcnt vmcnt(16)
  s_mov_b64 exec, s[38:39]
  ds_write2_b32 v229, a248, a252 offset0:0 offset1:11
  s_mov_b64 exec, -1
  v_mfma_f32_16x16x32_bf16 v[192:195], v[224:227], v[224:227], 0
  v_smfmac_f32_16x16x64_bf16 v[204:207], v[184:187], v[128:135], v166
  s_waitcnt lgkmcnt(13)
  ds_read_b128 v[176:179], v165 offset:8192
  ds_read_b64 v[112:113], v161 offset:2944
  s_mov_b64 exec, s[38:39]
  ds_write2_b32 v229, a249, a253 offset0:22 offset1:33
  s_mov_b64 exec, -1
  v_mfma_f32_16x16x32_bf16 v[196:199], v[224:227], v[224:227], 0
  v_smfmac_f32_16x16x64_bf16 v[204:207], v[188:191], v[136:143], v166
  s_waitcnt lgkmcnt(10)
  ds_read_b64 v[114:115], v161 offset:2952
  ds_read_b64 v[116:117], v161 offset:3680
  ds_read_b64 v[118:119], v161 offset:3688
  ds_read_b64 v[120:121], v161 offset:4416
  s_mov_b64 exec, s[38:39]
  ds_write2_b32 v229, a250, a254 offset0:44 offset1:55
  s_mov_b64 exec, -1
  v_smfmac_f32_16x16x64_bf16 v[192:195], v[168:171], v[144:151], v166
  s_waitcnt lgkmcnt(9)
  ds_read_b64 v[122:123], v161 offset:4424
  ds_read_b128 v[180:183], v163 offset:8704
  ds_read_b64 v[128:129], v161 offset:88
  ds_read_b64 v[130:131], v161 offset:96
  s_mov_b64 exec, s[38:39]
  ds_write2_b32 v229, a251, a255 offset0:66 offset1:77
  s_mov_b64 exec, -1
  buffer_load_dwordx4 a[0:3], v2, s[8:11], 0 offen offset:320
  v_cvt_pk_bf16_f32 v211, v200, v201
  v_cvt_pk_bf16_f32 v215, v202, v203
  v_smfmac_f32_16x16x64_bf16 v[192:195], v[172:175], v[152:159], v166
  ds_read_b64 v[132:133], v161 offset:824
  v_smfmac_f32_16x16x64_bf16 v[196:199], v[168:171], v[152:159], v166
  s_waitcnt lgkmcnt(8)
  ds_read_b64 v[134:135], v161 offset:832
  ds_read_b128 v[184:187], v164 offset:8704
  ds_read_b64 v[136:137], v161 offset:1560
  ds_read_b64 v[138:139], v161 offset:1568
  buffer_load_dwordx4 a[16:19], v6, s[8:11], 0 offen offset:320
  v_cvt_pk_bf16_f32 v219, v204, v205
  v_cvt_pk_bf16_f32 v223, v206, v207
  v_smfmac_f32_16x16x64_bf16 v[192:195], v[176:179], v[112:119], v166
  ds_read_b64 v[140:141], v161 offset:2296
  ds_read_b64 v[142:143], v161 offset:2304
  ds_read_b128 v[188:191], v165 offset:8704
  ds_write_b128 v167, v[208:211] offset:0
  v_mfma_f32_16x16x32_bf16 v[200:203], v[224:227], v[224:227], 0
  v_smfmac_f32_16x16x64_bf16 v[196:199], v[172:175], v[112:119], v166
  s_waitcnt lgkmcnt(13)
  ds_read_b64 v[144:145], v161 offset:3032
  ds_read_b64 v[146:147], v161 offset:3040
  ds_write_b128 v167, v[212:215] offset:1024
  buffer_load_dwordx4 a[32:35], v3, s[8:11], 0 offen offset:320
  v_mfma_f32_16x16x32_bf16 v[204:207], v[224:227], v[224:227], 0
  v_smfmac_f32_16x16x64_bf16 v[196:199], v[176:179], v[120:127], v166
  s_waitcnt lgkmcnt(10)
  ds_read_b64 v[148:149], v161 offset:3768
  ds_read_b64 v[150:151], v161 offset:3776
  ds_read_b64 v[152:153], v161 offset:4504
  ds_read_b64 v[154:155], v161 offset:4512
  ds_write_b128 v167, v[216:219] offset:2048
  v_smfmac_f32_16x16x64_bf16 v[200:203], v[180:183], v[128:135], v166
  s_waitcnt lgkmcnt(10)
  ds_read_b128 v[168:171], v163 offset:9216
  ds_read_b64 v[112:113], v161 offset:176
  ds_read_b64 v[114:115], v161 offset:184
  ds_read_b64 v[116:117], v161 offset:912
  ds_write_b128 v167, v[220:223] offset:3072
  buffer_load_dwordx4 a[48:51], v7, s[8:11], 0 offen offset:320
  v_cvt_pk_bf16_f32 v208, v192, v193
  v_cvt_pk_bf16_f32 v212, v194, v195
  v_smfmac_f32_16x16x64_bf16 v[200:203], v[184:187], v[136:143], v166
  v_smfmac_f32_16x16x64_bf16 v[204:207], v[180:183], v[136:143], v166
  s_waitcnt lgkmcnt(8)
  ds_read_b64 v[118:119], v161 offset:920
  ds_read_b128 v[172:175], v164 offset:9216
  ds_read_b64 v[120:121], v161 offset:1648
  ds_read_b64 v[122:123], v161 offset:1656
  s_waitcnt lgkmcnt(4)
  s_barrier
  ds_read_b128 v[16:19], v0 offset:0
  ds_read_b128 v[20:23], v0 offset:256
  ds_read_b128 v[24:27], v0 offset:512
  ds_read_b128 v[28:31], v0 offset:768
  v_add_u32 v228, 98304, v10
  buffer_load_dwordx4 a[64:67], v4, s[8:11], 0 offen offset:320
  v_cvt_pk_bf16_f32 v216, v196, v197
  v_cvt_pk_bf16_f32 v220, v198, v199
  v_smfmac_f32_16x16x64_bf16 v[200:203], v[188:191], v[144:151], v166
  ds_read_b64 v[124:125], v161 offset:2384
  ds_read_b64 v[126:127], v161 offset:2392
  ds_read_b128 v[176:179], v165 offset:9216
  ds_read_b64 v[128:129], v161 offset:3120
  s_waitcnt vmcnt(19)
  ds_write2_b32 v228, a160, a164 offset0:0 offset1:11
  v_mfma_f32_16x16x32_bf16 v[192:195], v[224:227], v[224:227], 0
  v_smfmac_f32_16x16x64_bf16 v[204:207], v[184:187], v[144:151], v166
  ds_read_b64 v[130:131], v161 offset:3128
  ds_read_b64 v[132:133], v161 offset:3856
  ds_write2_b32 v228, a161, a165 offset0:22 offset1:33
  buffer_load_dwordx4 a[80:83], v8, s[8:11], 0 offen offset:320
  v_mfma_f32_16x16x32_bf16 v[196:199], v[224:227], v[224:227], 0
  v_smfmac_f32_16x16x64_bf16 v[204:207], v[188:191], v[152:159], v166
  s_waitcnt lgkmcnt(15)
  ds_write2_b32 v228, a162, a166 offset0:44 offset1:55
  v_smfmac_f32_16x16x64_bf16 v[192:195], v[168:171], v[112:119], v166
  s_waitcnt lgkmcnt(7)
  ds_read_b64 v[134:135], v161 offset:3864
  ds_read_b64 v[136:137], v161 offset:4592
  ds_read_b64 v[138:139], v161 offset:4600
  ds_read_b128 v[180:183], v163 offset:9728
  ds_write2_b32 v228, a163, a167 offset0:66 offset1:77
  v_add_u32 v229, 98304, v11
  buffer_load_dwordx4 a[96:99], v5, s[8:11], 0 offen offset:320
  v_cvt_pk_bf16_f32 v209, v200, v201
  v_cvt_pk_bf16_f32 v213, v202, v203
  v_smfmac_f32_16x16x64_bf16 v[192:195], v[172:175], v[120:127], v166
  ds_read_b64 v[144:145], v161 offset:264
  ds_read_b64 v[146:147], v161 offset:272
  ds_read_b64 v[148:149], v161 offset:1000
  s_waitcnt vmcnt(19)
  ds_write2_b32 v229, a168, a172 offset0:0 offset1:11
  v_smfmac_f32_16x16x64_bf16 v[196:199], v[168:171], v[120:127], v166
  s_waitcnt lgkmcnt(8)
  ds_read_b64 v[150:151], v161 offset:1008
  ds_read_b128 v[184:187], v164 offset:9728
  ds_read_b64 v[152:153], v161 offset:1736
  ds_read_b64 v[154:155], v161 offset:1744
  ds_write2_b32 v229, a169, a173 offset0:22 offset1:33
  buffer_load_dwordx4 a[112:115], v9, s[8:11], 0 offen offset:320
  v_cvt_pk_bf16_f32 v217, v204, v205
  v_cvt_pk_bf16_f32 v221, v206, v207
  v_smfmac_f32_16x16x64_bf16 v[192:195], v[176:179], v[128:135], v166
  ds_read_b64 v[156:157], v161 offset:2472
  ds_read_b64 v[158:159], v161 offset:2480
  ds_write2_b32 v229, a170, a174 offset0:44 offset1:55
  v_mfma_f32_16x16x32_bf16 v[200:203], v[224:227], v[224:227], 0
  v_smfmac_f32_16x16x64_bf16 v[196:199], v[172:175], v[128:135], v166
  s_waitcnt lgkmcnt(14)
  ds_read_b128 v[188:191], v165 offset:9728
  ds_write2_b32 v229, a171, a175 offset0:66 offset1:77
  v_add_u32 v228, 98304, v12
  v_mfma_f32_16x16x32_bf16 v[204:207], v[224:227], v[224:227], 0
  v_smfmac_f32_16x16x64_bf16 v[196:199], v[176:179], v[136:143], v166
  s_waitcnt lgkmcnt(9)
  ds_read_b64 v[112:113], v161 offset:3208
  ds_read_b64 v[114:115], v161 offset:3216
  ds_read_b64 v[116:117], v161 offset:3944
  ds_read_b64 v[118:119], v161 offset:3952
  s_waitcnt vmcnt(18)
  ds_write2_b32 v228, a176, a180 offset0:0 offset1:11
  v_smfmac_f32_16x16x64_bf16 v[200:203], v[180:183], v[144:151], v166
  s_waitcnt lgkmcnt(8)
  ds_read_b64 v[120:121], v161 offset:4680
  ds_read_b64 v[122:123], v161 offset:4688
  ds_read_b128 v[168:171], v163 offset:16384
  ds_read_b64 v[128:129], v162 offset:0
  ds_write2_b32 v228, a177, a181 offset0:22 offset1:33
  s_barrier
  v_cvt_pk_bf16_f32 v210, v192, v193
  v_cvt_pk_bf16_f32 v214, v194, v195
  v_smfmac_f32_16x16x64_bf16 v[200:203], v[184:187], v[152:159], v166
  ds_read_b64 v[130:131], v162 offset:8
  ds_read_b64 v[132:133], v162 offset:736
  ds_write2_b32 v228, a178, a182 offset0:44 offset1:55
  v_smfmac_f32_16x16x64_bf16 v[204:207], v[180:183], v[152:159], v166
  s_waitcnt lgkmcnt(9)
  ds_read_b64 v[134:135], v162 offset:744
  ds_read_b128 v[172:175], v164 offset:16384
  ds_read_b64 v[136:137], v162 offset:1472
  ds_read_b64 v[138:139], v162 offset:1480
  ds_write2_b32 v228, a179, a183 offset0:66 offset1:77
  v_add_u32 v229, 98304, v13
  v_cvt_pk_bf16_f32 v218, v196, v197
  v_cvt_pk_bf16_f32 v222, v198, v199
  v_smfmac_f32_16x16x64_bf16 v[200:203], v[188:191], v[112:119], v166
  ds_read_b64 v[140:141], v162 offset:2208
  s_waitcnt vmcnt(16)
  s_mov_b64 exec, s[38:39]
  ds_write2_b32 v229, a184, a188 offset0:0 offset1:11
  s_mov_b64 exec, -1
  v_mfma_f32_16x16x32_bf16 v[192:195], v[224:227], v[224:227], 0
  v_smfmac_f32_16x16x64_bf16 v[204:207], v[184:187], v[112:119], v166
  s_waitcnt lgkmcnt(13)
  ds_read_b64 v[142:143], v162 offset:2216
  ds_read_b128 v[176:179], v165 offset:16384
  s_mov_b64 exec, s[38:39]
  ds_write2_b32 v229, a185, a189 offset0:22 offset1:33
  s_mov_b64 exec, -1
  v_mfma_f32_16x16x32_bf16 v[196:199], v[224:227], v[224:227], 0
  v_smfmac_f32_16x16x64_bf16 v[204:207], v[188:191], v[120:127], v166
  s_waitcnt lgkmcnt(9)
  ds_read_b64 v[144:145], v162 offset:2944
  ds_read_b64 v[146:147], v162 offset:2952
  ds_read_b64 v[148:149], v162 offset:3680
  ds_read_b64 v[150:151], v162 offset:3688
  s_mov_b64 exec, s[38:39]
  ds_write2_b32 v229, a186, a190 offset0:44 offset1:55
  s_mov_b64 exec, -1
  v_smfmac_f32_16x16x64_bf16 v[192:195], v[168:171], v[128:135], v166
  s_waitcnt lgkmcnt(7)
  ds_read_b64 v[152:153], v162 offset:4416
  ds_read_b64 v[154:155], v162 offset:4424
  ds_read_b128 v[180:183], v163 offset:16896
  ds_read_b64 v[112:113], v162 offset:88
  s_mov_b64 exec, s[38:39]
  ds_write2_b32 v229, a187, a191 offset0:66 offset1:77
  s_mov_b64 exec, -1
  v_cvt_pk_bf16_f32 v211, v200, v201
  v_cvt_pk_bf16_f32 v215, v202, v203
  v_smfmac_f32_16x16x64_bf16 v[192:195], v[172:175], v[136:143], v166
  ds_read_b64 v[114:115], v162 offset:96
  ds_read_b64 v[116:117], v162 offset:824
  ds_read_b64 v[118:119], v162 offset:832
  v_smfmac_f32_16x16x64_bf16 v[196:199], v[168:171], v[136:143], v166
  s_waitcnt lgkmcnt(9)
  ds_read_b128 v[184:187], v164 offset:16896
  ds_read_b64 v[120:121], v162 offset:1560
  ds_read_b64 v[122:123], v162 offset:1568
  ds_read_b64 v[124:125], v162 offset:2296
  v_cvt_pk_bf16_f32 v219, v204, v205
  v_cvt_pk_bf16_f32 v223, v206, v207
  v_smfmac_f32_16x16x64_bf16 v[192:195], v[176:179], v[144:151], v166
  ds_read_b64 v[126:127], v162 offset:2304
  ds_read_b128 v[188:191], v165 offset:16896
  ds_write_b128 v167, v[208:211] offset:0
  v_mfma_f32_16x16x32_bf16 v[200:203], v[224:227], v[224:227], 0
  v_smfmac_f32_16x16x64_bf16 v[196:199], v[172:175], v[144:151], v166
  s_waitcnt lgkmcnt(13)
  ds_read_b64 v[128:129], v162 offset:3032
  ds_read_b64 v[130:131], v162 offset:3040
  ds_write_b128 v167, v[212:215] offset:1024
  v_mfma_f32_16x16x32_bf16 v[204:207], v[224:227], v[224:227], 0
  v_smfmac_f32_16x16x64_bf16 v[196:199], v[176:179], v[152:159], v166
  s_waitcnt lgkmcnt(10)
  ds_read_b64 v[132:133], v162 offset:3768
  ds_read_b64 v[134:135], v162 offset:3776
  ds_read_b64 v[136:137], v162 offset:4504
  ds_read_b64 v[138:139], v162 offset:4512
  ds_write_b128 v167, v[216:219] offset:2048
  v_smfmac_f32_16x16x64_bf16 v[200:203], v[180:183], v[112:119], v166
  s_waitcnt lgkmcnt(10)
  ds_read_b128 v[168:171], v163 offset:17408
  ds_read_b64 v[144:145], v162 offset:176
  ds_read_b64 v[146:147], v162 offset:184
  ds_read_b64 v[148:149], v162 offset:912
  ds_write_b128 v167, v[220:223] offset:3072
  v_cvt_pk_bf16_f32 v208, v192, v193
  v_cvt_pk_bf16_f32 v212, v194, v195
  v_smfmac_f32_16x16x64_bf16 v[200:203], v[184:187], v[120:127], v166
  v_smfmac_f32_16x16x64_bf16 v[204:207], v[180:183], v[120:127], v166
  s_waitcnt lgkmcnt(8)
  ds_read_b64 v[150:151], v162 offset:920
  ds_read_b128 v[172:175], v164 offset:17408
  ds_read_b64 v[152:153], v162 offset:1648
  ds_read_b64 v[154:155], v162 offset:1656
  s_waitcnt lgkmcnt(4)
  s_barrier
  ds_read_b128 v[32:35], v0 offset:0
  ds_read_b128 v[36:39], v0 offset:256
  ds_read_b128 v[40:43], v0 offset:512
  ds_read_b128 v[44:47], v0 offset:768
  v_add_u32 v228, 130688, v10
  v_cvt_pk_bf16_f32 v216, v196, v197
  v_cvt_pk_bf16_f32 v220, v198, v199
  v_smfmac_f32_16x16x64_bf16 v[200:203], v[188:191], v[128:135], v166
  ds_read_b64 v[156:157], v162 offset:2384
  ds_read_b64 v[158:159], v162 offset:2392
  ds_read_b128 v[176:179], v165 offset:17408
  ds_read_b64 v[112:113], v162 offset:3120
  s_waitcnt vmcnt(14)
  ds_write2_b32 v228, a192, a196 offset0:0 offset1:11
  v_mfma_f32_16x16x32_bf16 v[192:195], v[224:227], v[224:227], 0
  v_smfmac_f32_16x16x64_bf16 v[204:207], v[184:187], v[128:135], v166
  ds_read_b64 v[114:115], v162 offset:3128
  ds_read_b64 v[116:117], v162 offset:3856
  ds_write2_b32 v228, a193, a197 offset0:22 offset1:33
  v_mfma_f32_16x16x32_bf16 v[196:199], v[224:227], v[224:227], 0
  v_smfmac_f32_16x16x64_bf16 v[204:207], v[188:191], v[136:143], v166
  s_waitcnt lgkmcnt(15)
  ds_write2_b32 v228, a194, a198 offset0:44 offset1:55
  v_smfmac_f32_16x16x64_bf16 v[192:195], v[168:171], v[144:151], v166
  s_waitcnt lgkmcnt(7)
  ds_read_b64 v[118:119], v162 offset:3864
  ds_read_b64 v[120:121], v162 offset:4592
  ds_read_b64 v[122:123], v162 offset:4600
  ds_read_b128 v[180:183], v163 offset:17920
  ds_write2_b32 v228, a195, a199 offset0:66 offset1:77
  v_add_u32 v229, 130688, v11
  v_cvt_pk_bf16_f32 v209, v200, v201
  v_cvt_pk_bf16_f32 v213, v202, v203
  v_smfmac_f32_16x16x64_bf16 v[192:195], v[172:175], v[152:159], v166
  ds_read_b64 v[128:129], v162 offset:264
  ds_read_b64 v[130:131], v162 offset:272
  ds_read_b64 v[132:133], v162 offset:1000
  s_waitcnt vmcnt(12)
  ds_write2_b32 v229, a200, a204 offset0:0 offset1:11
  v_smfmac_f32_16x16x64_bf16 v[196:199], v[168:171], v[152:159], v166
  s_waitcnt lgkmcnt(8)
  ds_read_b64 v[134:135], v162 offset:1008
  ds_read_b128 v[184:187], v164 offset:17920
  ds_read_b64 v[136:137], v162 offset:1736
  ds_read_b64 v[138:139], v162 offset:1744
  ds_write2_b32 v229, a201, a205 offset0:22 offset1:33
  v_cvt_pk_bf16_f32 v217, v204, v205
  v_cvt_pk_bf16_f32 v221, v206, v207
  v_smfmac_f32_16x16x64_bf16 v[192:195], v[176:179], v[112:119], v166
  ds_read_b64 v[140:141], v162 offset:2472
  ds_read_b64 v[142:143], v162 offset:2480
  ds_write2_b32 v229, a202, a206 offset0:44 offset1:55
  v_mfma_f32_16x16x32_bf16 v[200:203], v[224:227], v[224:227], 0
  v_smfmac_f32_16x16x64_bf16 v[196:199], v[172:175], v[112:119], v166
  s_waitcnt lgkmcnt(14)
  ds_read_b128 v[188:191], v165 offset:17920
  ds_write2_b32 v229, a203, a207 offset0:66 offset1:77
  v_add_u32 v228, 130688, v12
  v_mfma_f32_16x16x32_bf16 v[204:207], v[224:227], v[224:227], 0
  v_smfmac_f32_16x16x64_bf16 v[196:199], v[176:179], v[120:127], v166
  s_waitcnt lgkmcnt(9)
  ds_read_b64 v[144:145], v162 offset:3208
  ds_read_b64 v[146:147], v162 offset:3216
  ds_read_b64 v[148:149], v162 offset:3944
  ds_read_b64 v[150:151], v162 offset:3952
  s_waitcnt vmcnt(10)
  ds_write2_b32 v228, a208, a212 offset0:0 offset1:11
  v_smfmac_f32_16x16x64_bf16 v[200:203], v[180:183], v[128:135], v166
  s_waitcnt lgkmcnt(8)
  ds_read_b64 v[152:153], v162 offset:4680
  ds_read_b64 v[154:155], v162 offset:4688
  ds_read_b128 v[168:171], v163 offset:24576
  ds_read_b64 v[112:113], v160 offset:0
  ds_write2_b32 v228, a209, a213 offset0:22 offset1:33
  s_barrier
  v_cvt_pk_bf16_f32 v210, v192, v193
  v_cvt_pk_bf16_f32 v214, v194, v195
  v_smfmac_f32_16x16x64_bf16 v[200:203], v[184:187], v[136:143], v166
  ds_read_b64 v[114:115], v160 offset:8
  ds_read_b64 v[116:117], v160 offset:736
  ds_write2_b32 v228, a210, a214 offset0:44 offset1:55
  v_smfmac_f32_16x16x64_bf16 v[204:207], v[180:183], v[136:143], v166
  s_waitcnt lgkmcnt(9)
  ds_read_b64 v[118:119], v160 offset:744
  ds_read_b128 v[172:175], v164 offset:24576
  ds_read_b64 v[120:121], v160 offset:1472
  ds_read_b64 v[122:123], v160 offset:1480
  ds_write2_b32 v228, a211, a215 offset0:66 offset1:77
  v_add_u32 v229, 130688, v13
  v_cvt_pk_bf16_f32 v218, v196, v197
  v_cvt_pk_bf16_f32 v222, v198, v199
  v_smfmac_f32_16x16x64_bf16 v[200:203], v[188:191], v[144:151], v166
  ds_read_b64 v[124:125], v160 offset:2208
  s_waitcnt vmcnt(8)
  s_mov_b64 exec, s[38:39]
  ds_write2_b32 v229, a216, a220 offset0:0 offset1:11
  s_mov_b64 exec, -1
  v_mfma_f32_16x16x32_bf16 v[192:195], v[224:227], v[224:227], 0
  v_smfmac_f32_16x16x64_bf16 v[204:207], v[184:187], v[144:151], v166
  s_waitcnt lgkmcnt(13)
  ds_read_b64 v[126:127], v160 offset:2216
  ds_read_b128 v[176:179], v165 offset:24576
  s_mov_b64 exec, s[38:39]
  ds_write2_b32 v229, a217, a221 offset0:22 offset1:33
  s_mov_b64 exec, -1
  v_mfma_f32_16x16x32_bf16 v[196:199], v[224:227], v[224:227], 0
  v_smfmac_f32_16x16x64_bf16 v[204:207], v[188:191], v[152:159], v166
  s_waitcnt lgkmcnt(9)
  ds_read_b64 v[128:129], v160 offset:2944
  ds_read_b64 v[130:131], v160 offset:2952
  ds_read_b64 v[132:133], v160 offset:3680
  ds_read_b64 v[134:135], v160 offset:3688
  s_mov_b64 exec, s[38:39]
  ds_write2_b32 v229, a218, a222 offset0:44 offset1:55
  s_mov_b64 exec, -1
  v_smfmac_f32_16x16x64_bf16 v[192:195], v[168:171], v[112:119], v166
  s_waitcnt lgkmcnt(7)
  ds_read_b64 v[136:137], v160 offset:4416
  ds_read_b64 v[138:139], v160 offset:4424
  ds_read_b128 v[180:183], v163 offset:25088
  ds_read_b64 v[144:145], v160 offset:88
  s_mov_b64 exec, s[38:39]
  ds_write2_b32 v229, a219, a223 offset0:66 offset1:77
  s_mov_b64 exec, -1
  v_cvt_pk_bf16_f32 v211, v200, v201
  v_cvt_pk_bf16_f32 v215, v202, v203
  v_smfmac_f32_16x16x64_bf16 v[192:195], v[172:175], v[120:127], v166
  ds_read_b64 v[146:147], v160 offset:96
  ds_read_b64 v[148:149], v160 offset:824
  ds_read_b64 v[150:151], v160 offset:832
  v_smfmac_f32_16x16x64_bf16 v[196:199], v[168:171], v[120:127], v166
  s_waitcnt lgkmcnt(9)
  ds_read_b128 v[184:187], v164 offset:25088
  ds_read_b64 v[152:153], v160 offset:1560
  ds_read_b64 v[154:155], v160 offset:1568
  ds_read_b64 v[156:157], v160 offset:2296
  v_cvt_pk_bf16_f32 v219, v204, v205
  v_cvt_pk_bf16_f32 v223, v206, v207
  v_smfmac_f32_16x16x64_bf16 v[192:195], v[176:179], v[128:135], v166
  ds_read_b64 v[158:159], v160 offset:2304
  ds_read_b128 v[188:191], v165 offset:25088
  ds_write_b128 v167, v[208:211] offset:0
  v_mfma_f32_16x16x32_bf16 v[200:203], v[224:227], v[224:227], 0
  v_smfmac_f32_16x16x64_bf16 v[196:199], v[172:175], v[128:135], v166
  s_waitcnt lgkmcnt(13)
  ds_read_b64 v[112:113], v160 offset:3032
  ds_read_b64 v[114:115], v160 offset:3040
  ds_write_b128 v167, v[212:215] offset:1024
  v_mfma_f32_16x16x32_bf16 v[204:207], v[224:227], v[224:227], 0
  v_smfmac_f32_16x16x64_bf16 v[196:199], v[176:179], v[136:143], v166
  s_waitcnt lgkmcnt(10)
  ds_read_b64 v[116:117], v160 offset:3768
  ds_read_b64 v[118:119], v160 offset:3776
  ds_read_b64 v[120:121], v160 offset:4504
  ds_read_b64 v[122:123], v160 offset:4512
  ds_write_b128 v167, v[216:219] offset:2048
  v_smfmac_f32_16x16x64_bf16 v[200:203], v[180:183], v[144:151], v166
  s_waitcnt lgkmcnt(10)
  ds_read_b128 v[168:171], v163 offset:25600
  ds_read_b64 v[128:129], v160 offset:176
  ds_read_b64 v[130:131], v160 offset:184
  ds_read_b64 v[132:133], v160 offset:912
  ds_write_b128 v167, v[220:223] offset:3072
  v_cvt_pk_bf16_f32 v208, v192, v193
  v_cvt_pk_bf16_f32 v212, v194, v195
  v_smfmac_f32_16x16x64_bf16 v[200:203], v[184:187], v[152:159], v166
  v_smfmac_f32_16x16x64_bf16 v[204:207], v[180:183], v[152:159], v166
  s_waitcnt lgkmcnt(8)
  ds_read_b64 v[134:135], v160 offset:920
  ds_read_b128 v[172:175], v164 offset:25600
  ds_read_b64 v[136:137], v160 offset:1648
  ds_read_b64 v[138:139], v160 offset:1656
  s_waitcnt lgkmcnt(4)
  s_barrier
  ds_read_b128 v[48:51], v0 offset:0
  ds_read_b128 v[52:55], v0 offset:256
  ds_read_b128 v[56:59], v0 offset:512
  ds_read_b128 v[60:63], v0 offset:768
  v_add_u32 v228, 0, v10
  v_cvt_pk_bf16_f32 v216, v196, v197
  v_cvt_pk_bf16_f32 v220, v198, v199
  v_smfmac_f32_16x16x64_bf16 v[200:203], v[188:191], v[112:119], v166
  ds_read_b64 v[140:141], v160 offset:2384
  ds_read_b64 v[142:143], v160 offset:2392
  ds_read_b128 v[176:179], v165 offset:25600
  ds_read_b64 v[144:145], v160 offset:3120
  s_waitcnt vmcnt(6)
  ds_write2_b32 v228, a0, a16 offset0:0 offset1:11
  v_mfma_f32_16x16x32_bf16 v[192:195], v[224:227], v[224:227], 0
  v_smfmac_f32_16x16x64_bf16 v[204:207], v[184:187], v[112:119], v166
  ds_read_b64 v[146:147], v160 offset:3128
  ds_read_b64 v[148:149], v160 offset:3856
  ds_write2_b32 v228, a1, a17 offset0:22 offset1:33
  v_mfma_f32_16x16x32_bf16 v[196:199], v[224:227], v[224:227], 0
  v_smfmac_f32_16x16x64_bf16 v[204:207], v[188:191], v[120:127], v166
  s_waitcnt lgkmcnt(15)
  ds_write2_b32 v228, a2, a18 offset0:44 offset1:55
  v_smfmac_f32_16x16x64_bf16 v[192:195], v[168:171], v[128:135], v166
  s_waitcnt lgkmcnt(7)
  ds_read_b64 v[150:151], v160 offset:3864
  ds_read_b64 v[152:153], v160 offset:4592
  ds_read_b64 v[154:155], v160 offset:4600
  ds_read_b128 v[180:183], v163 offset:26112
  ds_write2_b32 v228, a3, a19 offset0:66 offset1:77
  v_add_u32 v229, 0, v11
  v_cvt_pk_bf16_f32 v209, v200, v201
  v_cvt_pk_bf16_f32 v213, v202, v203
  v_smfmac_f32_16x16x64_bf16 v[192:195], v[172:175], v[136:143], v166
  ds_read_b64 v[112:113], v160 offset:264
  ds_read_b64 v[114:115], v160 offset:272
  ds_read_b64 v[116:117], v160 offset:1000
  s_waitcnt vmcnt(4)
  ds_write2_b32 v229, a32, a48 offset0:0 offset1:11
  v_smfmac_f32_16x16x64_bf16 v[196:199], v[168:171], v[136:143], v166
  s_waitcnt lgkmcnt(8)
  ds_read_b64 v[118:119], v160 offset:1008
  ds_read_b128 v[184:187], v164 offset:26112
  ds_read_b64 v[120:121], v160 offset:1736
  ds_read_b64 v[122:123], v160 offset:1744
  ds_write2_b32 v229, a33, a49 offset0:22 offset1:33
  v_cvt_pk_bf16_f32 v217, v204, v205
  v_cvt_pk_bf16_f32 v221, v206, v207
  v_smfmac_f32_16x16x64_bf16 v[192:195], v[176:179], v[144:151], v166
  ds_read_b64 v[124:125], v160 offset:2472
  ds_read_b64 v[126:127], v160 offset:2480
  ds_write2_b32 v229, a34, a50 offset0:44 offset1:55
  v_mfma_f32_16x16x32_bf16 v[200:203], v[224:227], v[224:227], 0
  v_smfmac_f32_16x16x64_bf16 v[196:199], v[172:175], v[144:151], v166
  s_waitcnt lgkmcnt(14)
  ds_read_b128 v[188:191], v165 offset:26112
  ds_write2_b32 v229, a35, a51 offset0:66 offset1:77
  v_add_u32 v228, 0, v12
  v_mfma_f32_16x16x32_bf16 v[204:207], v[224:227], v[224:227], 0
  v_smfmac_f32_16x16x64_bf16 v[196:199], v[176:179], v[152:159], v166
  s_waitcnt lgkmcnt(9)
  ds_read_b64 v[128:129], v160 offset:3208
  ds_read_b64 v[130:131], v160 offset:3216
  ds_read_b64 v[132:133], v160 offset:3944
  ds_read_b64 v[134:135], v160 offset:3952
  s_waitcnt vmcnt(2)
  ds_write2_b32 v228, a64, a80 offset0:0 offset1:11
  v_smfmac_f32_16x16x64_bf16 v[200:203], v[180:183], v[112:119], v166
  s_waitcnt lgkmcnt(8)
  ds_read_b64 v[136:137], v160 offset:4680
  ds_read_b64 v[138:139], v160 offset:4688
  ds_read_b128 v[168:171], v163 offset:32768
  ds_read_b64 v[144:145], v161 offset:0
  ds_write2_b32 v228, a65, a81 offset0:22 offset1:33
  s_barrier
  v_cvt_pk_bf16_f32 v210, v192, v193
  v_cvt_pk_bf16_f32 v214, v194, v195
  v_smfmac_f32_16x16x64_bf16 v[200:203], v[184:187], v[120:127], v166
  ds_read_b64 v[146:147], v161 offset:8
  ds_read_b64 v[148:149], v161 offset:736
  ds_write2_b32 v228, a66, a82 offset0:44 offset1:55
  v_smfmac_f32_16x16x64_bf16 v[204:207], v[180:183], v[120:127], v166
  s_waitcnt lgkmcnt(9)
  ds_read_b64 v[150:151], v161 offset:744
  ds_read_b128 v[172:175], v164 offset:32768
  ds_read_b64 v[152:153], v161 offset:1472
  ds_read_b64 v[154:155], v161 offset:1480
  ds_write2_b32 v228, a67, a83 offset0:66 offset1:77
  v_add_u32 v229, 0, v13
  v_cvt_pk_bf16_f32 v218, v196, v197
  v_cvt_pk_bf16_f32 v222, v198, v199
  v_smfmac_f32_16x16x64_bf16 v[200:203], v[188:191], v[128:135], v166
  ds_read_b64 v[156:157], v161 offset:2208
  s_waitcnt vmcnt(0)
  s_mov_b64 exec, s[38:39]
  ds_write2_b32 v229, a96, a112 offset0:0 offset1:11
  s_mov_b64 exec, -1
  v_mfma_f32_16x16x32_bf16 v[192:195], v[224:227], v[224:227], 0
  v_smfmac_f32_16x16x64_bf16 v[204:207], v[184:187], v[128:135], v166
  s_waitcnt lgkmcnt(13)
  ds_read_b64 v[158:159], v161 offset:2216
  ds_read_b128 v[176:179], v165 offset:32768
  s_mov_b64 exec, s[38:39]
  ds_write2_b32 v229, a97, a113 offset0:22 offset1:33
  s_mov_b64 exec, -1
  v_mfma_f32_16x16x32_bf16 v[196:199], v[224:227], v[224:227], 0
  v_smfmac_f32_16x16x64_bf16 v[204:207], v[188:191], v[136:143], v166
  s_waitcnt lgkmcnt(9)
  ds_read_b64 v[112:113], v161 offset:2944
  ds_read_b64 v[114:115], v161 offset:2952
  ds_read_b64 v[116:117], v161 offset:3680
  ds_read_b64 v[118:119], v161 offset:3688
  s_mov_b64 exec, s[38:39]
  ds_write2_b32 v229, a98, a114 offset0:44 offset1:55
  s_mov_b64 exec, -1
  v_smfmac_f32_16x16x64_bf16 v[192:195], v[168:171], v[144:151], v166
  s_waitcnt lgkmcnt(7)
  ds_read_b64 v[120:121], v161 offset:4416
  ds_read_b64 v[122:123], v161 offset:4424
  ds_read_b128 v[180:183], v163 offset:33280
  ds_read_b64 v[128:129], v161 offset:88
  s_mov_b64 exec, s[38:39]
  ds_write2_b32 v229, a99, a115 offset0:66 offset1:77
  s_mov_b64 exec, -1
  v_cvt_pk_bf16_f32 v211, v200, v201
  v_cvt_pk_bf16_f32 v215, v202, v203
  v_smfmac_f32_16x16x64_bf16 v[192:195], v[172:175], v[152:159], v166
  ds_read_b64 v[130:131], v161 offset:96
  ds_read_b64 v[132:133], v161 offset:824
  ds_read_b64 v[134:135], v161 offset:832
  v_smfmac_f32_16x16x64_bf16 v[196:199], v[168:171], v[152:159], v166
  s_waitcnt lgkmcnt(9)
  ds_read_b128 v[184:187], v164 offset:33280
  ds_read_b64 v[136:137], v161 offset:1560
  ds_read_b64 v[138:139], v161 offset:1568
  ds_read_b64 v[140:141], v161 offset:2296
  v_dot2_f32_bf16 v236, v16, s35, 0
  v_dot2_f32_bf16 v237, v20, s35, 0
  v_dot2_f32_bf16 v238, v24, s35, 0
  v_dot2_f32_bf16 v239, v28, s35, 0
  v_dot2_f32_bf16 v240, v16, v16, 0
  v_cvt_pk_bf16_f32 v219, v204, v205
  v_cvt_pk_bf16_f32 v223, v206, v207
  v_smfmac_f32_16x16x64_bf16 v[192:195], v[176:179], v[112:119], v166
  ds_read_b64 v[142:143], v161 offset:2304
  ds_read_b128 v[188:191], v165 offset:33280
  ds_write_b128 v167, v[208:211] offset:0
  v_dot2_f32_bf16 v241, v20, v20, 0
  v_dot2_f32_bf16 v242, v24, v24, 0
  v_dot2_f32_bf16 v243, v28, v28, 0
  v_dot2c_f32_bf16 v236, s35, v17
  v_dot2c_f32_bf16 v237, s35, v21
  v_mfma_f32_16x16x32_bf16 v[200:203], v[224:227], v[224:227], 0
  v_smfmac_f32_16x16x64_bf16 v[196:199], v[172:175], v[112:119], v166
  s_waitcnt lgkmcnt(13)
  ds_read_b64 v[144:145], v161 offset:3032
  ds_read_b64 v[146:147], v161 offset:3040
  ds_write_b128 v167, v[212:215] offset:1024
  v_dot2c_f32_bf16 v238, s35, v25
  v_dot2c_f32_bf16 v239, s35, v29
  v_dot2c_f32_bf16 v240, v17, v17
  v_dot2c_f32_bf16 v241, v21, v21
  v_dot2c_f32_bf16 v242, v25, v25
  v_mfma_f32_16x16x32_bf16 v[204:207], v[224:227], v[224:227], 0
  v_smfmac_f32_16x16x64_bf16 v[196:199], v[176:179], v[120:127], v166
  s_waitcnt lgkmcnt(10)
  ds_read_b64 v[148:149], v161 offset:3768
  ds_read_b64 v[150:151], v161 offset:3776
  ds_read_b64 v[152:153], v161 offset:4504
  ds_read_b64 v[154:155], v161 offset:4512
  ds_write_b128 v167, v[216:219] offset:2048
  v_dot2c_f32_bf16 v243, v29, v29
  v_dot2c_f32_bf16 v236, s35, v18
  v_dot2c_f32_bf16 v237, s35, v22
  v_dot2c_f32_bf16 v238, s35, v26
  v_dot2c_f32_bf16 v239, s35, v30
  v_smfmac_f32_16x16x64_bf16 v[200:203], v[180:183], v[128:135], v166
  s_waitcnt lgkmcnt(10)
  ds_read_b128 v[168:171], v163 offset:33792
  ds_read_b64 v[112:113], v161 offset:176
  ds_read_b64 v[114:115], v161 offset:184
  ds_read_b64 v[116:117], v161 offset:912
  ds_write_b128 v167, v[220:223] offset:3072
  v_dot2c_f32_bf16 v240, v18, v18
  v_dot2c_f32_bf16 v241, v22, v22
  v_dot2c_f32_bf16 v242, v26, v26
  v_dot2c_f32_bf16 v243, v30, v30
  v_dot2c_f32_bf16 v236, s35, v19
  v_cvt_pk_bf16_f32 v208, v192, v193
  v_cvt_pk_bf16_f32 v212, v194, v195
  v_smfmac_f32_16x16x64_bf16 v[200:203], v[184:187], v[136:143], v166
  v_dot2c_f32_bf16 v237, s35, v23
  v_dot2c_f32_bf16 v238, s35, v27
  v_dot2c_f32_bf16 v239, s35, v31
  v_dot2c_f32_bf16 v240, v19, v19
  v_dot2c_f32_bf16 v241, v23, v23
  v_smfmac_f32_16x16x64_bf16 v[204:207], v[180:183], v[136:143], v166
  s_waitcnt lgkmcnt(8)
  ds_read_b64 v[118:119], v161 offset:920
  ds_read_b128 v[172:175], v164 offset:33792
  ds_read_b64 v[120:121], v161 offset:1648
  ds_read_b64 v[122:123], v161 offset:1656
  s_waitcnt lgkmcnt(4)
  s_barrier
  ds_read_b128 v[64:67], v0 offset:0
  ds_read_b128 v[68:71], v0 offset:256
  ds_read_b128 v[72:75], v0 offset:512
  ds_read_b128 v[76:79], v0 offset:768
  v_dot2c_f32_bf16 v242, v27, v27
  v_dot2c_f32_bf16 v243, v31, v31
  v_dot2c_f32_bf16 v236, s35, v32
  v_dot2c_f32_bf16 v237, s35, v36
  v_dot2c_f32_bf16 v238, s35, v40
  v_cvt_pk_bf16_f32 v216, v196, v197
  v_cvt_pk_bf16_f32 v220, v198, v199
  v_smfmac_f32_16x16x64_bf16 v[200:203], v[188:191], v[144:151], v166
  ds_read_b64 v[124:125], v161 offset:2384
  ds_read_b64 v[126:127], v161 offset:2392
  ds_read_b128 v[176:179], v165 offset:33792
  ds_read_b64 v[128:129], v161 offset:3120
  v_dot2c_f32_bf16 v239, s35, v44
  v_dot2c_f32_bf16 v240, v32, v32
  v_dot2c_f32_bf16 v241, v36, v36
  v_dot2c_f32_bf16 v242, v40, v40
  v_dot2c_f32_bf16 v243, v44, v44
  v_mfma_f32_16x16x32_bf16 v[192:195], v[224:227], v[224:227], 0
  v_smfmac_f32_16x16x64_bf16 v[204:207], v[184:187], v[144:151], v166
  ds_read_b64 v[130:131], v161 offset:3128
  ds_read_b64 v[132:133], v161 offset:3856
  ds_read_b64 v[134:135], v161 offset:3864
  v_dot2c_f32_bf16 v236, s35, v33
  v_dot2c_f32_bf16 v237, s35, v37
  v_dot2c_f32_bf16 v238, s35, v41
  v_dot2c_f32_bf16 v239, s35, v45
  v_dot2c_f32_bf16 v240, v33, v33
  v_mfma_f32_16x16x32_bf16 v[196:199], v[224:227], v[224:227], 0
  v_smfmac_f32_16x16x64_bf16 v[204:207], v[188:191], v[152:159], v166
  s_waitcnt lgkmcnt(14)
  ds_read_b64 v[136:137], v161 offset:4592
  v_dot2c_f32_bf16 v241, v37, v37
  v_dot2c_f32_bf16 v242, v41, v41
  v_dot2c_f32_bf16 v243, v45, v45
  v_dot2c_f32_bf16 v236, s35, v34
  v_dot2c_f32_bf16 v237, s35, v38
  v_smfmac_f32_16x16x64_bf16 v[192:195], v[168:171], v[112:119], v166
  s_waitcnt lgkmcnt(6)
  ds_read_b64 v[138:139], v161 offset:4600
  ds_read_b128 v[180:183], v163 offset:34304
  ds_read_b64 v[144:145], v161 offset:264
  ds_read_b64 v[146:147], v161 offset:272
  v_dot2c_f32_bf16 v238, s35, v42
  v_dot2c_f32_bf16 v239, s35, v46
  v_dot2c_f32_bf16 v240, v34, v34
  v_dot2c_f32_bf16 v241, v38, v38
  v_dot2c_f32_bf16 v242, v42, v42
  v_cvt_pk_bf16_f32 v209, v200, v201
  v_cvt_pk_bf16_f32 v213, v202, v203
  v_smfmac_f32_16x16x64_bf16 v[192:195], v[172:175], v[120:127], v166
  ds_read_b64 v[148:149], v161 offset:1000
  ds_read_b64 v[150:151], v161 offset:1008
  ds_read_b128 v[184:187], v164 offset:34304
  ds_read_b64 v[152:153], v161 offset:1736
  v_dot2c_f32_bf16 v243, v46, v46
  v_dot2c_f32_bf16 v236, s35, v35
  v_dot2c_f32_bf16 v237, s35, v39
  v_dot2c_f32_bf16 v238, s35, v43
  v_dot2c_f32_bf16 v239, s35, v47
  v_smfmac_f32_16x16x64_bf16 v[196:199], v[168:171], v[120:127], v166
  s_waitcnt lgkmcnt(9)
  ds_read_b64 v[154:155], v161 offset:1744
  ds_read_b64 v[156:157], v161 offset:2472
  ds_read_b64 v[158:159], v161 offset:2480
  ds_read_b128 v[188:191], v165 offset:34304
  v_dot2c_f32_bf16 v240, v35, v35
  v_dot2c_f32_bf16 v241, v39, v39
  v_dot2c_f32_bf16 v242, v43, v43
  v_dot2c_f32_bf16 v243, v47, v47
  v_dot2c_f32_bf16 v236, s35, v48
  v_cvt_pk_bf16_f32 v217, v204, v205
  v_cvt_pk_bf16_f32 v221, v206, v207
  v_smfmac_f32_16x16x64_bf16 v[192:195], v[176:179], v[128:135], v166
  ds_read_b64 v[112:113], v161 offset:3208
  ds_read_b64 v[114:115], v161 offset:3216
  v_dot2c_f32_bf16 v237, s35, v52
  v_dot2c_f32_bf16 v238, s35, v56
  v_dot2c_f32_bf16 v239, s35, v60
  v_dot2c_f32_bf16 v240, v48, v48
  v_dot2c_f32_bf16 v241, v52, v52
  v_mfma_f32_16x16x32_bf16 v[200:203], v[224:227], v[224:227], 0
  v_smfmac_f32_16x16x64_bf16 v[196:199], v[172:175], v[128:135], v166
  s_waitcnt lgkmcnt(13)
  ds_read_b64 v[116:117], v161 offset:3944
  ds_read_b64 v[118:119], v161 offset:3952
  v_dot2c_f32_bf16 v242, v56, v56
  v_dot2c_f32_bf16 v243, v60, v60
  v_dot2c_f32_bf16 v236, s35, v49
  v_dot2c_f32_bf16 v237, s35, v53
  v_dot2c_f32_bf16 v238, s35, v57
  v_mfma_f32_16x16x32_bf16 v[204:207], v[224:227], v[224:227], 0
  v_smfmac_f32_16x16x64_bf16 v[196:199], v[176:179], v[136:143], v166
  s_waitcnt lgkmcnt(10)
  ds_read_b64 v[120:121], v161 offset:4680
  ds_read_b64 v[122:123], v161 offset:4688
  ds_read_b128 v[168:171], v163 offset:40960
  ds_read_b64 v[128:129], v162 offset:0
  v_dot2c_f32_bf16 v239, s35, v61
  v_dot2c_f32_bf16 v240, v49, v49
  v_dot2c_f32_bf16 v241, v53, v53
  v_dot2c_f32_bf16 v242, v57, v57
  v_dot2c_f32_bf16 v243, v61, v61
  v_smfmac_f32_16x16x64_bf16 v[200:203], v[180:183], v[144:151], v166
  s_waitcnt lgkmcnt(9)
  ds_read_b64 v[130:131], v162 offset:8
  ds_read_b64 v[132:133], v162 offset:736
  ds_read_b64 v[134:135], v162 offset:744
  ds_read_b128 v[172:175], v164 offset:40960
  s_barrier
  v_dot2c_f32_bf16 v236, s35, v50
  v_dot2c_f32_bf16 v237, s35, v54
  v_dot2c_f32_bf16 v238, s35, v58
  v_dot2c_f32_bf16 v239, s35, v62
  v_dot2c_f32_bf16 v240, v50, v50
  v_cvt_pk_bf16_f32 v210, v192, v193
  v_cvt_pk_bf16_f32 v214, v194, v195
  v_smfmac_f32_16x16x64_bf16 v[200:203], v[184:187], v[152:159], v166
  ds_read_b64 v[136:137], v162 offset:1472
  ds_read_b64 v[138:139], v162 offset:1480
  v_dot2c_f32_bf16 v241, v54, v54
  v_dot2c_f32_bf16 v242, v58, v58
  v_dot2c_f32_bf16 v243, v62, v62
  v_dot2c_f32_bf16 v236, s35, v51
  v_dot2c_f32_bf16 v237, s35, v55
  v_smfmac_f32_16x16x64_bf16 v[204:207], v[180:183], v[152:159], v166
  s_waitcnt lgkmcnt(10)
  ds_read_b64 v[140:141], v162 offset:2208
  ds_read_b64 v[142:143], v162 offset:2216
  ds_read_b128 v[176:179], v165 offset:40960
  ds_read_b64 v[144:145], v162 offset:2944
  v_dot2c_f32_bf16 v238, s35, v59
  v_dot2c_f32_bf16 v239, s35, v63
  v_dot2c_f32_bf16 v240, v51, v51
  v_dot2c_f32_bf16 v241, v55, v55
  v_dot2c_f32_bf16 v242, v59, v59
  v_cvt_pk_bf16_f32 v218, v196, v197
  v_cvt_pk_bf16_f32 v222, v198, v199
  v_smfmac_f32_16x16x64_bf16 v[200:203], v[188:191], v[112:119], v166
  ds_read_b64 v[146:147], v162 offset:2952
  v_dot2c_f32_bf16 v243, v63, v63
  v_mfma_f32_16x16x32_bf16 v[192:195], v[224:227], v[224:227], 0
  v_smfmac_f32_16x16x64_bf16 v[204:207], v[184:187], v[112:119], v166
  s_waitcnt lgkmcnt(13)
  ds_read_b64 v[148:149], v162 offset:3680
  ds_read_b64 v[150:151], v162 offset:3688
  v_mfma_f32_16x16x32_bf16 v[196:199], v[224:227], v[224:227], 0
  v_smfmac_f32_16x16x64_bf16 v[204:207], v[188:191], v[120:127], v166
  s_waitcnt lgkmcnt(10)
  ds_read_b64 v[152:153], v162 offset:4416
  ds_read_b64 v[154:155], v162 offset:4424
  ds_read_b128 v[180:183], v163 offset:41472
  ds_read_b64 v[112:113], v162 offset:88
  v_smfmac_f32_16x16x64_bf16 v[192:195], v[168:171], v[128:135], v166
  s_waitcnt lgkmcnt(9)
  ds_read_b64 v[114:115], v162 offset:96
  ds_read_b64 v[116:117], v162 offset:824
  ds_read_b64 v[118:119], v162 offset:832
  ds_read_b128 v[184:187], v164 offset:41472
  v_cvt_pk_bf16_f32 v211, v200, v201
  v_cvt_pk_bf16_f32 v215, v202, v203
  v_smfmac_f32_16x16x64_bf16 v[192:195], v[172:175], v[136:143], v166
  ds_read_b64 v[120:121], v162 offset:1560
  ds_read_b64 v[122:123], v162 offset:1568
  v_smfmac_f32_16x16x64_bf16 v[196:199], v[168:171], v[136:143], v166
  s_waitcnt lgkmcnt(10)
  ds_read_b64 v[124:125], v162 offset:2296
  ds_read_b64 v[126:127], v162 offset:2304
  ds_read_b128 v[188:191], v165 offset:41472
  ds_read_b64 v[128:129], v162 offset:3032
  v_dot2c_f32_bf16 v236, s35, v64
  v_dot2c_f32_bf16 v237, s35, v68
  v_cvt_pk_bf16_f32 v219, v204, v205
  v_cvt_pk_bf16_f32 v223, v206, v207
  v_smfmac_f32_16x16x64_bf16 v[192:195], v[176:179], v[144:151], v166
  ds_read_b64 v[130:131], v162 offset:3040
  ds_write_b128 v167, v[208:211] offset:0
  v_dot2c_f32_bf16 v238, s35, v72
  v_dot2c_f32_bf16 v239, s35, v76
  v_mfma_f32_16x16x32_bf16 v[200:203], v[224:227], v[224:227], 0
  v_smfmac_f32_16x16x64_bf16 v[196:199], v[172:175], v[144:151], v166
  s_waitcnt lgkmcnt(14)
  ds_read_b64 v[132:133], v162 offset:3768
  ds_write_b128 v167, v[212:215] offset:1024
  v_dot2c_f32_bf16 v240, v64, v64
  v_dot2c_f32_bf16 v241, v68, v68
  v_mfma_f32_16x16x32_bf16 v[204:207], v[224:227], v[224:227], 0
  v_smfmac_f32_16x16x64_bf16 v[196:199], v[176:179], v[152:159], v166
  s_waitcnt lgkmcnt(11)
  ds_read_b64 v[134:135], v162 offset:3776
  ds_read_b64 v[136:137], v162 offset:4504
  ds_read_b64 v[138:139], v162 offset:4512
  ds_read_b128 v[168:171], v163 offset:41984
  ds_write_b128 v167, v[216:219] offset:2048
  v_dot2c_f32_bf16 v242, v72, v72
  v_dot2c_f32_bf16 v243, v76, v76
  v_smfmac_f32_16x16x64_bf16 v[200:203], v[180:183], v[112:119], v166
  s_waitcnt lgkmcnt(11)
  ds_read_b64 v[144:145], v162 offset:176
  ds_read_b64 v[146:147], v162 offset:184
  ds_read_b64 v[148:149], v162 offset:912
  ds_read_b64 v[150:151], v162 offset:920
  ds_write_b128 v167, v[220:223] offset:3072
  v_dot2c_f32_bf16 v236, s35, v65
  v_dot2c_f32_bf16 v237, s35, v69
  v_cvt_pk_bf16_f32 v208, v192, v193
  v_cvt_pk_bf16_f32 v212, v194, v195
  v_smfmac_f32_16x16x64_bf16 v[200:203], v[184:187], v[120:127], v166
  v_dot2c_f32_bf16 v238, s35, v73
  v_dot2c_f32_bf16 v239, s35, v77
  v_smfmac_f32_16x16x64_bf16 v[204:207], v[180:183], v[120:127], v166
  s_waitcnt lgkmcnt(9)
  ds_read_b128 v[172:175], v164 offset:41984
  ds_read_b64 v[152:153], v162 offset:1648
  ds_read_b64 v[154:155], v162 offset:1656
  ds_read_b64 v[156:157], v162 offset:2384
  s_waitcnt lgkmcnt(4)
  s_barrier
  ds_read_b128 v[80:83], v0 offset:0
  ds_read_b128 v[84:87], v0 offset:256
  ds_read_b128 v[88:91], v0 offset:512
  ds_read_b128 v[92:95], v0 offset:768
  v_dot2c_f32_bf16 v240, v65, v65
  v_dot2c_f32_bf16 v241, v69, v69
  v_cvt_pk_bf16_f32 v216, v196, v197
  v_cvt_pk_bf16_f32 v220, v198, v199
  v_smfmac_f32_16x16x64_bf16 v[200:203], v[188:191], v[128:135], v166
  ds_read_b64 v[158:159], v162 offset:2392
  ds_read_b128 v[176:179], v165 offset:41984
  ds_read_b64 v[112:113], v162 offset:3120
  ds_read_b64 v[114:115], v162 offset:3128
  v_dot2c_f32_bf16 v242, v73, v73
  v_dot2c_f32_bf16 v243, v77, v77
  v_mfma_f32_16x16x32_bf16 v[192:195], v[224:227], v[224:227], 0
  v_smfmac_f32_16x16x64_bf16 v[204:207], v[184:187], v[128:135], v166
  ds_read_b64 v[116:117], v162 offset:3856
  ds_read_b64 v[118:119], v162 offset:3864
  ds_read_b64 v[120:121], v162 offset:4592
  v_dot2c_f32_bf16 v236, s35, v66
  v_dot2c_f32_bf16 v237, s35, v70
  v_mfma_f32_16x16x32_bf16 v[196:199], v[224:227], v[224:227], 0
  v_smfmac_f32_16x16x64_bf16 v[204:207], v[188:191], v[136:143], v166
  v_dot2c_f32_bf16 v238, s35, v74
  v_dot2c_f32_bf16 v239, s35, v78
  v_smfmac_f32_16x16x64_bf16 v[192:195], v[168:171], v[144:151], v166
  s_waitcnt lgkmcnt(6)
  ds_read_b64 v[122:123], v162 offset:4600
  ds_read_b128 v[180:183], v163 offset:42496
  ds_read_b64 v[128:129], v162 offset:264
  ds_read_b64 v[130:131], v162 offset:272
  v_dot2c_f32_bf16 v240, v66, v66
  v_dot2c_f32_bf16 v241, v70, v70
  v_cvt_pk_bf16_f32 v209, v200, v201
  v_cvt_pk_bf16_f32 v213, v202, v203
  v_smfmac_f32_16x16x64_bf16 v[192:195], v[172:175], v[152:159], v166
  ds_read_b64 v[132:133], v162 offset:1000
  ds_read_b64 v[134:135], v162 offset:1008
  ds_read_b128 v[184:187], v164 offset:42496
  ds_read_b64 v[136:137], v162 offset:1736
  v_dot2c_f32_bf16 v242, v74, v74
  v_dot2c_f32_bf16 v243, v78, v78
  v_smfmac_f32_16x16x64_bf16 v[196:199], v[168:171], v[152:159], v166
  s_waitcnt lgkmcnt(9)
  ds_read_b64 v[138:139], v162 offset:1744
  ds_read_b64 v[140:141], v162 offset:2472
  ds_read_b64 v[142:143], v162 offset:2480
  ds_read_b128 v[188:191], v165 offset:42496
  v_dot2c_f32_bf16 v236, s35, v67
  v_dot2c_f32_bf16 v237, s35, v71
  v_cvt_pk_bf16_f32 v217, v204, v205
  v_cvt_pk_bf16_f32 v221, v206, v207
  v_smfmac_f32_16x16x64_bf16 v[192:195], v[176:179], v[112:119], v166
  ds_read_b64 v[144:145], v162 offset:3208
  ds_read_b64 v[146:147], v162 offset:3216
  v_dot2c_f32_bf16 v238, s35, v75
  v_dot2c_f32_bf16 v239, s35, v79
  v_mfma_f32_16x16x32_bf16 v[200:203], v[224:227], v[224:227], 0
  v_smfmac_f32_16x16x64_bf16 v[196:199], v[172:175], v[112:119], v166
  s_waitcnt lgkmcnt(13)
  ds_read_b64 v[148:149], v162 offset:3944
  ds_read_b64 v[150:151], v162 offset:3952
  v_dot2c_f32_bf16 v240, v67, v67
  v_dot2c_f32_bf16 v241, v71, v71
  v_mfma_f32_16x16x32_bf16 v[204:207], v[224:227], v[224:227], 0
  v_smfmac_f32_16x16x64_bf16 v[196:199], v[176:179], v[120:127], v166
  s_waitcnt lgkmcnt(10)
  ds_read_b64 v[152:153], v162 offset:4680
  ds_read_b64 v[154:155], v162 offset:4688
  v_dot2c_f32_bf16 v242, v75, v75
  v_dot2c_f32_bf16 v243, v79, v79
  v_smfmac_f32_16x16x64_bf16 v[200:203], v[180:183], v[128:135], v166
  s_waitcnt lgkmcnt(7)
  s_barrier
  v_cvt_pk_bf16_f32 v210, v192, v193
  v_cvt_pk_bf16_f32 v214, v194, v195
  v_smfmac_f32_16x16x64_bf16 v[200:203], v[184:187], v[136:143], v166
  v_smfmac_f32_16x16x64_bf16 v[204:207], v[180:183], v[136:143], v166
  s_waitcnt lgkmcnt(2)
  v_cvt_pk_bf16_f32 v218, v196, v197
  v_cvt_pk_bf16_f32 v222, v198, v199
  v_smfmac_f32_16x16x64_bf16 v[200:203], v[188:191], v[144:151], v166
  v_smfmac_f32_16x16x64_bf16 v[204:207], v[184:187], v[144:151], v166
  s_waitcnt lgkmcnt(0)
  v_smfmac_f32_16x16x64_bf16 v[204:207], v[188:191], v[152:159], v166
  s_nop 7
  v_cvt_pk_bf16_f32 v211, v200, v201
  v_cvt_pk_bf16_f32 v215, v202, v203
  v_cvt_pk_bf16_f32 v219, v204, v205
  v_cvt_pk_bf16_f32 v223, v206, v207
  ds_write_b128 v167, v[208:211] offset:0
  ds_write_b128 v167, v[212:215] offset:1024
  ds_write_b128 v167, v[216:219] offset:2048
  ds_write_b128 v167, v[220:223] offset:3072
  v_dot2c_f32_bf16 v236, s35, v80
  v_dot2c_f32_bf16 v237, s35, v84
  v_dot2c_f32_bf16 v238, s35, v88
  v_dot2c_f32_bf16 v239, s35, v92
  v_dot2c_f32_bf16 v240, v80, v80
  v_dot2c_f32_bf16 v241, v84, v84
  v_dot2c_f32_bf16 v242, v88, v88
  v_dot2c_f32_bf16 v243, v92, v92
  v_dot2c_f32_bf16 v236, s35, v81
  v_dot2c_f32_bf16 v237, s35, v85
  v_dot2c_f32_bf16 v238, s35, v89
  v_dot2c_f32_bf16 v239, s35, v93
  v_dot2c_f32_bf16 v240, v81, v81
  v_dot2c_f32_bf16 v241, v85, v85
  v_dot2c_f32_bf16 v242, v89, v89
  v_dot2c_f32_bf16 v243, v93, v93
  v_dot2c_f32_bf16 v236, s35, v82
  v_dot2c_f32_bf16 v237, s35, v86
  v_dot2c_f32_bf16 v238, s35, v90
  v_dot2c_f32_bf16 v239, s35, v94
  v_dot2c_f32_bf16 v240, v82, v82
  v_dot2c_f32_bf16 v241, v86, v86
  v_dot2c_f32_bf16 v242, v90, v90
  v_dot2c_f32_bf16 v243, v94, v94
  v_dot2c_f32_bf16 v236, s35, v83
  v_dot2c_f32_bf16 v237, s35, v87
  v_dot2c_f32_bf16 v238, s35, v91
  v_dot2c_f32_bf16 v239, s35, v95
  v_dot2c_f32_bf16 v240, v83, v83
  v_dot2c_f32_bf16 v241, v87, v87
  v_dot2c_f32_bf16 v242, v91, v91
  v_dot2c_f32_bf16 v243, v95, v95
  s_waitcnt lgkmcnt(0)
  s_barrier
  ds_read_b128 v[96:99], v0 offset:0
  ds_read_b128 v[100:103], v0 offset:256
  ds_read_b128 v[104:107], v0 offset:512
  ds_read_b128 v[108:111], v0 offset:768
  s_mov_b32 s20, s29
  s_add_u32 m0, s29, 0
  s_nop 0
  buffer_load_dwordx4 v1, s[16:19], s20 offen offset:0 lds
  buffer_load_dwordx4 v1, s[16:19], s20 offen offset:1024 lds
  buffer_load_dwordx4 v1, s[16:19], s20 offen offset:2048 lds
  buffer_load_dwordx4 v1, s[16:19], s20 offen offset:3072 lds
  s_add_u32 m0, s29, 4096
  s_add_u32 s20, s20, 4096
  s_nop 0
  buffer_load_dwordx4 v1, s[16:19], s20 offen offset:0 lds
  buffer_load_dwordx4 v1, s[16:19], s20 offen offset:1024 lds
  s_add_u32 s20, s20, 20480
  s_branch ln_entry
tile_loop:
  s_waitcnt vmcnt(16)
  v_dot2_f32_bf16 v224, v81, s33, v224
  v_dot2_f32_bf16 v240, v81, s34, v240
  v_dot2_f32_bf16 v225, v83, s33, v225
  v_dot2_f32_bf16 v241, v83, s34, v241
  v_dot2_f32_bf16 v226, v85, s33, v226
  v_dot2_f32_bf16 v242, v85, s34, v242
  v_dot2_f32_bf16 v227, v87, s33, v227
  v_dot2_f32_bf16 v243, v87, s34, v243
  v_dot2_f32_bf16 v228, v89, s33, v228
  v_dot2_f32_bf16 v244, v89, s34, v244
  v_dot2_f32_bf16 v229, v91, s33, v229
  v_dot2_f32_bf16 v245, v91, s34, v245
  v_dot2_f32_bf16 v230, v93, s33, v230
  v_dot2_f32_bf16 v246, v93, s34, v246
  v_dot2_f32_bf16 v231, v95, s33, v231
  v_dot2_f32_bf16 v247, v95, s34, v247
  v_dot2_f32_bf16 v232, v97, s33, v232
  v_dot2_f32_bf16 v248, v97, s34, v248
  v_dot2_f32_bf16 v233, v99, s33, v233
  v_dot2_f32_bf16 v249, v99, s34, v249
  v_dot2_f32_bf16 v234, v101, s33, v234
  v_dot2_f32_bf16 v250, v101, s34, v250
  v_dot2_f32_bf16 v235, v103, s33, v235
  v_dot2_f32_bf16 v251, v103, s34, v251
  v_dot2_f32_bf16 v236, v105, s33, v236
  v_dot2_f32_bf16 v252, v105, s34, v252
  v_dot2_f32_bf16 v237, v107, s33, v237
  v_dot2_f32_bf16 v253, v107, s34, v253
  v_dot2_f32_bf16 v238, v109, s33, v238
  v_dot2_f32_bf16 v254, v109, s34, v254
  v_dot2_f32_bf16 v239, v111, s33, v239
  v_dot2_f32_bf16 v255, v111, s34, v255
  v_cvt_pk_bf16_f32 v81, v224, v240
  v_cvt_pk_bf16_f32 v83, v225, v241
  v_cvt_pk_bf16_f32 v85, v226, v242
  v_cvt_pk_bf16_f32 v87, v227, v243
  v_cvt_pk_bf16_f32 v89, v228, v244
  v_cvt_pk_bf16_f32 v91, v229, v245
  v_cvt_pk_bf16_f32 v93, v230, v246
  v_cvt_pk_bf16_f32 v95, v231, v247
  v_cvt_pk_bf16_f32 v97, v232, v248
  v_cvt_pk_bf16_f32 v99, v233, v249
  v_cvt_pk_bf16_f32 v101, v234, v250
  v_cvt_pk_bf16_f32 v103, v235, v251
  v_cvt_pk_bf16_f32 v105, v236, v252
  v_cvt_pk_bf16_f32 v107, v237, v253
  v_cvt_pk_bf16_f32 v109, v238, v254
  v_cvt_pk_bf16_f32 v111, v239, v255
  v_mov_b32 v224, 0
  v_mov_b32 v225, 0
  v_mov_b32 v226, 0
  v_mov_b32 v227, 0
  s_nop 1
  v_mfma_f32_16x16x32_bf16 v[192:195], v[224:227], v[224:227], 0
  s_nop 0
  v_mfma_f32_16x16x32_bf16 v[196:199], v[224:227], v[224:227], 0
  ds_read_b128 v[168:171], v163 offset:0
  ds_read_b64 v[112:113], v160 offset:0
  ds_read_b64 v[114:115], v160 offset:8
  ds_read_b64 v[116:117], v160 offset:736
  ds_read_b64 v[118:119], v160 offset:744
  ds_read_b128 v[172:175], v164 offset:0
  ds_read_b64 v[120:121], v160 offset:1472
  ds_read_b64 v[122:123], v160 offset:1480
  ds_read_b64 v[124:125], v160 offset:2208
  ds_read_b64 v[126:127], v160 offset:2216
  ds_read_b128 v[176:179], v165 offset:0
  ds_read_b64 v[128:129], v160 offset:2944
  ds_read_b64 v[130:131], v160 offset:2952
  ds_read_b64 v[132:133], v160 offset:3680
  ds_read_b64 v[134:135], v160 offset:3688
  s_waitcnt lgkmcnt(10)
  v_smfmac_f32_16x16x64_bf16 v[192:195], v[168:171], v[112:119], v166
  s_waitcnt lgkmcnt(5)
  ds_read_b64 v[136:137], v160 offset:4416
  ds_read_b64 v[138:139], v160 offset:4424
  ds_read_b128 v[180:183], v163 offset:512
  ds_read_b64 v[144:145], v160 offset:88
  buffer_load_dwordx4 v[48:51], v14, s[8:11], s26 offen offset:0
  v_accvgpr_read_b32 v236, a0
  v_accvgpr_read_b32 v237, a16
  v_accvgpr_read_b32 v238, a32
  v_accvgpr_read_b32 v239, a48
  v_accvgpr_read_b32 v240, a64
  v_smfmac_f32_16x16x64_bf16 v[192:195], v[172:175], v[120:127], v166
  ds_read_b64 v[146:147], v160 offset:96
  ds_read_b64 v[148:149], v160 offset:824
  ds_read_b64 v[150:151], v160 offset:832
  ds_read_b128 v[184:187], v164 offset:512
  v_accvgpr_read_b32 v241, a80
  v_accvgpr_read_b32 v242, a96
  v_accvgpr_read_b32 v243, a112
  v_accvgpr_read_b32 v244, a128
  v_accvgpr_read_b32 v245, a144
  v_smfmac_f32_16x16x64_bf16 v[196:199], v[168:171], v[120:127], v166
  s_waitcnt lgkmcnt(8)
  ds_read_b64 v[152:153], v160 offset:1560
  ds_read_b64 v[154:155], v160 offset:1568
  ds_read_b64 v[156:157], v160 offset:2296
  ds_read_b64 v[158:159], v160 offset:2304
  buffer_load_dwordx4 v[52:55], v14, s[8:11], s26 offen offset:768
  s_waitcnt vmcnt(17)
  v_dot2c_f32_bf16 v236, s33, v16
  v_dot2c_f32_bf16 v237, s34, v16
  v_dot2c_f32_bf16 v238, s33, v17
  v_dot2c_f32_bf16 v239, s34, v17
  v_dot2c_f32_bf16 v240, s33, v18
  v_smfmac_f32_16x16x64_bf16 v[192:195], v[176:179], v[128:135], v166
  ds_read_b128 v[188:191], v165 offset:512
  ds_read_b64 v[112:113], v160 offset:3032
  ds_read_b64 v[114:115], v160 offset:3040
  v_dot2c_f32_bf16 v241, s34, v18
  v_dot2c_f32_bf16 v242, s33, v19
  v_dot2c_f32_bf16 v243, s34, v19
  v_dot2c_f32_bf16 v244, s33, v80
  v_dot2c_f32_bf16 v245, s34, v80
  v_mfma_f32_16x16x32_bf16 v[200:203], v[224:227], v[224:227], 0
  v_smfmac_f32_16x16x64_bf16 v[196:199], v[172:175], v[128:135], v166
  s_waitcnt lgkmcnt(13)
  ds_read_b64 v[116:117], v160 offset:3768
  ds_read_b64 v[118:119], v160 offset:3776
  buffer_load_dwordx4 v[56:59], v14, s[8:11], s26 offen offset:1536
  v_cvt_pk_bf16_f32 v16, v236, v237
  v_cvt_pk_bf16_f32 v17, v238, v239
  v_cvt_pk_bf16_f32 v18, v240, v241
  v_cvt_pk_bf16_f32 v19, v242, v243
  v_cvt_pk_bf16_f32 v80, v244, v245
  v_mfma_f32_16x16x32_bf16 v[204:207], v[224:227], v[224:227], 0
  v_smfmac_f32_16x16x64_bf16 v[196:199], v[176:179], v[136:143], v166
  s_waitcnt lgkmcnt(10)
  ds_read_b64 v[120:121], v160 offset:4504
  ds_read_b64 v[122:123], v160 offset:4512
  ds_read_b128 v[168:171], v163 offset:1024
  ds_read_b64 v[128:129], v160 offset:176
  buffer_store_dwordx4 v[16:19], v14, s[12:15], s24 offen offset:0
  buffer_store_dwordx2 v[80:81], v15, s[12:15], s24 offen offset:0
  v_smfmac_f32_16x16x64_bf16 v[200:203], v[180:183], v[144:151], v166
  s_waitcnt lgkmcnt(9)
  ds_read_b64 v[130:131], v160 offset:184
  ds_read_b64 v[132:133], v160 offset:912
  ds_read_b64 v[134:135], v160 offset:920
  ds_read_b128 v[172:175], v164 offset:1024
  buffer_load_dwordx4 v[60:63], v14, s[8:11], s26 offen offset:2304
  v_accvgpr_read_b32 v246, a1
  v_accvgpr_read_b32 v247, a17
  v_accvgpr_read_b32 v248, a33
  v_accvgpr_read_b32 v249, a49
  v_accvgpr_read_b32 v250, a65
  v_cvt_pk_bf16_f32 v208, v192, v193
  v_cvt_pk_bf16_f32 v212, v194, v195
  v_smfmac_f32_16x16x64_bf16 v[200:203], v[184:187], v[152:159], v166
  ds_read_b64 v[136:137], v160 offset:1648
  ds_read_b64 v[138:139], v160 offset:1656
  v_accvgpr_read_b32 v251, a81
  v_accvgpr_read_b32 v252, a97
  v_accvgpr_read_b32 v253, a113
  v_accvgpr_read_b32 v254, a129
  v_accvgpr_read_b32 v255, a145
  v_smfmac_f32_16x16x64_bf16 v[204:207], v[180:183], v[152:159], v166
  s_waitcnt lgkmcnt(10)
  ds_read_b64 v[140:141], v160 offset:2384
  ds_read_b64 v[142:143], v160 offset:2392
  ds_read_b128 v[176:179], v165 offset:1024
  ds_read_b64 v[144:145], v160 offset:3120
  v_add_u32 v228, 0, v10
  buffer_load_dwordx4 a[192:195], v2, s[8:11], 0 offen offset:256
  s_waitcnt vmcnt(21)
  v_dot2c_f32_bf16 v246, s33, v20
  v_dot2c_f32_bf16 v247, s34, v20
  v_dot2c_f32_bf16 v248, s33, v21
  v_dot2c_f32_bf16 v249, s34, v21
  v_dot2c_f32_bf16 v250, s33, v22
  v_cvt_pk_bf16_f32 v216, v196, v197
  v_cvt_pk_bf16_f32 v220, v198, v199
  v_smfmac_f32_16x16x64_bf16 v[200:203], v[188:191], v[112:119], v166
  ds_read_b64 v[146:147], v160 offset:3128
  ds_write2_b32 v228, a224, a228 offset0:0 offset1:11
  v_dot2c_f32_bf16 v251, s34, v22
  v_dot2c_f32_bf16 v252, s33, v23
  v_dot2c_f32_bf16 v253, s34, v23
  v_dot2c_f32_bf16 v254, s33, v82
  v_dot2c_f32_bf16 v255, s34, v82
  v_mfma_f32_16x16x32_bf16 v[192:195], v[224:227], v[224:227], 0
  v_smfmac_f32_16x16x64_bf16 v[204:207], v[184:187], v[112:119], v166
  s_waitcnt lgkmcnt(14)
  ds_read_b64 v[148:149], v160 offset:3856
  ds_write2_b32 v228, a225, a229 offset0:22 offset1:33
  buffer_load_dwordx4 a[196:199], v6, s[8:11], 0 offen offset:256
  v_cvt_pk_bf16_f32 v20, v246, v247
  v_cvt_pk_bf16_f32 v21, v248, v249
  v_cvt_pk_bf16_f32 v22, v250, v251
  v_cvt_pk_bf16_f32 v23, v252, v253
  v_cvt_pk_bf16_f32 v82, v254, v255
  v_mfma_f32_16x16x32_bf16 v[196:199], v[224:227], v[224:227], 0
  v_smfmac_f32_16x16x64_bf16 v[204:207], v[188:191], v[120:127], v166
  s_waitcnt lgkmcnt(11)
  ds_read_b64 v[150:151], v160 offset:3864
  ds_read_b64 v[152:153], v160 offset:4592
  ds_read_b64 v[154:155], v160 offset:4600
  ds_read_b128 v[180:183], v163 offset:1536
  ds_write2_b32 v228, a226, a230 offset0:44 offset1:55
  buffer_store_dwordx4 v[20:23], v14, s[12:15], s24 offen offset:768
  buffer_store_dwordx2 v[82:83], v15, s[12:15], s24 offen offset:768
  v_smfmac_f32_16x16x64_bf16 v[192:195], v[168:171], v[128:135], v166
  s_waitcnt lgkmcnt(11)
  ds_read_b64 v[112:113], v160 offset:264
  ds_read_b64 v[114:115], v160 offset:272
  ds_read_b64 v[116:117], v160 offset:1000
  ds_read_b64 v[118:119], v160 offset:1008
  ds_write2_b32 v228, a227, a231 offset0:66 offset1:77
  v_add_u32 v229, 0, v11
  buffer_load_dwordx4 a[200:203], v3, s[8:11], 0 offen offset:256
  v_accvgpr_read_b32 v236, a2
  v_accvgpr_read_b32 v237, a18
  v_accvgpr_read_b32 v238, a34
  v_accvgpr_read_b32 v239, a50
  v_accvgpr_read_b32 v240, a66
  v_cvt_pk_bf16_f32 v209, v200, v201
  v_cvt_pk_bf16_f32 v213, v202, v203
  v_smfmac_f32_16x16x64_bf16 v[192:195], v[172:175], v[136:143], v166
  ds_write2_b32 v229, a232, a236 offset0:0 offset1:11
  v_accvgpr_read_b32 v241, a82
  v_accvgpr_read_b32 v242, a98
  v_accvgpr_read_b32 v243, a114
  v_accvgpr_read_b32 v244, a130
  v_accvgpr_read_b32 v245, a146
  v_smfmac_f32_16x16x64_bf16 v[196:199], v[168:171], v[136:143], v166
  s_waitcnt lgkmcnt(10)
  ds_read_b128 v[184:187], v164 offset:1536
  ds_read_b64 v[120:121], v160 offset:1736
  ds_read_b64 v[122:123], v160 offset:1744
  ds_read_b64 v[124:125], v160 offset:2472
  ds_write2_b32 v229, a233, a237 offset0:22 offset1:33
  buffer_load_dwordx4 a[204:207], v7, s[8:11], 0 offen offset:256
  s_waitcnt vmcnt(25)
  v_dot2c_f32_bf16 v236, s33, v24
  v_dot2c_f32_bf16 v237, s34, v24
  v_dot2c_f32_bf16 v238, s33, v25
  v_dot2c_f32_bf16 v239, s34, v25
  v_dot2c_f32_bf16 v240, s33, v26
  v_cvt_pk_bf16_f32 v217, v204, v205
  v_cvt_pk_bf16_f32 v221, v206, v207
  v_smfmac_f32_16x16x64_bf16 v[192:195], v[176:179], v[144:151], v166
  ds_write2_b32 v229, a234, a238 offset0:44 offset1:55
  v_dot2c_f32_bf16 v241, s34, v26
  v_dot2c_f32_bf16 v242, s33, v27
  v_dot2c_f32_bf16 v243, s34, v27
  v_dot2c_f32_bf16 v244, s33, v84
  v_dot2c_f32_bf16 v245, s34, v84
  v_mfma_f32_16x16x32_bf16 v[200:203], v[224:227], v[224:227], 0
  v_smfmac_f32_16x16x64_bf16 v[196:199], v[172:175], v[144:151], v166
  s_waitcnt lgkmcnt(14)
  ds_read_b64 v[126:127], v160 offset:2480
  ds_write2_b32 v229, a235, a239 offset0:66 offset1:77
  v_add_u32 v228, 0, v12
  buffer_load_dwordx4 a[208:211], v4, s[8:11], 0 offen offset:256
  v_cvt_pk_bf16_f32 v24, v236, v237
  v_cvt_pk_bf16_f32 v25, v238, v239
  v_cvt_pk_bf16_f32 v26, v240, v241
  v_cvt_pk_bf16_f32 v27, v242, v243
  v_cvt_pk_bf16_f32 v84, v244, v245
  v_mfma_f32_16x16x32_bf16 v[204:207], v[224:227], v[224:227], 0
  v_smfmac_f32_16x16x64_bf16 v[196:199], v[176:179], v[152:159], v166
  s_waitcnt lgkmcnt(10)
  ds_read_b128 v[188:191], v165 offset:1536
  ds_read_b64 v[128:129], v160 offset:3208
  ds_read_b64 v[130:131], v160 offset:3216
  ds_read_b64 v[132:133], v160 offset:3944
  ds_write2_b32 v228, a240, a244 offset0:0 offset1:11
  buffer_store_dwordx4 v[24:27], v14, s[12:15], s24 offen offset:1536
  buffer_store_dwordx2 v[84:85], v15, s[12:15], s24 offen offset:1536
  v_smfmac_f32_16x16x64_bf16 v[200:203], v[180:183], v[112:119], v166
  s_waitcnt lgkmcnt(6)
  ds_read_b64 v[134:135], v160 offset:3952
  ds_read_b64 v[136:137], v160 offset:4680
  ds_read_b64 v[138:139], v160 offset:4688
  ds_read_b128 v[168:171], v163 offset:8192
  ds_write2_b32 v228, a241, a245 offset0:22 offset1:33
  buffer_load_dwordx4 a[212:215], v8, s[8:11], 0 offen offset:256
  v_accvgpr_read_b32 v246, a3
  v_accvgpr_read_b32 v247, a19
  v_accvgpr_read_b32 v248, a35
  v_accvgpr_read_b32 v249, a51
  v_accvgpr_read_b32 v250, a67
  v_cvt_pk_bf16_f32 v210, v192, v193
  v_cvt_pk_bf16_f32 v214, v194, v195
  v_smfmac_f32_16x16x64_bf16 v[200:203], v[184:187], v[120:127], v166
  ds_read_b64 v[144:145], v161 offset:0
  ds_read_b64 v[146:147], v161 offset:8
  ds_read_b64 v[148:149], v161 offset:736
  ds_read_b64 v[150:151], v161 offset:744
  ds_write2_b32 v228, a242, a246 offset0:44 offset1:55
  v_accvgpr_read_b32 v251, a83
  v_accvgpr_read_b32 v252, a99
  v_accvgpr_read_b32 v253, a115
  v_accvgpr_read_b32 v254, a131
  v_accvgpr_read_b32 v255, a147
  v_smfmac_f32_16x16x64_bf16 v[204:207], v[180:183], v[120:127], v166
  s_waitcnt lgkmcnt(9)
  ds_read_b128 v[172:175], v164 offset:8192
  ds_read_b64 v[152:153], v161 offset:1472
  ds_read_b64 v[154:155], v161 offset:1480
  ds_read_b64 v[156:157], v161 offset:2208
  ds_write2_b32 v228, a243, a247 offset0:66 offset1:77
  v_add_u32 v229, 0, v13
  buffer_load_dwordx4 a[216:219], v5, s[8:11], 0 offen offset:256
  s_waitcnt vmcnt(29)
  v_dot2c_f32_bf16 v246, s33, v28
  v_dot2c_f32_bf16 v247, s34, v28
  v_dot2c_f32_bf16 v248, s33, v29
  v_dot2c_f32_bf16 v249, s34, v29
  v_dot2c_f32_bf16 v250, s33, v30
  v_cvt_pk_bf16_f32 v218, v196, v197
  v_cvt_pk_bf16_f32 v222, v198, v199
  v_smfmac_f32_16x16x64_bf16 v[200:203], v[188:191], v[128:135], v166
  ds_read_b64 v[158:159], v161 offset:2216
  s_mov_b64 exec, s[38:39]
  ds_write2_b32 v229, a248, a252 offset0:0 offset1:11
  s_mov_b64 exec, -1
  v_dot2c_f32_bf16 v251, s34, v30
  v_dot2c_f32_bf16 v252, s33, v31
  v_dot2c_f32_bf16 v253, s34, v31
  v_dot2c_f32_bf16 v254, s33, v86
  v_dot2c_f32_bf16 v255, s34, v86
  v_mfma_f32_16x16x32_bf16 v[192:195], v[224:227], v[224:227], 0
  v_smfmac_f32_16x16x64_bf16 v[204:207], v[184:187], v[128:135], v166
  s_waitcnt lgkmcnt(14)
  ds_read_b128 v[176:179], v165 offset:8192
  s_mov_b64 exec, s[38:39]
  ds_write2_b32 v229, a249, a253 offset0:22 offset1:33
  s_mov_b64 exec, -1
  buffer_load_dwordx4 a[220:223], v9, s[8:11], 0 offen offset:256
  v_cvt_pk_bf16_f32 v28, v246, v247
  v_cvt_pk_bf16_f32 v29, v248, v249
  v_cvt_pk_bf16_f32 v30, v250, v251
  v_cvt_pk_bf16_f32 v31, v252, v253
  v_cvt_pk_bf16_f32 v86, v254, v255
  v_mfma_f32_16x16x32_bf16 v[196:199], v[224:227], v[224:227], 0
  v_smfmac_f32_16x16x64_bf16 v[204:207], v[188:191], v[136:143], v166
  s_waitcnt lgkmcnt(10)
  ds_read_b64 v[112:113], v161 offset:2944
  ds_read_b64 v[114:115], v161 offset:2952
  ds_read_b64 v[116:117], v161 offset:3680
  ds_read_b64 v[118:119], v161 offset:3688
  s_mov_b64 exec, s[38:39]
  ds_write2_b32 v229, a250, a254 offset0:44 offset1:55
  s_mov_b64 exec, -1
  buffer_store_dwordx4 v[28:31], v14, s[12:15], s24 offen offset:2304
  buffer_store_dwordx2 v[86:87], v15, s[12:15], s24 offen offset:2304
  v_smfmac_f32_16x16x64_bf16 v[192:195], v[168:171], v[144:151], v166
  s_waitcnt lgkmcnt(8)
  ds_read_b64 v[120:121], v161 offset:4416
  ds_read_b64 v[122:123], v161 offset:4424
  ds_read_b128 v[180:183], v163 offset:8704
  ds_read_b64 v[128:129], v161 offset:88
  s_mov_b64 exec, s[38:39]
  ds_write2_b32 v229, a251, a255 offset0:66 offset1:77
  s_mov_b64 exec, -1
  buffer_load_dwordx4 v[64:67], v14, s[8:11], s27 offen offset:0
  v_accvgpr_read_b32 v236, a4
  v_accvgpr_read_b32 v237, a20
  v_accvgpr_read_b32 v238, a36
  v_accvgpr_read_b32 v239, a52
  v_accvgpr_read_b32 v240, a68
  v_cvt_pk_bf16_f32 v211, v200, v201
  v_cvt_pk_bf16_f32 v215, v202, v203
  v_smfmac_f32_16x16x64_bf16 v[192:195], v[172:175], v[152:159], v166
  ds_read_b64 v[130:131], v161 offset:96
  ds_read_b64 v[132:133], v161 offset:824
  v_accvgpr_read_b32 v241, a84
  v_accvgpr_read_b32 v242, a100
  v_accvgpr_read_b32 v243, a116
  v_accvgpr_read_b32 v244, a132
  v_accvgpr_read_b32 v245, a148
  v_smfmac_f32_16x16x64_bf16 v[196:199], v[168:171], v[152:159], v166
  s_waitcnt lgkmcnt(8)
  ds_read_b64 v[134:135], v161 offset:832
  ds_read_b128 v[184:187], v164 offset:8704
  ds_read_b64 v[136:137], v161 offset:1560
  ds_read_b64 v[138:139], v161 offset:1568
  buffer_load_dwordx4 v[68:71], v14, s[8:11], s27 offen offset:768
  s_waitcnt vmcnt(33)
  v_dot2c_f32_bf16 v236, s33, v32
  v_dot2c_f32_bf16 v237, s34, v32
  v_dot2c_f32_bf16 v238, s33, v33
  v_dot2c_f32_bf16 v239, s34, v33
  v_dot2c_f32_bf16 v240, s33, v34
  v_cvt_pk_bf16_f32 v219, v204, v205
  v_cvt_pk_bf16_f32 v223, v206, v207
  v_smfmac_f32_16x16x64_bf16 v[192:195], v[176:179], v[112:119], v166
  ds_read_b64 v[140:141], v161 offset:2296
  ds_read_b64 v[142:143], v161 offset:2304
  ds_read_b128 v[188:191], v165 offset:8704
  ds_write_b128 v167, v[208:211] offset:0
  v_dot2c_f32_bf16 v241, s34, v34
  v_dot2c_f32_bf16 v242, s33, v35
  v_dot2c_f32_bf16 v243, s34, v35
  v_dot2c_f32_bf16 v244, s33, v88
  v_dot2c_f32_bf16 v245, s34, v88
  v_mfma_f32_16x16x32_bf16 v[200:203], v[224:227], v[224:227], 0
  v_smfmac_f32_16x16x64_bf16 v[196:199], v[172:175], v[112:119], v166
  s_waitcnt lgkmcnt(13)
  ds_read_b64 v[144:145], v161 offset:3032
  ds_read_b64 v[146:147], v161 offset:3040
  ds_write_b128 v167, v[212:215] offset:1024
  buffer_load_dwordx4 v[72:75], v14, s[8:11], s27 offen offset:1536
  v_cvt_pk_bf16_f32 v32, v236, v237
  v_cvt_pk_bf16_f32 v33, v238, v239
  v_cvt_pk_bf16_f32 v34, v240, v241
  v_cvt_pk_bf16_f32 v35, v242, v243
  v_cvt_pk_bf16_f32 v88, v244, v245
  v_mfma_f32_16x16x32_bf16 v[204:207], v[224:227], v[224:227], 0
  v_smfmac_f32_16x16x64_bf16 v[196:199], v[176:179], v[120:127], v166
  s_waitcnt lgkmcnt(10)
  ds_read_b64 v[148:149], v161 offset:3768
  ds_read_b64 v[150:151], v161 offset:3776
  ds_read_b64 v[152:153], v161 offset:4504
  ds_read_b64 v[154:155], v161 offset:4512
  ds_write_b128 v167, v[216:219] offset:2048
  buffer_store_dwordx4 v[32:35], v14, s[12:15], s25 offen offset:0
  buffer_store_dwordx2 v[88:89], v15, s[12:15], s25 offen offset:0
  v_smfmac_f32_16x16x64_bf16 v[200:203], v[180:183], v[128:135], v166
  s_waitcnt lgkmcnt(10)
  ds_read_b128 v[168:171], v163 offset:9216
  ds_read_b64 v[112:113], v161 offset:176
  ds_read_b64 v[114:115], v161 offset:184
  ds_read_b64 v[116:117], v161 offset:912
  ds_write_b128 v167, v[220:223] offset:3072
  buffer_load_dwordx4 v[76:79], v14, s[8:11], s27 offen offset:2304
  v_accvgpr_read_b32 v246, a5
  v_accvgpr_read_b32 v247, a21
  v_accvgpr_read_b32 v248, a37
  v_accvgpr_read_b32 v249, a53
  v_accvgpr_read_b32 v250, a69
  v_cvt_pk_bf16_f32 v208, v192, v193
  v_cvt_pk_bf16_f32 v212, v194, v195
  v_smfmac_f32_16x16x64_bf16 v[200:203], v[184:187], v[136:143], v166
  v_accvgpr_read_b32 v251, a85
  v_accvgpr_read_b32 v252, a101
  v_accvgpr_read_b32 v253, a117
  v_accvgpr_read_b32 v254, a133
  v_accvgpr_read_b32 v255, a149
  v_smfmac_f32_16x16x64_bf16 v[204:207], v[180:183], v[136:143], v166
  s_waitcnt lgkmcnt(8)
  ds_read_b64 v[118:119], v161 offset:920
  ds_read_b128 v[172:175], v164 offset:9216
  ds_read_b64 v[120:121], v161 offset:1648
  ds_read_b64 v[122:123], v161 offset:1656
  s_waitcnt lgkmcnt(4)
  s_barrier
  ds_read_b128 v[16:19], v0 offset:0
  ds_read_b128 v[20:23], v0 offset:256
  ds_read_b128 v[24:27], v0 offset:512
  ds_read_b128 v[28:31], v0 offset:768
  v_add_u32 v228, 98304, v10
  buffer_load_dwordx4 a[0:3], v2, s[8:11], 0 offen offset:320
  s_waitcnt vmcnt(37)
  v_dot2c_f32_bf16 v246, s33, v36
  v_dot2c_f32_bf16 v247, s34, v36
  v_dot2c_f32_bf16 v248, s33, v37
  v_dot2c_f32_bf16 v249, s34, v37
  v_dot2c_f32_bf16 v250, s33, v38
  v_cvt_pk_bf16_f32 v216, v196, v197
  v_cvt_pk_bf16_f32 v220, v198, v199
  v_smfmac_f32_16x16x64_bf16 v[200:203], v[188:191], v[144:151], v166
  ds_read_b64 v[124:125], v161 offset:2384
  ds_read_b64 v[126:127], v161 offset:2392
  ds_read_b128 v[176:179], v165 offset:9216
  ds_read_b64 v[128:129], v161 offset:3120
  s_waitcnt vmcnt(33)
  ds_write2_b32 v228, a160, a164 offset0:0 offset1:11
  v_dot2c_f32_bf16 v251, s34, v38
  v_dot2c_f32_bf16 v252, s33, v39
  v_dot2c_f32_bf16 v253, s34, v39
  v_dot2c_f32_bf16 v254, s33, v90
  v_dot2c_f32_bf16 v255, s34, v90
  v_mfma_f32_16x16x32_bf16 v[192:195], v[224:227], v[224:227], 0
  v_smfmac_f32_16x16x64_bf16 v[204:207], v[184:187], v[144:151], v166
  ds_read_b64 v[130:131], v161 offset:3128
  ds_read_b64 v[132:133], v161 offset:3856
  ds_write2_b32 v228, a161, a165 offset0:22 offset1:33
  buffer_load_dwordx4 a[16:19], v6, s[8:11], 0 offen offset:320
  v_cvt_pk_bf16_f32 v36, v246, v247
  v_cvt_pk_bf16_f32 v37, v248, v249
  v_cvt_pk_bf16_f32 v38, v250, v251
  v_cvt_pk_bf16_f32 v39, v252, v253
  v_cvt_pk_bf16_f32 v90, v254, v255
  v_mfma_f32_16x16x32_bf16 v[196:199], v[224:227], v[224:227], 0
  v_smfmac_f32_16x16x64_bf16 v[204:207], v[188:191], v[152:159], v166
  s_waitcnt lgkmcnt(15)
  ds_write2_b32 v228, a162, a166 offset0:44 offset1:55
  buffer_store_dwordx4 v[36:39], v14, s[12:15], s25 offen offset:768
  buffer_store_dwordx2 v[90:91], v15, s[12:15], s25 offen offset:768
  v_smfmac_f32_16x16x64_bf16 v[192:195], v[168:171], v[112:119], v166
  s_waitcnt lgkmcnt(7)
  ds_read_b64 v[134:135], v161 offset:3864
  ds_read_b64 v[136:137], v161 offset:4592
  ds_read_b64 v[138:139], v161 offset:4600
  ds_read_b128 v[180:183], v163 offset:9728
  ds_write2_b32 v228, a163, a167 offset0:66 offset1:77
  v_add_u32 v229, 98304, v11
  buffer_load_dwordx4 a[32:35], v3, s[8:11], 0 offen offset:320
  v_accvgpr_read_b32 v236, a6
  v_accvgpr_read_b32 v237, a22
  v_accvgpr_read_b32 v238, a38
  v_accvgpr_read_b32 v239, a54
  v_accvgpr_read_b32 v240, a70
  v_cvt_pk_bf16_f32 v209, v200, v201
  v_cvt_pk_bf16_f32 v213, v202, v203
  v_smfmac_f32_16x16x64_bf16 v[192:195], v[172:175], v[120:127], v166
  ds_read_b64 v[144:145], v161 offset:264
  ds_read_b64 v[146:147], v161 offset:272
  ds_read_b64 v[148:149], v161 offset:1000
  s_waitcnt vmcnt(35)
  ds_write2_b32 v229, a168, a172 offset0:0 offset1:11
  v_accvgpr_read_b32 v241, a86
  v_accvgpr_read_b32 v242, a102
  v_accvgpr_read_b32 v243, a118
  v_accvgpr_read_b32 v244, a134
  v_accvgpr_read_b32 v245, a150
  v_smfmac_f32_16x16x64_bf16 v[196:199], v[168:171], v[120:127], v166
  s_waitcnt lgkmcnt(8)
  ds_read_b64 v[150:151], v161 offset:1008
  ds_read_b128 v[184:187], v164 offset:9728
  ds_read_b64 v[152:153], v161 offset:1736
  ds_read_b64 v[154:155], v161 offset:1744
  ds_write2_b32 v229, a169, a173 offset0:22 offset1:33
  buffer_load_dwordx4 a[48:51], v7, s[8:11], 0 offen offset:320
  v_dot2c_f32_bf16 v236, s33, v40
  v_dot2c_f32_bf16 v237, s34, v40
  v_dot2c_f32_bf16 v238, s33, v41
  v_dot2c_f32_bf16 v239, s34, v41
  v_dot2c_f32_bf16 v240, s33, v42
  v_cvt_pk_bf16_f32 v217, v204, v205
  v_cvt_pk_bf16_f32 v221, v206, v207
  v_smfmac_f32_16x16x64_bf16 v[192:195], v[176:179], v[128:135], v166
  ds_read_b64 v[156:157], v161 offset:2472
  ds_read_b64 v[158:159], v161 offset:2480
  ds_write2_b32 v229, a170, a174 offset0:44 offset1:55
  v_dot2c_f32_bf16 v241, s34, v42
  v_dot2c_f32_bf16 v242, s33, v43
  v_dot2c_f32_bf16 v243, s34, v43
  v_dot2c_f32_bf16 v244, s33, v92
  v_dot2c_f32_bf16 v245, s34, v92
  v_mfma_f32_16x16x32_bf16 v[200:203], v[224:227], v[224:227], 0
  v_smfmac_f32_16x16x64_bf16 v[196:199], v[172:175], v[128:135], v166
  s_waitcnt lgkmcnt(14)
  ds_read_b128 v[188:191], v165 offset:9728
  ds_write2_b32 v229, a171, a175 offset0:66 offset1:77
  v_add_u32 v228, 98304, v12
  buffer_load_dwordx4 a[64:67], v4, s[8:11], 0 offen offset:320
  v_cvt_pk_bf16_f32 v40, v236, v237
  v_cvt_pk_bf16_f32 v41, v238, v239
  v_cvt_pk_bf16_f32 v42, v240, v241
  v_cvt_pk_bf16_f32 v43, v242, v243
  v_cvt_pk_bf16_f32 v92, v244, v245
  v_mfma_f32_16x16x32_bf16 v[204:207], v[224:227], v[224:227], 0
  v_smfmac_f32_16x16x64_bf16 v[196:199], v[176:179], v[136:143], v166
  s_waitcnt lgkmcnt(9)
  ds_read_b64 v[112:113], v161 offset:3208
  ds_read_b64 v[114:115], v161 offset:3216
  ds_read_b64 v[116:117], v161 offset:3944
  ds_read_b64 v[118:119], v161 offset:3952
  s_waitcnt vmcnt(35)
  ds_write2_b32 v228, a176, a180 offset0:0 offset1:11
  buffer_store_dwordx4 v[40:43], v14, s[12:15], s25 offen offset:1536
  buffer_store_dwordx2 v[92:93], v15, s[12:15], s25 offen offset:1536
  v_smfmac_f32_16x16x64_bf16 v[200:203], v[180:183], v[144:151], v166
  s_waitcnt lgkmcnt(8)
  ds_read_b64 v[120:121], v161 offset:4680
  ds_read_b64 v[122:123], v161 offset:4688
  ds_read_b128 v[168:171], v163 offset:16384
  ds_read_b64 v[128:129], v162 offset:0
  ds_write2_b32 v228, a177, a181 offset0:22 offset1:33
  s_barrier
  buffer_load_dwordx4 a[80:83], v8, s[8:11], 0 offen offset:320
  v_accvgpr_read_b32 v246, a7
  v_accvgpr_read_b32 v247, a23
  v_accvgpr_read_b32 v248, a39
  v_accvgpr_read_b32 v249, a55
  v_accvgpr_read_b32 v250, a71
  v_cvt_pk_bf16_f32 v210, v192, v193
  v_cvt_pk_bf16_f32 v214, v194, v195
  v_smfmac_f32_16x16x64_bf16 v[200:203], v[184:187], v[152:159], v166
  ds_read_b64 v[130:131], v162 offset:8
  ds_read_b64 v[132:133], v162 offset:736
  ds_write2_b32 v228, a178, a182 offset0:44 offset1:55
  v_accvgpr_read_b32 v251, a87
  v_accvgpr_read_b32 v252, a103
  v_accvgpr_read_b32 v253, a119
  v_accvgpr_read_b32 v254, a135
  v_accvgpr_read_b32 v255, a151
  v_smfmac_f32_16x16x64_bf16 v[204:207], v[180:183], v[152:159], v166
  s_waitcnt lgkmcnt(9)
  ds_read_b64 v[134:135], v162 offset:744
  ds_read_b128 v[172:175], v164 offset:16384
  ds_read_b64 v[136:137], v162 offset:1472
  ds_read_b64 v[138:139], v162 offset:1480
  ds_write2_b32 v228, a179, a183 offset0:66 offset1:77
  v_add_u32 v229, 98304, v13
  buffer_load_dwordx4 a[96:99], v5, s[8:11], 0 offen offset:320
  v_dot2c_f32_bf16 v246, s33, v44
  v_dot2c_f32_bf16 v247, s34, v44
  v_dot2c_f32_bf16 v248, s33, v45
  v_dot2c_f32_bf16 v249, s34, v45
  v_dot2c_f32_bf16 v250, s33, v46
  v_cvt_pk_bf16_f32 v218, v196, v197
  v_cvt_pk_bf16_f32 v222, v198, v199
  v_smfmac_f32_16x16x64_bf16 v[200:203], v[188:191], v[112:119], v166
  ds_read_b64 v[140:141], v162 offset:2208
  s_waitcnt vmcnt(37)
  s_mov_b64 exec, s[38:39]
  ds_write2_b32 v229, a184, a188 offset0:0 offset1:11
  s_mov_b64 exec, -1
  v_dot2c_f32_bf16 v251, s34, v46
  v_dot2c_f32_bf16 v252, s33, v47
  v_dot2c_f32_bf16 v253, s34, v47
  v_dot2c_f32_bf16 v254, s33, v94
  v_dot2c_f32_bf16 v255, s34, v94
  v_mfma_f32_16x16x32_bf16 v[192:195], v[224:227], v[224:227], 0
  v_smfmac_f32_16x16x64_bf16 v[204:207], v[184:187], v[112:119], v166
  s_waitcnt lgkmcnt(13)
  ds_read_b64 v[142:143], v162 offset:2216
  ds_read_b128 v[176:179], v165 offset:16384
  s_mov_b64 exec, s[38:39]
  ds_write2_b32 v229, a185, a189 offset0:22 offset1:33
  s_mov_b64 exec, -1
  buffer_load_dwordx4 a[112:115], v9, s[8:11], 0 offen offset:320
  v_cvt_pk_bf16_f32 v44, v246, v247
  v_cvt_pk_bf16_f32 v45, v248, v249
  v_cvt_pk_bf16_f32 v46, v250, v251
  v_cvt_pk_bf16_f32 v47, v252, v253
  v_cvt_pk_bf16_f32 v94, v254, v255
  v_mfma_f32_16x16x32_bf16 v[196:199], v[224:227], v[224:227], 0
  v_smfmac_f32_16x16x64_bf16 v[204:207], v[188:191], v[120:127], v166
  s_waitcnt lgkmcnt(9)
  ds_read_b64 v[144:145], v162 offset:2944
  ds_read_b64 v[146:147], v162 offset:2952
  ds_read_b64 v[148:149], v162 offset:3680
  ds_read_b64 v[150:151], v162 offset:3688
  s_mov_b64 exec, s[38:39]
  ds_write2_b32 v229, a186, a190 offset0:44 offset1:55
  s_mov_b64 exec, -1
  buffer_store_dwordx4 v[44:47], v14, s[12:15], s25 offen offset:2304
  buffer_store_dwordx2 v[94:95], v15, s[12:15], s25 offen offset:2304
  v_smfmac_f32_16x16x64_bf16 v[192:195], v[168:171], v[128:135], v166
  s_waitcnt lgkmcnt(7)
  ds_read_b64 v[152:153], v162 offset:4416
  ds_read_b64 v[154:155], v162 offset:4424
  ds_read_b128 v[180:183], v163 offset:16896
  ds_read_b64 v[112:113], v162 offset:88
  s_mov_b64 exec, s[38:39]
  ds_write2_b32 v229, a187, a191 offset0:66 offset1:77
  s_mov_b64 exec, -1
  v_accvgpr_read_b32 v236, a8
  v_accvgpr_read_b32 v237, a24
  v_accvgpr_read_b32 v238, a40
  v_accvgpr_read_b32 v239, a56
  v_accvgpr_read_b32 v240, a72
  v_cvt_pk_bf16_f32 v211, v200, v201
  v_cvt_pk_bf16_f32 v215, v202, v203
  v_smfmac_f32_16x16x64_bf16 v[192:195], v[172:175], v[136:143], v166
  ds_read_b64 v[114:115], v162 offset:96
  ds_read_b64 v[116:117], v162 offset:824
  ds_read_b64 v[118:119], v162 offset:832
  v_accvgpr_read_b32 v241, a88
  v_accvgpr_read_b32 v242, a104
  v_accvgpr_read_b32 v243, a120
  v_accvgpr_read_b32 v244, a136
  v_accvgpr_read_b32 v245, a152
  v_smfmac_f32_16x16x64_bf16 v[196:199], v[168:171], v[136:143], v166
  s_waitcnt lgkmcnt(9)
  ds_read_b128 v[184:187], v164 offset:16896
  ds_read_b64 v[120:121], v162 offset:1560
  ds_read_b64 v[122:123], v162 offset:1568
  ds_read_b64 v[124:125], v162 offset:2296
  s_waitcnt vmcnt(39)
  v_dot2c_f32_bf16 v236, s33, v48
  v_dot2c_f32_bf16 v237, s34, v48
  v_dot2c_f32_bf16 v238, s33, v49
  v_dot2c_f32_bf16 v239, s34, v49
  v_dot2c_f32_bf16 v240, s33, v50
  v_cvt_pk_bf16_f32 v219, v204, v205
  v_cvt_pk_bf16_f32 v223, v206, v207
  v_smfmac_f32_16x16x64_bf16 v[192:195], v[176:179], v[144:151], v166
  ds_read_b64 v[126:127], v162 offset:2304
  ds_read_b128 v[188:191], v165 offset:16896
  ds_write_b128 v167, v[208:211] offset:0
  v_dot2c_f32_bf16 v241, s34, v50
  v_dot2c_f32_bf16 v242, s33, v51
  v_dot2c_f32_bf16 v243, s34, v51
  v_dot2c_f32_bf16 v244, s33, v96
  v_dot2c_f32_bf16 v245, s34, v96
  v_mfma_f32_16x16x32_bf16 v[200:203], v[224:227], v[224:227], 0
  v_smfmac_f32_16x16x64_bf16 v[196:199], v[172:175], v[144:151], v166
  s_waitcnt lgkmcnt(13)
  ds_read_b64 v[128:129], v162 offset:3032
  ds_read_b64 v[130:131], v162 offset:3040
  ds_write_b128 v167, v[212:215] offset:1024
  v_cvt_pk_bf16_f32 v48, v236, v237
  v_cvt_pk_bf16_f32 v49, v238, v239
  v_cvt_pk_bf16_f32 v50, v240, v241
  v_cvt_pk_bf16_f32 v51, v242, v243
  v_cvt_pk_bf16_f32 v96, v244, v245
  v_mfma_f32_16x16x32_bf16 v[204:207], v[224:227], v[224:227], 0
  v_smfmac_f32_16x16x64_bf16 v[196:199], v[176:179], v[152:159], v166
  s_waitcnt lgkmcnt(10)
  ds_read_b64 v[132:133], v162 offset:3768
  ds_read_b64 v[134:135], v162 offset:3776
  ds_read_b64 v[136:137], v162 offset:4504
  ds_read_b64 v[138:139], v162 offset:4512
  ds_write_b128 v167, v[216:219] offset:2048
  buffer_store_dwordx4 v[48:51], v14, s[12:15], s26 offen offset:0
  buffer_store_dwordx2 v[96:97], v15, s[12:15], s26 offen offset:0
  v_smfmac_f32_16x16x64_bf16 v[200:203], v[180:183], v[112:119], v166
  s_waitcnt lgkmcnt(10)
  ds_read_b128 v[168:171], v163 offset:17408
  ds_read_b64 v[144:145], v162 offset:176
  ds_read_b64 v[146:147], v162 offset:184
  ds_read_b64 v[148:149], v162 offset:912
  ds_write_b128 v167, v[220:223] offset:3072
  v_accvgpr_read_b32 v246, a9
  v_accvgpr_read_b32 v247, a25
  v_accvgpr_read_b32 v248, a41
  v_accvgpr_read_b32 v249, a57
  v_accvgpr_read_b32 v250, a73
  v_cvt_pk_bf16_f32 v208, v192, v193
  v_cvt_pk_bf16_f32 v212, v194, v195
  v_smfmac_f32_16x16x64_bf16 v[200:203], v[184:187], v[120:127], v166
  v_accvgpr_read_b32 v251, a89
  v_accvgpr_read_b32 v252, a105
  v_accvgpr_read_b32 v253, a121
  v_accvgpr_read_b32 v254, a137
  v_accvgpr_read_b32 v255, a153
  v_smfmac_f32_16x16x64_bf16 v[204:207], v[180:183], v[120:127], v166
  s_waitcnt lgkmcnt(8)
  ds_read_b64 v[150:151], v162 offset:920
  ds_read_b128 v[172:175], v164 offset:17408
  ds_read_b64 v[152:153], v162 offset:1648
  ds_read_b64 v[154:155], v162 offset:1656
  s_waitcnt lgkmcnt(4)
  s_barrier
  ds_read_b128 v[32:35], v0 offset:0
  ds_read_b128 v[36:39], v0 offset:256
  ds_read_b128 v[40:43], v0 offset:512
  ds_read_b128 v[44:47], v0 offset:768
  v_add_u32 v228, 130688, v10
  s_waitcnt vmcnt(40)
  v_dot2c_f32_bf16 v246, s33, v52
  v_dot2c_f32_bf16 v247, s34, v52
  v_dot2c_f32_bf16 v248, s33, v53
  v_dot2c_f32_bf16 v249, s34, v53
  v_dot2c_f32_bf16 v250, s33, v54
  v_cvt_pk_bf16_f32 v216, v196, v197
  v_cvt_pk_bf16_f32 v220, v198, v199
  v_smfmac_f32_16x16x64_bf16 v[200:203], v[188:191], v[128:135], v166
  ds_read_b64 v[156:157], v162 offset:2384
  ds_read_b64 v[158:159], v162 offset:2392
  ds_read_b128 v[176:179], v165 offset:17408
  ds_read_b64 v[112:113], v162 offset:3120
  s_waitcnt vmcnt(34)
  ds_write2_b32 v228, a192, a196 offset0:0 offset1:11
  v_dot2c_f32_bf16 v251, s34, v54
  v_dot2c_f32_bf16 v252, s33, v55
  v_dot2c_f32_bf16 v253, s34, v55
  v_dot2c_f32_bf16 v254, s33, v98
  v_dot2c_f32_bf16 v255, s34, v98
  v_mfma_f32_16x16x32_bf16 v[192:195], v[224:227], v[224:227], 0
  v_smfmac_f32_16x16x64_bf16 v[204:207], v[184:187], v[128:135], v166
  ds_read_b64 v[114:115], v162 offset:3128
  ds_read_b64 v[116:117], v162 offset:3856
  ds_write2_b32 v228, a193, a197 offset0:22 offset1:33
  v_cvt_pk_bf16_f32 v52, v246, v247
  v_cvt_pk_bf16_f32 v53, v248, v249
  v_cvt_pk_bf16_f32 v54, v250, v251
  v_cvt_pk_bf16_f32 v55, v252, v253
  v_cvt_pk_bf16_f32 v98, v254, v255
  v_mfma_f32_16x16x32_bf16 v[196:199], v[224:227], v[224:227], 0
  v_smfmac_f32_16x16x64_bf16 v[204:207], v[188:191], v[136:143], v166
  s_waitcnt lgkmcnt(15)
  ds_write2_b32 v228, a194, a198 offset0:44 offset1:55
  buffer_store_dwordx4 v[52:55], v14, s[12:15], s26 offen offset:768
  buffer_store_dwordx2 v[98:99], v15, s[12:15], s26 offen offset:768
  v_smfmac_f32_16x16x64_bf16 v[192:195], v[168:171], v[144:151], v166
  s_waitcnt lgkmcnt(7)
  ds_read_b64 v[118:119], v162 offset:3864
  ds_read_b64 v[120:121], v162 offset:4592
  ds_read_b64 v[122:123], v162 offset:4600
  ds_read_b128 v[180:183], v163 offset:17920
  ds_write2_b32 v228, a195, a199 offset0:66 offset1:77
  v_add_u32 v229, 130688, v11
  v_accvgpr_read_b32 v236, a10
  v_accvgpr_read_b32 v237, a26
  v_accvgpr_read_b32 v238, a42
  v_accvgpr_read_b32 v239, a58
  v_accvgpr_read_b32 v240, a74
  v_cvt_pk_bf16_f32 v209, v200, v201
  v_cvt_pk_bf16_f32 v213, v202, v203
  v_smfmac_f32_16x16x64_bf16 v[192:195], v[172:175], v[152:159], v166
  ds_read_b64 v[128:129], v162 offset:264
  ds_read_b64 v[130:131], v162 offset:272
  ds_read_b64 v[132:133], v162 offset:1000
  s_waitcnt vmcnt(32)
  ds_write2_b32 v229, a200, a204 offset0:0 offset1:11
  v_accvgpr_read_b32 v241, a90
  v_accvgpr_read_b32 v242, a106
  v_accvgpr_read_b32 v243, a122
  v_accvgpr_read_b32 v244, a138
  v_accvgpr_read_b32 v245, a154
  v_smfmac_f32_16x16x64_bf16 v[196:199], v[168:171], v[152:159], v166
  s_waitcnt lgkmcnt(8)
  ds_read_b64 v[134:135], v162 offset:1008
  ds_read_b128 v[184:187], v164 offset:17920
  ds_read_b64 v[136:137], v162 offset:1736
  ds_read_b64 v[138:139], v162 offset:1744
  ds_write2_b32 v229, a201, a205 offset0:22 offset1:33
  v_dot2c_f32_bf16 v236, s33, v56
  v_dot2c_f32_bf16 v237, s34, v56
  v_dot2c_f32_bf16 v238, s33, v57
  v_dot2c_f32_bf16 v239, s34, v57
  v_dot2c_f32_bf16 v240, s33, v58
  v_cvt_pk_bf16_f32 v217, v204, v205
  v_cvt_pk_bf16_f32 v221, v206, v207
  v_smfmac_f32_16x16x64_bf16 v[192:195], v[176:179], v[112:119], v166
  ds_read_b64 v[140:141], v162 offset:2472
  ds_read_b64 v[142:143], v162 offset:2480
  ds_write2_b32 v229, a202, a206 offset0:44 offset1:55
  v_dot2c_f32_bf16 v241, s34, v58
  v_dot2c_f32_bf16 v242, s33, v59
  v_dot2c_f32_bf16 v243, s34, v59
  v_dot2c_f32_bf16 v244, s33, v100
  v_dot2c_f32_bf16 v245, s34, v100
  v_mfma_f32_16x16x32_bf16 v[200:203], v[224:227], v[224:227], 0
  v_smfmac_f32_16x16x64_bf16 v[196:199], v[172:175], v[112:119], v166
  s_waitcnt lgkmcnt(14)
  ds_read_b128 v[188:191], v165 offset:17920
  ds_write2_b32 v229, a203, a207 offset0:66 offset1:77
  v_add_u32 v228, 130688, v12
  v_cvt_pk_bf16_f32 v56, v236, v237
  v_cvt_pk_bf16_f32 v57, v238, v239
  v_cvt_pk_bf16_f32 v58, v240, v241
  v_cvt_pk_bf16_f32 v59, v242, v243
  v_cvt_pk_bf16_f32 v100, v244, v245
  v_mfma_f32_16x16x32_bf16 v[204:207], v[224:227], v[224:227], 0
  v_smfmac_f32_16x16x64_bf16 v[196:199], v[176:179], v[120:127], v166
  s_waitcnt lgkmcnt(9)
  ds_read_b64 v[144:145], v162 offset:3208
  ds_read_b64 v[146:147], v162 offset:3216
  ds_read_b64 v[148:149], v162 offset:3944
  ds_read_b64 v[150:151], v162 offset:3952
  s_waitcnt vmcnt(28)
  ds_write2_b32 v228, a208, a212 offset0:0 offset1:11
  buffer_store_dwordx4 v[56:59], v14, s[12:15], s26 offen offset:1536
  buffer_store_dwordx2 v[100:101], v15, s[12:15], s26 offen offset:1536
  v_smfmac_f32_16x16x64_bf16 v[200:203], v[180:183], v[128:135], v166
  s_waitcnt lgkmcnt(8)
  ds_read_b64 v[152:153], v162 offset:4680
  ds_read_b64 v[154:155], v162 offset:4688
  ds_read_b128 v[168:171], v163 offset:24576
  ds_read_b64 v[112:113], v160 offset:0
  ds_write2_b32 v228, a209, a213 offset0:22 offset1:33
  s_barrier
  v_accvgpr_read_b32 v246, a11
  v_accvgpr_read_b32 v247, a27
  v_accvgpr_read_b32 v248, a43
  v_accvgpr_read_b32 v249, a59
  v_accvgpr_read_b32 v250, a75
  v_cvt_pk_bf16_f32 v210, v192, v193
  v_cvt_pk_bf16_f32 v214, v194, v195
  v_smfmac_f32_16x16x64_bf16 v[200:203], v[184:187], v[136:143], v166
  ds_read_b64 v[114:115], v160 offset:8
  ds_read_b64 v[116:117], v160 offset:736
  ds_write2_b32 v228, a210, a214 offset0:44 offset1:55
  v_accvgpr_read_b32 v251, a91
  v_accvgpr_read_b32 v252, a107
  v_accvgpr_read_b32 v253, a123
  v_accvgpr_read_b32 v254, a139
  v_accvgpr_read_b32 v255, a155
  v_smfmac_f32_16x16x64_bf16 v[204:207], v[180:183], v[136:143], v166
  s_waitcnt lgkmcnt(9)
  ds_read_b64 v[118:119], v160 offset:744
  ds_read_b128 v[172:175], v164 offset:24576
  ds_read_b64 v[120:121], v160 offset:1472
  ds_read_b64 v[122:123], v160 offset:1480
  ds_write2_b32 v228, a211, a215 offset0:66 offset1:77
  v_add_u32 v229, 130688, v13
  v_dot2c_f32_bf16 v246, s33, v60
  v_dot2c_f32_bf16 v247, s34, v60
  v_dot2c_f32_bf16 v248, s33, v61
  v_dot2c_f32_bf16 v249, s34, v61
  v_dot2c_f32_bf16 v250, s33, v62
  v_cvt_pk_bf16_f32 v218, v196, v197
  v_cvt_pk_bf16_f32 v222, v198, v199
  v_smfmac_f32_16x16x64_bf16 v[200:203], v[188:191], v[144:151], v166
  ds_read_b64 v[124:125], v160 offset:2208
  s_waitcnt vmcnt(28)
  s_mov_b64 exec, s[38:39]
  ds_write2_b32 v229, a216, a220 offset0:0 offset1:11
  s_mov_b64 exec, -1
  v_dot2c_f32_bf16 v251, s34, v62
  v_dot2c_f32_bf16 v252, s33, v63
  v_dot2c_f32_bf16 v253, s34, v63
  v_dot2c_f32_bf16 v254, s33, v102
  v_dot2c_f32_bf16 v255, s34, v102
  v_mfma_f32_16x16x32_bf16 v[192:195], v[224:227], v[224:227], 0
  v_smfmac_f32_16x16x64_bf16 v[204:207], v[184:187], v[144:151], v166
  s_waitcnt lgkmcnt(13)
  ds_read_b64 v[126:127], v160 offset:2216
  ds_read_b128 v[176:179], v165 offset:24576
  s_mov_b64 exec, s[38:39]
  ds_write2_b32 v229, a217, a221 offset0:22 offset1:33
  s_mov_b64 exec, -1
  v_cvt_pk_bf16_f32 v60, v246, v247
  v_cvt_pk_bf16_f32 v61, v248, v249
  v_cvt_pk_bf16_f32 v62, v250, v251
  v_cvt_pk_bf16_f32 v63, v252, v253
  v_cvt_pk_bf16_f32 v102, v254, v255
  v_mfma_f32_16x16x32_bf16 v[196:199], v[224:227], v[224:227], 0
  v_smfmac_f32_16x16x64_bf16 v[204:207], v[188:191], v[152:159], v166
  s_waitcnt lgkmcnt(9)
  ds_read_b64 v[128:129], v160 offset:2944
  ds_read_b64 v[130:131], v160 offset:2952
  ds_read_b64 v[132:133], v160 offset:3680
  ds_read_b64 v[134:135], v160 offset:3688
  s_mov_b64 exec, s[38:39]
  ds_write2_b32 v229, a218, a222 offset0:44 offset1:55
  s_mov_b64 exec, -1
  buffer_store_dwordx4 v[60:63], v14, s[12:15], s26 offen offset:2304
  buffer_store_dwordx2 v[102:103], v15, s[12:15], s26 offen offset:2304
  v_smfmac_f32_16x16x64_bf16 v[192:195], v[168:171], v[112:119], v166
  s_waitcnt lgkmcnt(7)
  ds_read_b64 v[136:137], v160 offset:4416
  ds_read_b64 v[138:139], v160 offset:4424
  ds_read_b128 v[180:183], v163 offset:25088
  ds_read_b64 v[144:145], v160 offset:88
  s_mov_b64 exec, s[38:39]
  ds_write2_b32 v229, a219, a223 offset0:66 offset1:77
  s_mov_b64 exec, -1
  v_accvgpr_read_b32 v236, a12
  v_accvgpr_read_b32 v237, a28
  v_accvgpr_read_b32 v238, a44
  v_accvgpr_read_b32 v239, a60
  v_accvgpr_read_b32 v240, a76
  v_cvt_pk_bf16_f32 v211, v200, v201
  v_cvt_pk_bf16_f32 v215, v202, v203
  v_smfmac_f32_16x16x64_bf16 v[192:195], v[172:175], v[120:127], v166
  ds_read_b64 v[146:147], v160 offset:96
  ds_read_b64 v[148:149], v160 offset:824
  ds_read_b64 v[150:151], v160 offset:832
  v_accvgpr_read_b32 v241, a92
  v_accvgpr_read_b32 v242, a108
  v_accvgpr_read_b32 v243, a124
  v_accvgpr_read_b32 v244, a140
  v_accvgpr_read_b32 v245, a156
  v_smfmac_f32_16x16x64_bf16 v[196:199], v[168:171], v[120:127], v166
  s_waitcnt lgkmcnt(9)
  ds_read_b128 v[184:187], v164 offset:25088
  ds_read_b64 v[152:153], v160 offset:1560
  ds_read_b64 v[154:155], v160 offset:1568
  ds_read_b64 v[156:157], v160 offset:2296
  s_waitcnt vmcnt(27)
  v_dot2c_f32_bf16 v236, s33, v64
  v_dot2c_f32_bf16 v237, s34, v64
  v_dot2c_f32_bf16 v238, s33, v65
  v_dot2c_f32_bf16 v239, s34, v65
  v_dot2c_f32_bf16 v240, s33, v66
  v_cvt_pk_bf16_f32 v219, v204, v205
  v_cvt_pk_bf16_f32 v223, v206, v207
  v_smfmac_f32_16x16x64_bf16 v[192:195], v[176:179], v[128:135], v166
  ds_read_b64 v[158:159], v160 offset:2304
  ds_read_b128 v[188:191], v165 offset:25088
  ds_write_b128 v167, v[208:211] offset:0
  v_dot2c_f32_bf16 v241, s34, v66
  v_dot2c_f32_bf16 v242, s33, v67
  v_dot2c_f32_bf16 v243, s34, v67
  v_dot2c_f32_bf16 v244, s33, v104
  v_dot2c_f32_bf16 v245, s34, v104
  v_mfma_f32_16x16x32_bf16 v[200:203], v[224:227], v[224:227], 0
  v_smfmac_f32_16x16x64_bf16 v[196:199], v[172:175], v[128:135], v166
  s_waitcnt lgkmcnt(13)
  ds_read_b64 v[112:113], v160 offset:3032
  ds_read_b64 v[114:115], v160 offset:3040
  ds_write_b128 v167, v[212:215] offset:1024
  v_cvt_pk_bf16_f32 v64, v236, v237
  v_cvt_pk_bf16_f32 v65, v238, v239
  v_cvt_pk_bf16_f32 v66, v240, v241
  v_cvt_pk_bf16_f32 v67, v242, v243
  v_cvt_pk_bf16_f32 v104, v244, v245
  v_mfma_f32_16x16x32_bf16 v[204:207], v[224:227], v[224:227], 0
  v_smfmac_f32_16x16x64_bf16 v[196:199], v[176:179], v[136:143], v166
  s_waitcnt lgkmcnt(10)
  ds_read_b64 v[116:117], v160 offset:3768
  ds_read_b64 v[118:119], v160 offset:3776
  ds_read_b64 v[120:121], v160 offset:4504
  ds_read_b64 v[122:123], v160 offset:4512
  ds_write_b128 v167, v[216:219] offset:2048
  buffer_store_dwordx4 v[64:67], v14, s[12:15], s27 offen offset:0
  buffer_store_dwordx2 v[104:105], v15, s[12:15], s27 offen offset:0
  v_smfmac_f32_16x16x64_bf16 v[200:203], v[180:183], v[144:151], v166
  s_waitcnt lgkmcnt(10)
  ds_read_b128 v[168:171], v163 offset:25600
  ds_read_b64 v[128:129], v160 offset:176
  ds_read_b64 v[130:131], v160 offset:184
  ds_read_b64 v[132:133], v160 offset:912
  ds_write_b128 v167, v[220:223] offset:3072
  v_accvgpr_read_b32 v246, a13
  v_accvgpr_read_b32 v247, a29
  v_accvgpr_read_b32 v248, a45
  v_accvgpr_read_b32 v249, a61
  v_accvgpr_read_b32 v250, a77
  v_cvt_pk_bf16_f32 v208, v192, v193
  v_cvt_pk_bf16_f32 v212, v194, v195
  v_smfmac_f32_16x16x64_bf16 v[200:203], v[184:187], v[152:159], v166
  v_accvgpr_read_b32 v251, a93
  v_accvgpr_read_b32 v252, a109
  v_accvgpr_read_b32 v253, a125
  v_accvgpr_read_b32 v254, a141
  v_accvgpr_read_b32 v255, a157
  v_smfmac_f32_16x16x64_bf16 v[204:207], v[180:183], v[152:159], v166
  s_waitcnt lgkmcnt(8)
  ds_read_b64 v[134:135], v160 offset:920
  ds_read_b128 v[172:175], v164 offset:25600
  ds_read_b64 v[136:137], v160 offset:1648
  ds_read_b64 v[138:139], v160 offset:1656
  s_waitcnt lgkmcnt(4)
  s_barrier
  ds_read_b128 v[48:51], v0 offset:0
  ds_read_b128 v[52:55], v0 offset:256
  ds_read_b128 v[56:59], v0 offset:512
  ds_read_b128 v[60:63], v0 offset:768
  v_add_u32 v228, 0, v10
  s_waitcnt vmcnt(28)
  v_dot2c_f32_bf16 v246, s33, v68
  v_dot2c_f32_bf16 v247, s34, v68
  v_dot2c_f32_bf16 v248, s33, v69
  v_dot2c_f32_bf16 v249, s34, v69
  v_dot2c_f32_bf16 v250, s33, v70
  v_cvt_pk_bf16_f32 v216, v196, v197
  v_cvt_pk_bf16_f32 v220, v198, v199
  v_smfmac_f32_16x16x64_bf16 v[200:203], v[188:191], v[112:119], v166
  ds_read_b64 v[140:141], v160 offset:2384
  ds_read_b64 v[142:143], v160 offset:2392
  ds_read_b128 v[176:179], v165 offset:25600
  ds_read_b64 v[144:145], v160 offset:3120
  s_waitcnt vmcnt(22)
  ds_write2_b32 v228, a0, a16 offset0:0 offset1:11
  v_dot2c_f32_bf16 v251, s34, v70
  v_dot2c_f32_bf16 v252, s33, v71
  v_dot2c_f32_bf16 v253, s34, v71
  v_dot2c_f32_bf16 v254, s33, v106
  v_dot2c_f32_bf16 v255, s34, v106
  v_mfma_f32_16x16x32_bf16 v[192:195], v[224:227], v[224:227], 0
  v_smfmac_f32_16x16x64_bf16 v[204:207], v[184:187], v[112:119], v166
  ds_read_b64 v[146:147], v160 offset:3128
  ds_read_b64 v[148:149], v160 offset:3856
  ds_write2_b32 v228, a1, a17 offset0:22 offset1:33
  v_cvt_pk_bf16_f32 v68, v246, v247
  v_cvt_pk_bf16_f32 v69, v248, v249
  v_cvt_pk_bf16_f32 v70, v250, v251
  v_cvt_pk_bf16_f32 v71, v252, v253
  v_cvt_pk_bf16_f32 v106, v254, v255
  v_mfma_f32_16x16x32_bf16 v[196:199], v[224:227], v[224:227], 0
  v_smfmac_f32_16x16x64_bf16 v[204:207], v[188:191], v[120:127], v166
  s_waitcnt lgkmcnt(15)
  ds_write2_b32 v228, a2, a18 offset0:44 offset1:55
  buffer_store_dwordx4 v[68:71], v14, s[12:15], s27 offen offset:768
  buffer_store_dwordx2 v[106:107], v15, s[12:15], s27 offen offset:768
  v_smfmac_f32_16x16x64_bf16 v[192:195], v[168:171], v[128:135], v166
  s_waitcnt lgkmcnt(7)
  ds_read_b64 v[150:151], v160 offset:3864
  ds_read_b64 v[152:153], v160 offset:4592
  ds_read_b64 v[154:155], v160 offset:4600
  ds_read_b128 v[180:183], v163 offset:26112
  ds_write2_b32 v228, a3, a19 offset0:66 offset1:77
  v_add_u32 v229, 0, v11
  v_accvgpr_read_b32 v236, a14
  v_accvgpr_read_b32 v237, a30
  v_accvgpr_read_b32 v238, a46
  v_accvgpr_read_b32 v239, a62
  v_accvgpr_read_b32 v240, a78
  v_cvt_pk_bf16_f32 v209, v200, v201
  v_cvt_pk_bf16_f32 v213, v202, v203
  v_smfmac_f32_16x16x64_bf16 v[192:195], v[172:175], v[136:143], v166
  ds_read_b64 v[112:113], v160 offset:264
  ds_read_b64 v[114:115], v160 offset:272
  ds_read_b64 v[116:117], v160 offset:1000
  s_waitcnt vmcnt(20)
  ds_write2_b32 v229, a32, a48 offset0:0 offset1:11
  v_accvgpr_read_b32 v241, a94
  v_accvgpr_read_b32 v242, a110
  v_accvgpr_read_b32 v243, a126
  v_accvgpr_read_b32 v244, a142
  v_accvgpr_read_b32 v245, a158
  v_smfmac_f32_16x16x64_bf16 v[196:199], v[168:171], v[136:143], v166
  s_waitcnt lgkmcnt(8)
  ds_read_b64 v[118:119], v160 offset:1008
  ds_read_b128 v[184:187], v164 offset:26112
  ds_read_b64 v[120:121], v160 offset:1736
  ds_read_b64 v[122:123], v160 offset:1744
  ds_write2_b32 v229, a33, a49 offset0:22 offset1:33
  v_dot2c_f32_bf16 v236, s33, v72
  v_dot2c_f32_bf16 v237, s34, v72
  v_dot2c_f32_bf16 v238, s33, v73
  v_dot2c_f32_bf16 v239, s34, v73
  v_dot2c_f32_bf16 v240, s33, v74
  v_cvt_pk_bf16_f32 v217, v204, v205
  v_cvt_pk_bf16_f32 v221, v206, v207
  v_smfmac_f32_16x16x64_bf16 v[192:195], v[176:179], v[144:151], v166
  ds_read_b64 v[124:125], v160 offset:2472
  ds_read_b64 v[126:127], v160 offset:2480
  ds_write2_b32 v229, a34, a50 offset0:44 offset1:55
  v_dot2c_f32_bf16 v241, s34, v74
  v_dot2c_f32_bf16 v242, s33, v75
  v_dot2c_f32_bf16 v243, s34, v75
  v_dot2c_f32_bf16 v244, s33, v108
  v_dot2c_f32_bf16 v245, s34, v108
  v_mfma_f32_16x16x32_bf16 v[200:203], v[224:227], v[224:227], 0
  v_smfmac_f32_16x16x64_bf16 v[196:199], v[172:175], v[144:151], v166
  s_waitcnt lgkmcnt(14)
  ds_read_b128 v[188:191], v165 offset:26112
  ds_write2_b32 v229, a35, a51 offset0:66 offset1:77
  v_add_u32 v228, 0, v12
  v_cvt_pk_bf16_f32 v72, v236, v237
  v_cvt_pk_bf16_f32 v73, v238, v239
  v_cvt_pk_bf16_f32 v74, v240, v241
  v_cvt_pk_bf16_f32 v75, v242, v243
  v_cvt_pk_bf16_f32 v108, v244, v245
  v_mfma_f32_16x16x32_bf16 v[204:207], v[224:227], v[224:227], 0
  v_smfmac_f32_16x16x64_bf16 v[196:199], v[176:179], v[152:159], v166
  s_waitcnt lgkmcnt(9)
  ds_read_b64 v[128:129], v160 offset:3208
  ds_read_b64 v[130:131], v160 offset:3216
  ds_read_b64 v[132:133], v160 offset:3944
  ds_read_b64 v[134:135], v160 offset:3952
  s_waitcnt vmcnt(16)
  ds_write2_b32 v228, a64, a80 offset0:0 offset1:11
  buffer_store_dwordx4 v[72:75], v14, s[12:15], s27 offen offset:1536
  buffer_store_dwordx2 v[108:109], v15, s[12:15], s27 offen offset:1536
  v_smfmac_f32_16x16x64_bf16 v[200:203], v[180:183], v[112:119], v166
  s_waitcnt lgkmcnt(8)
  ds_read_b64 v[136:137], v160 offset:4680
  ds_read_b64 v[138:139], v160 offset:4688
  ds_read_b128 v[168:171], v163 offset:32768
  ds_read_b64 v[144:145], v161 offset:0
  ds_write2_b32 v228, a65, a81 offset0:22 offset1:33
  s_barrier
  v_accvgpr_read_b32 v246, a15
  v_accvgpr_read_b32 v247, a31
  v_accvgpr_read_b32 v248, a47
  v_accvgpr_read_b32 v249, a63
  v_accvgpr_read_b32 v250, a79
  v_cvt_pk_bf16_f32 v210, v192, v193
  v_cvt_pk_bf16_f32 v214, v194, v195
  v_smfmac_f32_16x16x64_bf16 v[200:203], v[184:187], v[120:127], v166
  ds_read_b64 v[146:147], v161 offset:8
  ds_read_b64 v[148:149], v161 offset:736
  ds_write2_b32 v228, a66, a82 offset0:44 offset1:55
  v_accvgpr_read_b32 v251, a95
  v_accvgpr_read_b32 v252, a111
  v_accvgpr_read_b32 v253, a127
  v_accvgpr_read_b32 v254, a143
  v_accvgpr_read_b32 v255, a159
  v_smfmac_f32_16x16x64_bf16 v[204:207], v[180:183], v[120:127], v166
  s_waitcnt lgkmcnt(9)
  ds_read_b64 v[150:151], v161 offset:744
  ds_read_b128 v[172:175], v164 offset:32768
  ds_read_b64 v[152:153], v161 offset:1472
  ds_read_b64 v[154:155], v161 offset:1480
  ds_write2_b32 v228, a67, a83 offset0:66 offset1:77
  v_add_u32 v229, 0, v13
  v_dot2c_f32_bf16 v246, s33, v76
  v_dot2c_f32_bf16 v247, s34, v76
  v_dot2c_f32_bf16 v248, s33, v77
  v_dot2c_f32_bf16 v249, s34, v77
  v_dot2c_f32_bf16 v250, s33, v78
  v_cvt_pk_bf16_f32 v218, v196, v197
  v_cvt_pk_bf16_f32 v222, v198, v199
  v_smfmac_f32_16x16x64_bf16 v[200:203], v[188:191], v[128:135], v166
  ds_read_b64 v[156:157], v161 offset:2208
  s_waitcnt vmcnt(16)
  s_mov_b64 exec, s[38:39]
  ds_write2_b32 v229, a96, a112 offset0:0 offset1:11
  s_mov_b64 exec, -1
  v_dot2c_f32_bf16 v251, s34, v78
  v_dot2c_f32_bf16 v252, s33, v79
  v_dot2c_f32_bf16 v253, s34, v79
  v_dot2c_f32_bf16 v254, s33, v110
  v_dot2c_f32_bf16 v255, s34, v110
  v_mfma_f32_16x16x32_bf16 v[192:195], v[224:227], v[224:227], 0
  v_smfmac_f32_16x16x64_bf16 v[204:207], v[184:187], v[128:135], v166
  s_waitcnt lgkmcnt(13)
  ds_read_b64 v[158:159], v161 offset:2216
  ds_read_b128 v[176:179], v165 offset:32768
  s_mov_b64 exec, s[38:39]
  ds_write2_b32 v229, a97, a113 offset0:22 offset1:33
  s_mov_b64 exec, -1
  v_cvt_pk_bf16_f32 v76, v246, v247
  v_cvt_pk_bf16_f32 v77, v248, v249
  v_cvt_pk_bf16_f32 v78, v250, v251
  v_cvt_pk_bf16_f32 v79, v252, v253
  v_cvt_pk_bf16_f32 v110, v254, v255
  v_mfma_f32_16x16x32_bf16 v[196:199], v[224:227], v[224:227], 0
  v_smfmac_f32_16x16x64_bf16 v[204:207], v[188:191], v[136:143], v166
  s_waitcnt lgkmcnt(9)
  ds_read_b64 v[112:113], v161 offset:2944
  ds_read_b64 v[114:115], v161 offset:2952
  ds_read_b64 v[116:117], v161 offset:3680
  ds_read_b64 v[118:119], v161 offset:3688
  s_mov_b64 exec, s[38:39]
  ds_write2_b32 v229, a98, a114 offset0:44 offset1:55
  s_mov_b64 exec, -1
  buffer_store_dwordx4 v[76:79], v14, s[12:15], s27 offen offset:2304
  buffer_store_dwordx2 v[110:111], v15, s[12:15], s27 offen offset:2304
  v_smfmac_f32_16x16x64_bf16 v[192:195], v[168:171], v[144:151], v166
  s_waitcnt lgkmcnt(7)
  ds_read_b64 v[120:121], v161 offset:4416
  ds_read_b64 v[122:123], v161 offset:4424
  ds_read_b128 v[180:183], v163 offset:33280
  ds_read_b64 v[128:129], v161 offset:88
  s_mov_b64 exec, s[38:39]
  ds_write2_b32 v229, a99, a115 offset0:66 offset1:77
  s_mov_b64 exec, -1
  v_cvt_pk_bf16_f32 v211, v200, v201
  v_cvt_pk_bf16_f32 v215, v202, v203
  v_smfmac_f32_16x16x64_bf16 v[192:195], v[172:175], v[152:159], v166
  ds_read_b64 v[130:131], v161 offset:96
  ds_read_b64 v[132:133], v161 offset:824
  ds_read_b64 v[134:135], v161 offset:832
  v_smfmac_f32_16x16x64_bf16 v[196:199], v[168:171], v[152:159], v166
  s_waitcnt lgkmcnt(9)
  ds_read_b128 v[184:187], v164 offset:33280
  ds_read_b64 v[136:137], v161 offset:1560
  ds_read_b64 v[138:139], v161 offset:1568
  ds_read_b64 v[140:141], v161 offset:2296
  v_dot2_f32_bf16 v236, v16, s35, 0
  v_dot2_f32_bf16 v237, v20, s35, 0
  v_dot2_f32_bf16 v238, v24, s35, 0
  v_dot2_f32_bf16 v239, v28, s35, 0
  v_dot2_f32_bf16 v240, v16, v16, 0
  v_cvt_pk_bf16_f32 v219, v204, v205
  v_cvt_pk_bf16_f32 v223, v206, v207
  v_smfmac_f32_16x16x64_bf16 v[192:195], v[176:179], v[112:119], v166
  ds_read_b64 v[142:143], v161 offset:2304
  ds_read_b128 v[188:191], v165 offset:33280
  ds_write_b128 v167, v[208:211] offset:0
  v_dot2_f32_bf16 v241, v20, v20, 0
  v_dot2_f32_bf16 v242, v24, v24, 0
  v_dot2_f32_bf16 v243, v28, v28, 0
  v_dot2c_f32_bf16 v236, s35, v17
  v_dot2c_f32_bf16 v237, s35, v21
  v_mfma_f32_16x16x32_bf16 v[200:203], v[224:227], v[224:227], 0
  v_smfmac_f32_16x16x64_bf16 v[196:199], v[172:175], v[112:119], v166
  s_waitcnt lgkmcnt(13)
  ds_read_b64 v[144:145], v161 offset:3032
  ds_read_b64 v[146:147], v161 offset:3040
  ds_write_b128 v167, v[212:215] offset:1024
  v_dot2c_f32_bf16 v238, s35, v25
  v_dot2c_f32_bf16 v239, s35, v29
  v_dot2c_f32_bf16 v240, v17, v17
  v_dot2c_f32_bf16 v241, v21, v21
  v_dot2c_f32_bf16 v242, v25, v25
  v_mfma_f32_16x16x32_bf16 v[204:207], v[224:227], v[224:227], 0
  v_smfmac_f32_16x16x64_bf16 v[196:199], v[176:179], v[120:127], v166
  s_waitcnt lgkmcnt(10)
  ds_read_b64 v[148:149], v161 offset:3768
  ds_read_b64 v[150:151], v161 offset:3776
  ds_read_b64 v[152:153], v161 offset:4504
  ds_read_b64 v[154:155], v161 offset:4512
  ds_write_b128 v167, v[216:219] offset:2048
  v_dot2c_f32_bf16 v243, v29, v29
  v_dot2c_f32_bf16 v236, s35, v18
  v_dot2c_f32_bf16 v237, s35, v22
  v_dot2c_f32_bf16 v238, s35, v26
  v_dot2c_f32_bf16 v239, s35, v30
  v_smfmac_f32_16x16x64_bf16 v[200:203], v[180:183], v[128:135], v166
  s_waitcnt lgkmcnt(10)
  ds_read_b128 v[168:171], v163 offset:33792
  ds_read_b64 v[112:113], v161 offset:176
  ds_read_b64 v[114:115], v161 offset:184
  ds_read_b64 v[116:117], v161 offset:912
  ds_write_b128 v167, v[220:223] offset:3072
  v_dot2c_f32_bf16 v240, v18, v18
  v_dot2c_f32_bf16 v241, v22, v22
  v_dot2c_f32_bf16 v242, v26, v26
  v_dot2c_f32_bf16 v243, v30, v30
  v_dot2c_f32_bf16 v236, s35, v19
  v_cvt_pk_bf16_f32 v208, v192, v193
  v_cvt_pk_bf16_f32 v212, v194, v195
  v_smfmac_f32_16x16x64_bf16 v[200:203], v[184:187], v[136:143], v166
  v_dot2c_f32_bf16 v237, s35, v23
  v_dot2c_f32_bf16 v238, s35, v27
  v_dot2c_f32_bf16 v239, s35, v31
  v_dot2c_f32_bf16 v240, v19, v19
  v_dot2c_f32_bf16 v241, v23, v23
  v_smfmac_f32_16x16x64_bf16 v[204:207], v[180:183], v[136:143], v166
  s_waitcnt lgkmcnt(8)
  ds_read_b64 v[118:119], v161 offset:920
  ds_read_b128 v[172:175], v164 offset:33792
  ds_read_b64 v[120:121], v161 offset:1648
  ds_read_b64 v[122:123], v161 offset:1656
  s_waitcnt lgkmcnt(4)
  s_barrier
  ds_read_b128 v[64:67], v0 offset:0
  ds_read_b128 v[68:71], v0 offset:256
  ds_read_b128 v[72:75], v0 offset:512
  ds_read_b128 v[76:79], v0 offset:768
  v_dot2c_f32_bf16 v242, v27, v27
  v_dot2c_f32_bf16 v243, v31, v31
  v_dot2c_f32_bf16 v236, s35, v32
  v_dot2c_f32_bf16 v237, s35, v36
  v_dot2c_f32_bf16 v238, s35, v40
  v_cvt_pk_bf16_f32 v216, v196, v197
  v_cvt_pk_bf16_f32 v220, v198, v199
  v_smfmac_f32_16x16x64_bf16 v[200:203], v[188:191], v[144:151], v166
  ds_read_b64 v[124:125], v161 offset:2384
  ds_read_b64 v[126:127], v161 offset:2392
  ds_read_b128 v[176:179], v165 offset:33792
  ds_read_b64 v[128:129], v161 offset:3120
  v_dot2c_f32_bf16 v239, s35, v44
  v_dot2c_f32_bf16 v240, v32, v32
  v_dot2c_f32_bf16 v241, v36, v36
  v_dot2c_f32_bf16 v242, v40, v40
  v_dot2c_f32_bf16 v243, v44, v44
  v_mfma_f32_16x16x32_bf16 v[192:195], v[224:227], v[224:227], 0
  v_smfmac_f32_16x16x64_bf16 v[204:207], v[184:187], v[144:151], v166
  ds_read_b64 v[130:131], v161 offset:3128
  ds_read_b64 v[132:133], v161 offset:3856
  ds_read_b64 v[134:135], v161 offset:3864
  v_dot2c_f32_bf16 v236, s35, v33
  v_dot2c_f32_bf16 v237, s35, v37
  v_dot2c_f32_bf16 v238, s35, v41
  v_dot2c_f32_bf16 v239, s35, v45
  v_dot2c_f32_bf16 v240, v33, v33
  v_mfma_f32_16x16x32_bf16 v[196:199], v[224:227], v[224:227], 0
  v_smfmac_f32_16x16x64_bf16 v[204:207], v[188:191], v[152:159], v166
  s_waitcnt lgkmcnt(14)
  ds_read_b64 v[136:137], v161 offset:4592
  v_dot2c_f32_bf16 v241, v37, v37
  v_dot2c_f32_bf16 v242, v41, v41
  v_dot2c_f32_bf16 v243, v45, v45
  v_dot2c_f32_bf16 v236, s35, v34
  v_dot2c_f32_bf16 v237, s35, v38
  v_smfmac_f32_16x16x64_bf16 v[192:195], v[168:171], v[112:119], v166
  s_waitcnt lgkmcnt(6)
  ds_read_b64 v[138:139], v161 offset:4600
  ds_read_b128 v[180:183], v163 offset:34304
  ds_read_b64 v[144:145], v161 offset:264
  ds_read_b64 v[146:147], v161 offset:272
  v_dot2c_f32_bf16 v238, s35, v42
  v_dot2c_f32_bf16 v239, s35, v46
  v_dot2c_f32_bf16 v240, v34, v34
  v_dot2c_f32_bf16 v241, v38, v38
  v_dot2c_f32_bf16 v242, v42, v42
  v_cvt_pk_bf16_f32 v209, v200, v201
  v_cvt_pk_bf16_f32 v213, v202, v203
  v_smfmac_f32_16x16x64_bf16 v[192:195], v[172:175], v[120:127], v166
  ds_read_b64 v[148:149], v161 offset:1000
  ds_read_b64 v[150:151], v161 offset:1008
  ds_read_b128 v[184:187], v164 offset:34304
  ds_read_b64 v[152:153], v161 offset:1736
  v_dot2c_f32_bf16 v243, v46, v46
  v_dot2c_f32_bf16 v236, s35, v35
  v_dot2c_f32_bf16 v237, s35, v39
  v_dot2c_f32_bf16 v238, s35, v43
  v_dot2c_f32_bf16 v239, s35, v47
  v_smfmac_f32_16x16x64_bf16 v[196:199], v[168:171], v[120:127], v166
  s_waitcnt lgkmcnt(9)
  ds_read_b64 v[154:155], v161 offset:1744
  ds_read_b64 v[156:157], v161 offset:2472
  ds_read_b64 v[158:159], v161 offset:2480
  ds_read_b128 v[188:191], v165 offset:34304
  v_dot2c_f32_bf16 v240, v35, v35
  v_dot2c_f32_bf16 v241, v39, v39
  v_dot2c_f32_bf16 v242, v43, v43
  v_dot2c_f32_bf16 v243, v47, v47
  v_dot2c_f32_bf16 v236, s35, v48
  v_cvt_pk_bf16_f32 v217, v204, v205
  v_cvt_pk_bf16_f32 v221, v206, v207
  v_smfmac_f32_16x16x64_bf16 v[192:195], v[176:179], v[128:135], v166
  ds_read_b64 v[112:113], v161 offset:3208
  ds_read_b64 v[114:115], v161 offset:3216
  v_dot2c_f32_bf16 v237, s35, v52
  v_dot2c_f32_bf16 v238, s35, v56
  v_dot2c_f32_bf16 v239, s35, v60
  v_dot2c_f32_bf16 v240, v48, v48
  v_dot2c_f32_bf16 v241, v52, v52
  v_mfma_f32_16x16x32_bf16 v[200:203], v[224:227], v[224:227], 0
  v_smfmac_f32_16x16x64_bf16 v[196:199], v[172:175], v[128:135], v166
  s_waitcnt lgkmcnt(13)
  ds_read_b64 v[116:117], v161 offset:3944
  ds_read_b64 v[118:119], v161 offset:3952
  v_dot2c_f32_bf16 v242, v56, v56
  v_dot2c_f32_bf16 v243, v60, v60
  v_dot2c_f32_bf16 v236, s35, v49
  v_dot2c_f32_bf16 v237, s35, v53
  v_dot2c_f32_bf16 v238, s35, v57
  v_mfma_f32_16x16x32_bf16 v[204:207], v[224:227], v[224:227], 0
  v_smfmac_f32_16x16x64_bf16 v[196:199], v[176:179], v[136:143], v166
  s_waitcnt lgkmcnt(10)
  ds_read_b64 v[120:121], v161 offset:4680
  ds_read_b64 v[122:123], v161 offset:4688
  ds_read_b128 v[168:171], v163 offset:40960
  ds_read_b64 v[128:129], v162 offset:0
  v_dot2c_f32_bf16 v239, s35, v61
  v_dot2c_f32_bf16 v240, v49, v49
  v_dot2c_f32_bf16 v241, v53, v53
  v_dot2c_f32_bf16 v242, v57, v57
  v_dot2c_f32_bf16 v243, v61, v61
  v_smfmac_f32_16x16x64_bf16 v[200:203], v[180:183], v[144:151], v166
  s_waitcnt lgkmcnt(9)
  ds_read_b64 v[130:131], v162 offset:8
  ds_read_b64 v[132:133], v162 offset:736
  ds_read_b64 v[134:135], v162 offset:744
  ds_read_b128 v[172:175], v164 offset:40960
  s_barrier
  v_dot2c_f32_bf16 v236, s35, v50
  v_dot2c_f32_bf16 v237, s35, v54
  v_dot2c_f32_bf16 v238, s35, v58
  v_dot2c_f32_bf16 v239, s35, v62
  v_dot2c_f32_bf16 v240, v50, v50
  v_cvt_pk_bf16_f32 v210, v192, v193
  v_cvt_pk_bf16_f32 v214, v194, v195
  v_smfmac_f32_16x16x64_bf16 v[200:203], v[184:187], v[152:159], v166
  ds_read_b64 v[136:137], v162 offset:1472
  ds_read_b64 v[138:139], v162 offset:1480
  v_dot2c_f32_bf16 v241, v54, v54
  v_dot2c_f32_bf16 v242, v58, v58
  v_dot2c_f32_bf16 v243, v62, v62
  v_dot2c_f32_bf16 v236, s35, v51
  v_dot2c_f32_bf16 v237, s35, v55
  v_smfmac_f32_16x16x64_bf16 v[204:207], v[180:183], v[152:159], v166
  s_waitcnt lgkmcnt(10)
  ds_read_b64 v[140:141], v162 offset:2208
  ds_read_b64 v[142:143], v162 offset:2216
  ds_read_b128 v[176:179], v165 offset:40960
  ds_read_b64 v[144:145], v162 offset:2944
  v_dot2c_f32_bf16 v238, s35, v59
  v_dot2c_f32_bf16 v239, s35, v63
  v_dot2c_f32_bf16 v240, v51, v51
  v_dot2c_f32_bf16 v241, v55, v55
  v_dot2c_f32_bf16 v242, v59, v59
  v_cvt_pk_bf16_f32 v218, v196, v197
  v_cvt_pk_bf16_f32 v222, v198, v199
  v_smfmac_f32_16x16x64_bf16 v[200:203], v[188:191], v[112:119], v166
  ds_read_b64 v[146:147], v162 offset:2952
  v_dot2c_f32_bf16 v243, v63, v63
  v_mfma_f32_16x16x32_bf16 v[192:195], v[224:227], v[224:227], 0
  v_smfmac_f32_16x16x64_bf16 v[204:207], v[184:187], v[112:119], v166
  s_waitcnt lgkmcnt(13)
  ds_read_b64 v[148:149], v162 offset:3680
  ds_read_b64 v[150:151], v162 offset:3688
  v_mfma_f32_16x16x32_bf16 v[196:199], v[224:227], v[224:227], 0
  v_smfmac_f32_16x16x64_bf16 v[204:207], v[188:191], v[120:127], v166
  s_waitcnt lgkmcnt(10)
  ds_read_b64 v[152:153], v162 offset:4416
  ds_read_b64 v[154:155], v162 offset:4424
  ds_read_b128 v[180:183], v163 offset:41472
  ds_read_b64 v[112:113], v162 offset:88
  v_smfmac_f32_16x16x64_bf16 v[192:195], v[168:171], v[128:135], v166
  s_waitcnt lgkmcnt(9)
  ds_read_b64 v[114:115], v162 offset:96
  ds_read_b64 v[116:117], v162 offset:824
  ds_read_b64 v[118:119], v162 offset:832
  ds_read_b128 v[184:187], v164 offset:41472
  v_cvt_pk_bf16_f32 v211, v200, v201
  v_cvt_pk_bf16_f32 v215, v202, v203
  v_smfmac_f32_16x16x64_bf16 v[192:195], v[172:175], v[136:143], v166
  ds_read_b64 v[120:121], v162 offset:1560
  ds_read_b64 v[122:123], v162 offset:1568
  v_smfmac_f32_16x16x64_bf16 v[196:199], v[168:171], v[136:143], v166
  s_waitcnt lgkmcnt(10)
  ds_read_b64 v[124:125], v162 offset:2296
  ds_read_b64 v[126:127], v162 offset:2304
  ds_read_b128 v[188:191], v165 offset:41472
  ds_read_b64 v[128:129], v162 offset:3032
  v_dot2c_f32_bf16 v236, s35, v64
  v_dot2c_f32_bf16 v237, s35, v68
  v_cvt_pk_bf16_f32 v219, v204, v205
  v_cvt_pk_bf16_f32 v223, v206, v207
  v_smfmac_f32_16x16x64_bf16 v[192:195], v[176:179], v[144:151], v166
  ds_read_b64 v[130:131], v162 offset:3040
  ds_write_b128 v167, v[208:211] offset:0
  v_dot2c_f32_bf16 v238, s35, v72
  v_dot2c_f32_bf16 v239, s35, v76
  v_mfma_f32_16x16x32_bf16 v[200:203], v[224:227], v[224:227], 0
  v_smfmac_f32_16x16x64_bf16 v[196:199], v[172:175], v[144:151], v166
  s_waitcnt lgkmcnt(14)
  ds_read_b64 v[132:133], v162 offset:3768
  ds_write_b128 v167, v[212:215] offset:1024
  v_dot2c_f32_bf16 v240, v64, v64
  v_dot2c_f32_bf16 v241, v68, v68
  v_mfma_f32_16x16x32_bf16 v[204:207], v[224:227], v[224:227], 0
  v_smfmac_f32_16x16x64_bf16 v[196:199], v[176:179], v[152:159], v166
  s_waitcnt lgkmcnt(11)
  ds_read_b64 v[134:135], v162 offset:3776
  ds_read_b64 v[136:137], v162 offset:4504
  ds_read_b64 v[138:139], v162 offset:4512
  ds_read_b128 v[168:171], v163 offset:41984
  ds_write_b128 v167, v[216:219] offset:2048
  v_dot2c_f32_bf16 v242, v72, v72
  v_dot2c_f32_bf16 v243, v76, v76
  v_smfmac_f32_16x16x64_bf16 v[200:203], v[180:183], v[112:119], v166
  s_waitcnt lgkmcnt(11)
  ds_read_b64 v[144:145], v162 offset:176
  ds_read_b64 v[146:147], v162 offset:184
  ds_read_b64 v[148:149], v162 offset:912
  ds_read_b64 v[150:151], v162 offset:920
  ds_write_b128 v167, v[220:223] offset:3072
  v_dot2c_f32_bf16 v236, s35, v65
  v_dot2c_f32_bf16 v237, s35, v69
  v_cvt_pk_bf16_f32 v208, v192, v193
  v_cvt_pk_bf16_f32 v212, v194, v195
  v_smfmac_f32_16x16x64_bf16 v[200:203], v[184:187], v[120:127], v166
  v_dot2c_f32_bf16 v238, s35, v73
  v_dot2c_f32_bf16 v239, s35, v77
  v_smfmac_f32_16x16x64_bf16 v[204:207], v[180:183], v[120:127], v166
  s_waitcnt lgkmcnt(9)
  ds_read_b128 v[172:175], v164 offset:41984
  ds_read_b64 v[152:153], v162 offset:1648
  ds_read_b64 v[154:155], v162 offset:1656
  ds_read_b64 v[156:157], v162 offset:2384
  s_waitcnt lgkmcnt(4)
  s_barrier
  ds_read_b128 v[80:83], v0 offset:0
  ds_read_b128 v[84:87], v0 offset:256
  ds_read_b128 v[88:91], v0 offset:512
  ds_read_b128 v[92:95], v0 offset:768
  v_dot2c_f32_bf16 v240, v65, v65
  v_dot2c_f32_bf16 v241, v69, v69
  v_cvt_pk_bf16_f32 v216, v196, v197
  v_cvt_pk_bf16_f32 v220, v198, v199
  v_smfmac_f32_16x16x64_bf16 v[200:203], v[188:191], v[128:135], v166
  ds_read_b64 v[158:159], v162 offset:2392
  ds_read_b128 v[176:179], v165 offset:41984
  ds_read_b64 v[112:113], v162 offset:3120
  ds_read_b64 v[114:115], v162 offset:3128
  v_dot2c_f32_bf16 v242, v73, v73
  v_dot2c_f32_bf16 v243, v77, v77
  v_mfma_f32_16x16x32_bf16 v[192:195], v[224:227], v[224:227], 0
  v_smfmac_f32_16x16x64_bf16 v[204:207], v[184:187], v[128:135], v166
  ds_read_b64 v[116:117], v162 offset:3856
  ds_read_b64 v[118:119], v162 offset:3864
  ds_read_b64 v[120:121], v162 offset:4592
  v_dot2c_f32_bf16 v236, s35, v66
  v_dot2c_f32_bf16 v237, s35, v70
  v_mfma_f32_16x16x32_bf16 v[196:199], v[224:227], v[224:227], 0
  v_smfmac_f32_16x16x64_bf16 v[204:207], v[188:191], v[136:143], v166
  v_dot2c_f32_bf16 v238, s35, v74
  v_dot2c_f32_bf16 v239, s35, v78
  v_smfmac_f32_16x16x64_bf16 v[192:195], v[168:171], v[144:151], v166
  s_waitcnt lgkmcnt(6)
  ds_read_b64 v[122:123], v162 offset:4600
  ds_read_b128 v[180:183], v163 offset:42496
  ds_read_b64 v[128:129], v162 offset:264
  ds_read_b64 v[130:131], v162 offset:272
  v_dot2c_f32_bf16 v240, v66, v66
  v_dot2c_f32_bf16 v241, v70, v70
  v_cvt_pk_bf16_f32 v209, v200, v201
  v_cvt_pk_bf16_f32 v213, v202, v203
  v_smfmac_f32_16x16x64_bf16 v[192:195], v[172:175], v[152:159], v166
  ds_read_b64 v[132:133], v162 offset:1000
  ds_read_b64 v[134:135], v162 offset:1008
  ds_read_b128 v[184:187], v164 offset:42496
  ds_read_b64 v[136:137], v162 offset:1736
  v_dot2c_f32_bf16 v242, v74, v74
  v_dot2c_f32_bf16 v243, v78, v78
  v_smfmac_f32_16x16x64_bf16 v[196:199], v[168:171], v[152:159], v166
  s_waitcnt lgkmcnt(9)
  ds_read_b64 v[138:139], v162 offset:1744
  ds_read_b64 v[140:141], v162 offset:2472
  ds_read_b64 v[142:143], v162 offset:2480
  ds_read_b128 v[188:191], v165 offset:42496
  v_dot2c_f32_bf16 v236, s35, v67
  v_dot2c_f32_bf16 v237, s35, v71
  v_cvt_pk_bf16_f32 v217, v204, v205
  v_cvt_pk_bf16_f32 v221, v206, v207
  v_smfmac_f32_16x16x64_bf16 v[192:195], v[176:179], v[112:119], v166
  ds_read_b64 v[144:145], v162 offset:3208
  ds_read_b64 v[146:147], v162 offset:3216
  v_dot2c_f32_bf16 v238, s35, v75
  v_dot2c_f32_bf16 v239, s35, v79
  v_mfma_f32_16x16x32_bf16 v[200:203], v[224:227], v[224:227], 0
  v_smfmac_f32_16x16x64_bf16 v[196:199], v[172:175], v[112:119], v166
  s_waitcnt lgkmcnt(13)
  ds_read_b64 v[148:149], v162 offset:3944
  ds_read_b64 v[150:151], v162 offset:3952
  v_dot2c_f32_bf16 v240, v67, v67
  v_dot2c_f32_bf16 v241, v71, v71
  v_mfma_f32_16x16x32_bf16 v[204:207], v[224:227], v[224:227], 0
  v_smfmac_f32_16x16x64_bf16 v[196:199], v[176:179], v[120:127], v166
  s_waitcnt lgkmcnt(10)
  ds_read_b64 v[152:153], v162 offset:4680
  ds_read_b64 v[154:155], v162 offset:4688
  v_dot2c_f32_bf16 v242, v75, v75
  v_dot2c_f32_bf16 v243, v79, v79
  v_smfmac_f32_16x16x64_bf16 v[200:203], v[180:183], v[128:135], v166
  s_waitcnt lgkmcnt(7)
  s_barrier
  v_cvt_pk_bf16_f32 v210, v192, v193
  v_cvt_pk_bf16_f32 v214, v194, v195
  v_smfmac_f32_16x16x64_bf16 v[200:203], v[184:187], v[136:143], v166
  v_smfmac_f32_16x16x64_bf16 v[204:207], v[180:183], v[136:143], v166
  s_waitcnt lgkmcnt(2)
  v_cvt_pk_bf16_f32 v218, v196, v197
  v_cvt_pk_bf16_f32 v222, v198, v199
  v_smfmac_f32_16x16x64_bf16 v[200:203], v[188:191], v[144:151], v166
  v_smfmac_f32_16x16x64_bf16 v[204:207], v[184:187], v[144:151], v166
  s_waitcnt lgkmcnt(0)
  v_smfmac_f32_16x16x64_bf16 v[204:207], v[188:191], v[152:159], v166
  s_nop 7
  v_cvt_pk_bf16_f32 v211, v200, v201
  v_cvt_pk_bf16_f32 v215, v202, v203
  v_cvt_pk_bf16_f32 v219, v204, v205
  v_cvt_pk_bf16_f32 v223, v206, v207
  ds_write_b128 v167, v[208:211] offset:0
  ds_write_b128 v167, v[212:215] offset:1024
  ds_write_b128 v167, v[216:219] offset:2048
  ds_write_b128 v167, v[220:223] offset:3072
  v_dot2c_f32_bf16 v236, s35, v80
  v_dot2c_f32_bf16 v237, s35, v84
  v_dot2c_f32_bf16 v238, s35, v88
  v_dot2c_f32_bf16 v239, s35, v92
  v_dot2c_f32_bf16 v240, v80, v80
  v_dot2c_f32_bf16 v241, v84, v84
  v_dot2c_f32_bf16 v242, v88, v88
  v_dot2c_f32_bf16 v243, v92, v92
  v_dot2c_f32_bf16 v236, s35, v81
  v_dot2c_f32_bf16 v237, s35, v85
  v_dot2c_f32_bf16 v238, s35, v89
  v_dot2c_f32_bf16 v239, s35, v93
  v_dot2c_f32_bf16 v240, v81, v81
  v_dot2c_f32_bf16 v241, v85, v85
  v_dot2c_f32_bf16 v242, v89, v89
  v_dot2c_f32_bf16 v243, v93, v93
  v_dot2c_f32_bf16 v236, s35, v82
  v_dot2c_f32_bf16 v237, s35, v86
  v_dot2c_f32_bf16 v238, s35, v90
  v_dot2c_f32_bf16 v239, s35, v94
  v_dot2c_f32_bf16 v240, v82, v82
  v_dot2c_f32_bf16 v241, v86, v86
  v_dot2c_f32_bf16 v242, v90, v90
  v_dot2c_f32_bf16 v243, v94, v94
  v_dot2c_f32_bf16 v236, s35, v83
  v_dot2c_f32_bf16 v237, s35, v87
  v_dot2c_f32_bf16 v238, s35, v91
  v_dot2c_f32_bf16 v239, s35, v95
  v_dot2c_f32_bf16 v240, v83, v83
  v_dot2c_f32_bf16 v241, v87, v87
  v_dot2c_f32_bf16 v242, v91, v91
  v_dot2c_f32_bf16 v243, v95, v95
  s_waitcnt lgkmcnt(0)
  s_barrier
  ds_read_b128 v[96:99], v0 offset:0
  ds_read_b128 v[100:103], v0 offset:256
  ds_read_b128 v[104:107], v0 offset:512
  ds_read_b128 v[108:111], v0 offset:768
  s_mov_b32 s20, s29
  s_add_u32 m0, s29, 0
  s_nop 0
  buffer_load_dwordx4 v1, s[16:19], s20 offen offset:0 lds
  buffer_load_dwordx4 v1, s[16:19], s20 offen offset:1024 lds
  buffer_load_dwordx4 v1, s[16:19], s20 offen offset:2048 lds
  buffer_load_dwordx4 v1, s[16:19], s20 offen offset:3072 lds
  s_add_u32 m0, s29, 4096
  s_add_u32 s20, s20, 4096
  s_nop 0
  buffer_load_dwordx4 v1, s[16:19], s20 offen offset:0 lds
  buffer_load_dwordx4 v1, s[16:19], s20 offen offset:1024 lds
  s_add_u32 s20, s20, 20480
ln_entry:
  s_waitcnt lgkmcnt(0)
  v_dot2c_f32_bf16 v236, s35, v96
  v_dot2c_f32_bf16 v237, s35, v100
  v_dot2c_f32_bf16 v238, s35, v104
  v_dot2c_f32_bf16 v239, s35, v108
  v_dot2c_f32_bf16 v240, v96, v96
  v_dot2c_f32_bf16 v241, v100, v100
  v_dot2c_f32_bf16 v242, v104, v104
  v_dot2c_f32_bf16 v243, v108, v108
  v_dot2c_f32_bf16 v236, s35, v97
  v_dot2c_f32_bf16 v237, s35, v101
  v_dot2c_f32_bf16 v238, s35, v105
  v_dot2c_f32_bf16 v239, s35, v109
  v_dot2c_f32_bf16 v240, v97, v97
  v_dot2c_f32_bf16 v241, v101, v101
  v_dot2c_f32_bf16 v242, v105, v105
  v_dot2c_f32_bf16 v243, v109, v109
  v_dot2c_f32_bf16 v236, s35, v98
  v_dot2c_f32_bf16 v237, s35, v102
  v_dot2c_f32_bf16 v238, s35, v106
  v_dot2c_f32_bf16 v239, s35, v110
  v_dot2c_f32_bf16 v240, v98, v98
  v_dot2c_f32_bf16 v241, v102, v102
  v_dot2c_f32_bf16 v242, v106, v106
  v_dot2c_f32_bf16 v243, v110, v110
  v_dot2c_f32_bf16 v236, s35, v99
  v_dot2c_f32_bf16 v237, s35, v103
  v_dot2c_f32_bf16 v238, s35, v107
  v_dot2c_f32_bf16 v239, s35, v111
  v_dot2c_f32_bf16 v240, v99, v99
  v_dot2c_f32_bf16 v241, v103, v103
  v_dot2c_f32_bf16 v242, v107, v107
  v_dot2c_f32_bf16 v243, v111, v111
  v_mov_b32 v120, v236
  v_mov_b32 v121, v237
  v_mov_b32 v122, v238
  v_mov_b32 v123, v239
  v_mov_b32 v124, v240
  v_mov_b32 v125, v241
  v_mov_b32 v126, v242
  v_mov_b32 v127, v243
  s_nop 1
  v_permlane32_swap_b32 v120, v236
  v_permlane32_swap_b32 v121, v237
  v_permlane32_swap_b32 v122, v238
  v_permlane32_swap_b32 v123, v239
  v_permlane32_swap_b32 v124, v240
  v_permlane32_swap_b32 v125, v241
  v_permlane32_swap_b32 v126, v242
  v_permlane32_swap_b32 v127, v243
  s_nop 1
  v_add_f32 v236, v236, v120
  v_add_f32 v237, v237, v121
  v_add_f32 v238, v238, v122
  v_add_f32 v239, v239, v123
  v_add_f32 v240, v240, v124
  v_add_f32 v241, v241, v125
  v_add_f32 v242, v242, v126
  v_add_f32 v243, v243, v127
  v_mov_b32 v120, v236
  v_mov_b32 v121, v237
  v_mov_b32 v122, v238
  v_mov_b32 v123, v239
  v_mov_b32 v124, v240
  v_mov_b32 v125, v241
  v_mov_b32 v126, v242
  v_mov_b32 v127, v243
  s_nop 1
  v_permlane16_swap_b32 v120, v236
  v_permlane16_swap_b32 v121, v237
  v_permlane16_swap_b32 v122, v238
  v_permlane16_swap_b32 v123, v239
  v_permlane16_swap_b32 v124, v240
  v_permlane16_swap_b32 v125, v241
  v_permlane16_swap_b32 v126, v242
  v_permlane16_swap_b32 v127, v243
  s_nop 1
  v_add_f32 v236, v236, v120
  v_add_f32 v237, v237, v121
  v_add_f32 v238, v238, v122
  v_add_f32 v239, v239, v123
  v_add_f32 v240, v240, v124
  v_add_f32 v241, v241, v125
  v_add_f32 v242, v242, v126
  v_add_f32 v243, v243, v127
  v_mul_f32 v128, s51, v236
  v_mul_f32 v129, s51, v237
  v_mul_f32 v130, s51, v238
  v_mul_f32 v131, s51, v239
  v_mul_f32 v240, s51, v240
  v_mul_f32 v241, s51, v241
  v_mul_f32 v242, s51, v242
  v_mul_f32 v243, s51, v243
  v_fma_f32 v240, -v128, v128, v240
  v_fma_f32 v241, -v129, v129, v241
  v_fma_f32 v242, -v130, v130, v242
  v_fma_f32 v243, -v131, v131, v243
  v_add_f32 v240, s52, v240
  v_add_f32 v241, s52, v241
  v_add_f32 v242, s52, v242
  v_add_f32 v243, s52, v243
  v_rsq_f32 v240, v240
  v_rsq_f32 v241, v241
  v_rsq_f32 v242, v242
  v_rsq_f32 v243, v243
  s_nop 0
  v_mul_f32 v136, s53, v240
  v_mul_f32 v138, s53, v241
  v_mul_f32 v140, s53, v242
  v_mul_f32 v142, s53, v243
  v_mul_f32 v144, -v128, v136
  v_mul_f32 v146, -v129, v138
  v_mul_f32 v148, -v130, v140
  v_mul_f32 v150, -v131, v142
  s_barrier
  s_add_u32 m0, s29, 24576
  s_nop 0
  buffer_load_dwordx4 v1, s[16:19], s20 offen offset:0 lds
  buffer_load_dwordx4 v1, s[16:19], s20 offen offset:1024 lds
  buffer_load_dwordx4 v1, s[16:19], s20 offen offset:2048 lds
  buffer_load_dwordx4 v1, s[16:19], s20 offen offset:3072 lds
  s_add_u32 m0, s29, 28672
  s_add_u32 s20, s20, 4096
  s_nop 0
  buffer_load_dwordx4 v1, s[16:19], s20 offen offset:0 lds
  buffer_load_dwordx4 v1, s[16:19], s20 offen offset:1024 lds
  s_add_u32 s20, s20, 20480
  v_lshlrev_b32 v152, 16, v16
  v_and_b32 v153, s50, v16
  v_lshlrev_b32 v154, 16, v17
  v_and_b32 v155, s50, v17
  v_lshlrev_b32 v156, 16, v18
  v_and_b32 v157, s50, v18
  v_lshlrev_b32 v158, 16, v19
  v_and_b32 v159, s50, v19
  v_lshlrev_b32 v160, 16, v20
  v_and_b32 v161, s50, v20
  v_lshlrev_b32 v162, 16, v21
  v_and_b32 v163, s50, v21
  v_lshlrev_b32 v164, 16, v22
  v_and_b32 v165, s50, v22
  v_lshlrev_b32 v166, 16, v23
  v_and_b32 v167, s50, v23
  v_pk_fma_f32 v[152:153], v[152:153], v[136:137], v[144:145] op_sel_hi:[1,0,0]
  v_pk_fma_f32 v[154:155], v[154:155], v[136:137], v[144:145] op_sel_hi:[1,0,0]
  v_pk_fma_f32 v[156:157], v[156:157], v[136:137], v[144:145] op_sel_hi:[1,0,0]
  v_pk_fma_f32 v[158:159], v[158:159], v[136:137], v[144:145] op_sel_hi:[1,0,0]
  v_pk_fma_f32 v[160:161], v[160:161], v[138:139], v[146:147] op_sel_hi:[1,0,0]
  v_pk_fma_f32 v[162:163], v[162:163], v[138:139], v[146:147] op_sel_hi:[1,0,0]
  v_pk_fma_f32 v[164:165], v[164:165], v[138:139], v[146:147] op_sel_hi:[1,0,0]
  v_pk_fma_f32 v[166:167], v[166:167], v[138:139], v[146:147] op_sel_hi:[1,0,0]
  v_cvt_pk_bf16_f32 v16, v152, v153
  v_cvt_pk_bf16_f32 v17, v154, v155
  v_cvt_pk_bf16_f32 v18, v156, v157
  v_cvt_pk_bf16_f32 v19, v158, v159
  v_cvt_pk_bf16_f32 v20, v160, v161
  v_cvt_pk_bf16_f32 v21, v162, v163
  v_cvt_pk_bf16_f32 v22, v164, v165
  v_cvt_pk_bf16_f32 v23, v166, v167
  v_lshlrev_b32 v152, 16, v24
  v_and_b32 v153, s50, v24
  v_lshlrev_b32 v154, 16, v25
  v_and_b32 v155, s50, v25
  v_lshlrev_b32 v156, 16, v26
  v_and_b32 v157, s50, v26
  v_lshlrev_b32 v158, 16, v27
  v_and_b32 v159, s50, v27
  v_lshlrev_b32 v160, 16, v28
  v_and_b32 v161, s50, v28
  v_lshlrev_b32 v162, 16, v29
  v_and_b32 v163, s50, v29
  v_lshlrev_b32 v164, 16, v30
  v_and_b32 v165, s50, v30
  v_lshlrev_b32 v166, 16, v31
  v_and_b32 v167, s50, v31
  v_pk_fma_f32 v[152:153], v[152:153], v[140:141], v[148:149] op_sel_hi:[1,0,0]
  v_pk_fma_f32 v[154:155], v[154:155], v[140:141], v[148:149] op_sel_hi:[1,0,0]
  v_pk_fma_f32 v[156:157], v[156:157], v[140:141], v[148:149] op_sel_hi:[1,0,0]
  v_pk_fma_f32 v[158:159], v[158:159], v[140:141], v[148:149] op_sel_hi:[1,0,0]
  v_pk_fma_f32 v[160:161], v[160:161], v[142:143], v[150:151] op_sel_hi:[1,0,0]
  v_pk_fma_f32 v[162:163], v[162:163], v[142:143], v[150:151] op_sel_hi:[1,0,0]
  v_pk_fma_f32 v[164:165], v[164:165], v[142:143], v[150:151] op_sel_hi:[1,0,0]
  v_pk_fma_f32 v[166:167], v[166:167], v[142:143], v[150:151] op_sel_hi:[1,0,0]
  v_cvt_pk_bf16_f32 v24, v152, v153
  v_cvt_pk_bf16_f32 v25, v154, v155
  v_cvt_pk_bf16_f32 v26, v156, v157
  v_cvt_pk_bf16_f32 v27, v158, v159
  v_cvt_pk_bf16_f32 v28, v160, v161
  v_cvt_pk_bf16_f32 v29, v162, v163
  v_cvt_pk_bf16_f32 v30, v164, v165
  v_cvt_pk_bf16_f32 v31, v166, v167
  v_lshlrev_b32 v152, 16, v32
  v_and_b32 v153, s50, v32
  v_lshlrev_b32 v154, 16, v33
  v_and_b32 v155, s50, v33
  v_lshlrev_b32 v156, 16, v34
  v_and_b32 v157, s50, v34
  v_lshlrev_b32 v158, 16, v35
  v_and_b32 v159, s50, v35
  v_lshlrev_b32 v160, 16, v36
  v_and_b32 v161, s50, v36
  v_lshlrev_b32 v162, 16, v37
  v_and_b32 v163, s50, v37
  v_lshlrev_b32 v164, 16, v38
  v_and_b32 v165, s50, v38
  v_lshlrev_b32 v166, 16, v39
  v_and_b32 v167, s50, v39
  v_pk_fma_f32 v[152:153], v[152:153], v[136:137], v[144:145] op_sel_hi:[1,0,0]
  v_pk_fma_f32 v[154:155], v[154:155], v[136:137], v[144:145] op_sel_hi:[1,0,0]
  v_pk_fma_f32 v[156:157], v[156:157], v[136:137], v[144:145] op_sel_hi:[1,0,0]
  v_pk_fma_f32 v[158:159], v[158:159], v[136:137], v[144:145] op_sel_hi:[1,0,0]
  v_pk_fma_f32 v[160:161], v[160:161], v[138:139], v[146:147] op_sel_hi:[1,0,0]
  v_pk_fma_f32 v[162:163], v[162:163], v[138:139], v[146:147] op_sel_hi:[1,0,0]
  v_pk_fma_f32 v[164:165], v[164:165], v[138:139], v[146:147] op_sel_hi:[1,0,0]
  v_pk_fma_f32 v[166:167], v[166:167], v[138:139], v[146:147] op_sel_hi:[1,0,0]
  v_cvt_pk_bf16_f32 v32, v152, v153
  v_cvt_pk_bf16_f32 v33, v154, v155
  v_cvt_pk_bf16_f32 v34, v156, v157
  v_cvt_pk_bf16_f32 v35, v158, v159
  v_cvt_pk_bf16_f32 v36, v160, v161
  v_cvt_pk_bf16_f32 v37, v162, v163
  v_cvt_pk_bf16_f32 v38, v164, v165
  v_cvt_pk_bf16_f32 v39, v166, v167
  v_lshlrev_b32 v152, 16, v40
  v_and_b32 v153, s50, v40
  v_lshlrev_b32 v154, 16, v41
  v_and_b32 v155, s50, v41
  v_lshlrev_b32 v156, 16, v42
  v_and_b32 v157, s50, v42
  v_lshlrev_b32 v158, 16, v43
  v_and_b32 v159, s50, v43
  v_lshlrev_b32 v160, 16, v44
  v_and_b32 v161, s50, v44
  v_lshlrev_b32 v162, 16, v45
  v_and_b32 v163, s50, v45
  v_lshlrev_b32 v164, 16, v46
  v_and_b32 v165, s50, v46
  v_lshlrev_b32 v166, 16, v47
  v_and_b32 v167, s50, v47
  v_pk_fma_f32 v[152:153], v[152:153], v[140:141], v[148:149] op_sel_hi:[1,0,0]
  v_pk_fma_f32 v[154:155], v[154:155], v[140:141], v[148:149] op_sel_hi:[1,0,0]
  v_pk_fma_f32 v[156:157], v[156:157], v[140:141], v[148:149] op_sel_hi:[1,0,0]
  v_pk_fma_f32 v[158:159], v[158:159], v[140:141], v[148:149] op_sel_hi:[1,0,0]
  v_pk_fma_f32 v[160:161], v[160:161], v[142:143], v[150:151] op_sel_hi:[1,0,0]
  v_pk_fma_f32 v[162:163], v[162:163], v[142:143], v[150:151] op_sel_hi:[1,0,0]
  v_pk_fma_f32 v[164:165], v[164:165], v[142:143], v[150:151] op_sel_hi:[1,0,0]
  v_pk_fma_f32 v[166:167], v[166:167], v[142:143], v[150:151] op_sel_hi:[1,0,0]
  v_cvt_pk_bf16_f32 v40, v152, v153
  v_cvt_pk_bf16_f32 v41, v154, v155
  v_cvt_pk_bf16_f32 v42, v156, v157
  v_cvt_pk_bf16_f32 v43, v158, v159
  v_cvt_pk_bf16_f32 v44, v160, v161
  v_cvt_pk_bf16_f32 v45, v162, v163
  v_cvt_pk_bf16_f32 v46, v164, v165
  v_cvt_pk_bf16_f32 v47, v166, v167
  v_lshlrev_b32 v152, 16, v48
  v_and_b32 v153, s50, v48
  v_lshlrev_b32 v154, 16, v49
  v_and_b32 v155, s50, v49
  v_lshlrev_b32 v156, 16, v50
  v_and_b32 v157, s50, v50
  v_lshlrev_b32 v158, 16, v51
  v_and_b32 v159, s50, v51
  v_lshlrev_b32 v160, 16, v52
  v_and_b32 v161, s50, v52
  v_lshlrev_b32 v162, 16, v53
  v_and_b32 v163, s50, v53
  v_lshlrev_b32 v164, 16, v54
  v_and_b32 v165, s50, v54
  v_lshlrev_b32 v166, 16, v55
  v_and_b32 v167, s50, v55
  v_pk_fma_f32 v[152:153], v[152:153], v[136:137], v[144:145] op_sel_hi:[1,0,0]
  v_pk_fma_f32 v[154:155], v[154:155], v[136:137], v[144:145] op_sel_hi:[1,0,0]
  v_pk_fma_f32 v[156:157], v[156:157], v[136:137], v[144:145] op_sel_hi:[1,0,0]
  v_pk_fma_f32 v[158:159], v[158:159], v[136:137], v[144:145] op_sel_hi:[1,0,0]
  v_pk_fma_f32 v[160:161], v[160:161], v[138:139], v[146:147] op_sel_hi:[1,0,0]
  v_pk_fma_f32 v[162:163], v[162:163], v[138:139], v[146:147] op_sel_hi:[1,0,0]
  v_pk_fma_f32 v[164:165], v[164:165], v[138:139], v[146:147] op_sel_hi:[1,0,0]
  v_pk_fma_f32 v[166:167], v[166:167], v[138:139], v[146:147] op_sel_hi:[1,0,0]
  v_cvt_pk_bf16_f32 v48, v152, v153
  v_cvt_pk_bf16_f32 v49, v154, v155
  v_cvt_pk_bf16_f32 v50, v156, v157
  v_cvt_pk_bf16_f32 v51, v158, v159
  v_cvt_pk_bf16_f32 v52, v160, v161
  v_cvt_pk_bf16_f32 v53, v162, v163
  v_cvt_pk_bf16_f32 v54, v164, v165
  v_cvt_pk_bf16_f32 v55, v166, v167
  v_lshlrev_b32 v152, 16, v56
  v_and_b32 v153, s50, v56
  v_lshlrev_b32 v154, 16, v57
  v_and_b32 v155, s50, v57
  v_lshlrev_b32 v156, 16, v58
  v_and_b32 v157, s50, v58
  v_lshlrev_b32 v158, 16, v59
  v_and_b32 v159, s50, v59
  v_lshlrev_b32 v160, 16, v60
  v_and_b32 v161, s50, v60
  v_lshlrev_b32 v162, 16, v61
  v_and_b32 v163, s50, v61
  v_lshlrev_b32 v164, 16, v62
  v_and_b32 v165, s50, v62
  v_lshlrev_b32 v166, 16, v63
  v_and_b32 v167, s50, v63
  v_pk_fma_f32 v[152:153], v[152:153], v[140:141], v[148:149] op_sel_hi:[1,0,0]
  v_pk_fma_f32 v[154:155], v[154:155], v[140:141], v[148:149] op_sel_hi:[1,0,0]
  v_pk_fma_f32 v[156:157], v[156:157], v[140:141], v[148:149] op_sel_hi:[1,0,0]
  v_pk_fma_f32 v[158:159], v[158:159], v[140:141], v[148:149] op_sel_hi:[1,0,0]
  v_pk_fma_f32 v[160:161], v[160:161], v[142:143], v[150:151] op_sel_hi:[1,0,0]
  v_pk_fma_f32 v[162:163], v[162:163], v[142:143], v[150:151] op_sel_hi:[1,0,0]
  v_pk_fma_f32 v[164:165], v[164:165], v[142:143], v[150:151] op_sel_hi:[1,0,0]
  v_pk_fma_f32 v[166:167], v[166:167], v[142:143], v[150:151] op_sel_hi:[1,0,0]
  v_cvt_pk_bf16_f32 v56, v152, v153
  v_cvt_pk_bf16_f32 v57, v154, v155
  v_cvt_pk_bf16_f32 v58, v156, v157
  v_cvt_pk_bf16_f32 v59, v158, v159
  v_cvt_pk_bf16_f32 v60, v160, v161
  v_cvt_pk_bf16_f32 v61, v162, v163
  v_cvt_pk_bf16_f32 v62, v164, v165
  v_cvt_pk_bf16_f32 v63, v166, v167
  v_lshlrev_b32 v152, 16, v64
  v_and_b32 v153, s50, v64
  v_lshlrev_b32 v154, 16, v65
  v_and_b32 v155, s50, v65
  v_lshlrev_b32 v156, 16, v66
  v_and_b32 v157, s50, v66
  v_lshlrev_b32 v158, 16, v67
  v_and_b32 v159, s50, v67
  v_lshlrev_b32 v160, 16, v68
  v_and_b32 v161, s50, v68
  v_lshlrev_b32 v162, 16, v69
  v_and_b32 v163, s50, v69
  v_lshlrev_b32 v164, 16, v70
  v_and_b32 v165, s50, v70
  v_lshlrev_b32 v166, 16, v71
  v_and_b32 v167, s50, v71
  v_pk_fma_f32 v[152:153], v[152:153], v[136:137], v[144:145] op_sel_hi:[1,0,0]
  v_pk_fma_f32 v[154:155], v[154:155], v[136:137], v[144:145] op_sel_hi:[1,0,0]
  v_pk_fma_f32 v[156:157], v[156:157], v[136:137], v[144:145] op_sel_hi:[1,0,0]
  v_pk_fma_f32 v[158:159], v[158:159], v[136:137], v[144:145] op_sel_hi:[1,0,0]
  v_pk_fma_f32 v[160:161], v[160:161], v[138:139], v[146:147] op_sel_hi:[1,0,0]
  v_pk_fma_f32 v[162:163], v[162:163], v[138:139], v[146:147] op_sel_hi:[1,0,0]
  v_pk_fma_f32 v[164:165], v[164:165], v[138:139], v[146:147] op_sel_hi:[1,0,0]
  v_pk_fma_f32 v[166:167], v[166:167], v[138:139], v[146:147] op_sel_hi:[1,0,0]
  v_cvt_pk_bf16_f32 v64, v152, v153
  v_cvt_pk_bf16_f32 v65, v154, v155
  v_cvt_pk_bf16_f32 v66, v156, v157
  v_cvt_pk_bf16_f32 v67, v158, v159
  v_cvt_pk_bf16_f32 v68, v160, v161
  v_cvt_pk_bf16_f32 v69, v162, v163
  v_cvt_pk_bf16_f32 v70, v164, v165
  v_cvt_pk_bf16_f32 v71, v166, v167
  v_lshlrev_b32 v152, 16, v72
  v_and_b32 v153, s50, v72
  v_lshlrev_b32 v154, 16, v73
  v_and_b32 v155, s50, v73
  v_lshlrev_b32 v156, 16, v74
  v_and_b32 v157, s50, v74
  v_lshlrev_b32 v158, 16, v75
  v_and_b32 v159, s50, v75
  v_lshlrev_b32 v160, 16, v76
  v_and_b32 v161, s50, v76
  v_lshlrev_b32 v162, 16, v77
  v_and_b32 v163, s50, v77
  v_lshlrev_b32 v164, 16, v78
  v_and_b32 v165, s50, v78
  v_lshlrev_b32 v166, 16, v79
  v_and_b32 v167, s50, v79
  v_pk_fma_f32 v[152:153], v[152:153], v[140:141], v[148:149] op_sel_hi:[1,0,0]
  v_pk_fma_f32 v[154:155], v[154:155], v[140:141], v[148:149] op_sel_hi:[1,0,0]
  v_pk_fma_f32 v[156:157], v[156:157], v[140:141], v[148:149] op_sel_hi:[1,0,0]
  v_pk_fma_f32 v[158:159], v[158:159], v[140:141], v[148:149] op_sel_hi:[1,0,0]
  v_pk_fma_f32 v[160:161], v[160:161], v[142:143], v[150:151] op_sel_hi:[1,0,0]
  v_pk_fma_f32 v[162:163], v[162:163], v[142:143], v[150:151] op_sel_hi:[1,0,0]
  v_pk_fma_f32 v[164:165], v[164:165], v[142:143], v[150:151] op_sel_hi:[1,0,0]
  v_pk_fma_f32 v[166:167], v[166:167], v[142:143], v[150:151] op_sel_hi:[1,0,0]
  v_cvt_pk_bf16_f32 v72, v152, v153
  v_cvt_pk_bf16_f32 v73, v154, v155
  v_cvt_pk_bf16_f32 v74, v156, v157
  v_cvt_pk_bf16_f32 v75, v158, v159
  v_cvt_pk_bf16_f32 v76, v160, v161
  v_cvt_pk_bf16_f32 v77, v162, v163
  v_cvt_pk_bf16_f32 v78, v164, v165
  v_cvt_pk_bf16_f32 v79, v166, v167
  v_lshlrev_b32 v152, 16, v80
  v_and_b32 v153, s50, v80
  v_lshlrev_b32 v154, 16, v81
  v_and_b32 v155, s50, v81
  v_lshlrev_b32 v156, 16, v82
  v_and_b32 v157, s50, v82
  v_lshlrev_b32 v158, 16, v83
  v_and_b32 v159, s50, v83
  v_lshlrev_b32 v160, 16, v84
  v_and_b32 v161, s50, v84
  v_lshlrev_b32 v162, 16, v85
  v_and_b32 v163, s50, v85
  v_lshlrev_b32 v164, 16, v86
  v_and_b32 v165, s50, v86
  v_lshlrev_b32 v166, 16, v87
  v_and_b32 v167, s50, v87
  v_pk_fma_f32 v[152:153], v[152:153], v[136:137], v[144:145] op_sel_hi:[1,0,0]
  v_pk_fma_f32 v[154:155], v[154:155], v[136:137], v[144:145] op_sel_hi:[1,0,0]
  v_pk_fma_f32 v[156:157], v[156:157], v[136:137], v[144:145] op_sel_hi:[1,0,0]
  v_pk_fma_f32 v[158:159], v[158:159], v[136:137], v[144:145] op_sel_hi:[1,0,0]
  v_pk_fma_f32 v[160:161], v[160:161], v[138:139], v[146:147] op_sel_hi:[1,0,0]
  v_pk_fma_f32 v[162:163], v[162:163], v[138:139], v[146:147] op_sel_hi:[1,0,0]
  v_pk_fma_f32 v[164:165], v[164:165], v[138:139], v[146:147] op_sel_hi:[1,0,0]
  v_pk_fma_f32 v[166:167], v[166:167], v[138:139], v[146:147] op_sel_hi:[1,0,0]
  v_cvt_pk_bf16_f32 v80, v152, v153
  v_cvt_pk_bf16_f32 v81, v154, v155
  v_cvt_pk_bf16_f32 v82, v156, v157
  v_cvt_pk_bf16_f32 v83, v158, v159
  v_cvt_pk_bf16_f32 v84, v160, v161
  v_cvt_pk_bf16_f32 v85, v162, v163
  v_cvt_pk_bf16_f32 v86, v164, v165
  v_cvt_pk_bf16_f32 v87, v166, v167
  v_lshlrev_b32 v152, 16, v88
  v_and_b32 v153, s50, v88
  v_lshlrev_b32 v154, 16, v89
  v_and_b32 v155, s50, v89
  v_lshlrev_b32 v156, 16, v90
  v_and_b32 v157, s50, v90
  v_lshlrev_b32 v158, 16, v91
  v_and_b32 v159, s50, v91
  v_lshlrev_b32 v160, 16, v92
  v_and_b32 v161, s50, v92
  v_lshlrev_b32 v162, 16, v93
  v_and_b32 v163, s50, v93
  v_lshlrev_b32 v164, 16, v94
  v_and_b32 v165, s50, v94
  v_lshlrev_b32 v166, 16, v95
  v_and_b32 v167, s50, v95
  v_pk_fma_f32 v[152:153], v[152:153], v[140:141], v[148:149] op_sel_hi:[1,0,0]
  v_pk_fma_f32 v[154:155], v[154:155], v[140:141], v[148:149] op_sel_hi:[1,0,0]
  v_pk_fma_f32 v[156:157], v[156:157], v[140:141], v[148:149] op_sel_hi:[1,0,0]
  v_pk_fma_f32 v[158:159], v[158:159], v[140:141], v[148:149] op_sel_hi:[1,0,0]
  v_pk_fma_f32 v[160:161], v[160:161], v[142:143], v[150:151] op_sel_hi:[1,0,0]
  v_pk_fma_f32 v[162:163], v[162:163], v[142:143], v[150:151] op_sel_hi:[1,0,0]
  v_pk_fma_f32 v[164:165], v[164:165], v[142:143], v[150:151] op_sel_hi:[1,0,0]
  v_pk_fma_f32 v[166:167], v[166:167], v[142:143], v[150:151] op_sel_hi:[1,0,0]
  v_cvt_pk_bf16_f32 v88, v152, v153
  v_cvt_pk_bf16_f32 v89, v154, v155
  v_cvt_pk_bf16_f32 v90, v156, v157
  v_cvt_pk_bf16_f32 v91, v158, v159
  v_cvt_pk_bf16_f32 v92, v160, v161
  v_cvt_pk_bf16_f32 v93, v162, v163
  v_cvt_pk_bf16_f32 v94, v164, v165
  v_cvt_pk_bf16_f32 v95, v166, v167
  v_lshlrev_b32 v152, 16, v96
  v_and_b32 v153, s50, v96
  v_lshlrev_b32 v154, 16, v97
  v_and_b32 v155, s50, v97
  v_lshlrev_b32 v156, 16, v98
  v_and_b32 v157, s50, v98
  v_lshlrev_b32 v158, 16, v99
  v_and_b32 v159, s50, v99
  v_lshlrev_b32 v160, 16, v100
  v_and_b32 v161, s50, v100
  v_lshlrev_b32 v162, 16, v101
  v_and_b32 v163, s50, v101
  v_lshlrev_b32 v164, 16, v102
  v_and_b32 v165, s50, v102
  v_lshlrev_b32 v166, 16, v103
  v_and_b32 v167, s50, v103
  v_pk_fma_f32 v[152:153], v[152:153], v[136:137], v[144:145] op_sel_hi:[1,0,0]
  v_pk_fma_f32 v[154:155], v[154:155], v[136:137], v[144:145] op_sel_hi:[1,0,0]
  v_pk_fma_f32 v[156:157], v[156:157], v[136:137], v[144:145] op_sel_hi:[1,0,0]
  v_pk_fma_f32 v[158:159], v[158:159], v[136:137], v[144:145] op_sel_hi:[1,0,0]
  v_pk_fma_f32 v[160:161], v[160:161], v[138:139], v[146:147] op_sel_hi:[1,0,0]
  v_pk_fma_f32 v[162:163], v[162:163], v[138:139], v[146:147] op_sel_hi:[1,0,0]
  v_pk_fma_f32 v[164:165], v[164:165], v[138:139], v[146:147] op_sel_hi:[1,0,0]
  v_pk_fma_f32 v[166:167], v[166:167], v[138:139], v[146:147] op_sel_hi:[1,0,0]
  v_cvt_pk_bf16_f32 v96, v152, v153
  v_cvt_pk_bf16_f32 v97, v154, v155
  v_cvt_pk_bf16_f32 v98, v156, v157
  v_cvt_pk_bf16_f32 v99, v158, v159
  v_cvt_pk_bf16_f32 v100, v160, v161
  v_cvt_pk_bf16_f32 v101, v162, v163
  v_cvt_pk_bf16_f32 v102, v164, v165
  v_cvt_pk_bf16_f32 v103, v166, v167
  v_lshlrev_b32 v152, 16, v104
  v_and_b32 v153, s50, v104
  v_lshlrev_b32 v154, 16, v105
  v_and_b32 v155, s50, v105
  v_lshlrev_b32 v156, 16, v106
  v_and_b32 v157, s50, v106
  v_lshlrev_b32 v158, 16, v107
  v_and_b32 v159, s50, v107
  v_lshlrev_b32 v160, 16, v108
  v_and_b32 v161, s50, v108
  v_lshlrev_b32 v162, 16, v109
  v_and_b32 v163, s50, v109
  v_lshlrev_b32 v164, 16, v110
  v_and_b32 v165, s50, v110
  v_lshlrev_b32 v166, 16, v111
  v_and_b32 v167, s50, v111
  v_pk_fma_f32 v[152:153], v[152:153], v[140:141], v[148:149] op_sel_hi:[1,0,0]
  v_pk_fma_f32 v[154:155], v[154:155], v[140:141], v[148:149] op_sel_hi:[1,0,0]
  v_pk_fma_f32 v[156:157], v[156:157], v[140:141], v[148:149] op_sel_hi:[1,0,0]
  v_pk_fma_f32 v[158:159], v[158:159], v[140:141], v[148:149] op_sel_hi:[1,0,0]
  v_pk_fma_f32 v[160:161], v[160:161], v[142:143], v[150:151] op_sel_hi:[1,0,0]
  v_pk_fma_f32 v[162:163], v[162:163], v[142:143], v[150:151] op_sel_hi:[1,0,0]
  v_pk_fma_f32 v[164:165], v[164:165], v[142:143], v[150:151] op_sel_hi:[1,0,0]
  v_pk_fma_f32 v[166:167], v[166:167], v[142:143], v[150:151] op_sel_hi:[1,0,0]
  v_cvt_pk_bf16_f32 v104, v152, v153
  v_cvt_pk_bf16_f32 v105, v154, v155
  v_cvt_pk_bf16_f32 v106, v156, v157
  v_cvt_pk_bf16_f32 v107, v158, v159
  v_cvt_pk_bf16_f32 v108, v160, v161
  v_cvt_pk_bf16_f32 v109, v162, v163
  v_cvt_pk_bf16_f32 v110, v164, v165
  v_cvt_pk_bf16_f32 v111, v166, v167
  s_waitcnt vmcnt(6)
  s_barrier
  s_add_u32 s58, s37, 128
  s_cmp_eq_u32 s31, 3
  s_cselect_b32 s58, 0x4000, s58
  v_mov_b32 v0, 0x80000000
  ds_read_b128 a[160:163], v1 offset:0
  ds_read_b128 a[164:167], v1 offset:1024
  ds_read_b128 a[168:171], v1 offset:2048
  ds_read_b128 a[172:175], v1 offset:3072
  ds_read_b128 a[176:179], v1 offset:4096
  ds_read_b128 a[180:183], v1 offset:5120
  ds_read_b128 a[184:187], v1 offset:6144
  ds_read_b128 a[188:191], v1 offset:7168
  ds_read_b128 a[192:195], v1 offset:8192
  ds_read_b128 a[196:199], v1 offset:9216
  ds_read_b128 a[200:203], v1 offset:10240
  ds_read_b128 a[204:207], v1 offset:11264
  s_waitcnt lgkmcnt(0)
  s_waitcnt vmcnt(0)
  s_barrier
  v_mfma_f32_16x16x32_bf16 v[112:115], a[160:163], v[16:19], 0
  v_lshrrev_b32 v208, 4, v1
  s_lshl_b32 s40, s32, 6
  v_mfma_f32_16x16x32_bf16 v[112:115], a[164:167], v[32:35], v[112:115]
  s_add_u32 m0, s29, 0
  v_add_u32 v208, s40, v208
  v_and_b32 v209, 3, v208
  v_lshrrev_b32 v210, 2, v208
  v_mfma_f32_16x16x32_bf16 v[112:115], a[168:171], v[48:51], v[112:115]
  buffer_load_dwordx4 v1, s[16:19], s20 offen offset:0 lds
  v_mfma_f32_16x16x32_bf16 v[112:115], a[172:175], v[64:67], v[112:115]
  s_sub_u32 s40, s36, 3
  s_mul_i32 s40, s40, 196608
  v_mfma_f32_16x16x32_bf16 v[112:115], a[176:179], v[80:83], v[112:115]
  s_sub_u32 s41, s58, 3
  s_mov_b32 s42, 745
  v_mov_b32 v219, 0x80000000
  v_mfma_f32_16x16x32_bf16 v[112:115], a[180:183], v[96:99], v[112:115]
  v_add_u32 v211, 0, v210
  v_mul_lo_u32 v212, v211, s42
  v_mfma_f32_16x16x32_bf16 v[116:119], a[160:163], v[20:23], 0
  buffer_load_dwordx4 v1, s[16:19], s20 offen offset:1024 lds
  v_mfma_f32_16x16x32_bf16 v[116:119], a[164:167], v[36:39], v[116:119]
  v_lshrrev_b32 v212, 13, v212
  v_mul_u32_u24 v213, 11, v212
  v_sub_u32 v213, v211, v213
  v_mfma_f32_16x16x32_bf16 v[116:119], a[168:171], v[52:55], v[116:119]
  v_add_u32 v216, s41, v213
  v_mov_b32 v217, 196608
  v_mfma_f32_16x16x32_bf16 v[116:119], a[172:175], v[68:71], v[116:119]
  v_mul_lo_u32 v217, v212, v217
  v_lshl_add_u32 v217, v209, 4, v217
  v_mfma_f32_16x16x32_bf16 v[116:119], a[176:179], v[84:87], v[116:119]
  buffer_load_dwordx4 v1, s[16:19], s20 offen offset:2048 lds
  v_mfma_f32_16x16x32_bf16 v[116:119], a[180:183], v[100:103], v[116:119]
  v_add_u32 v217, s40, v217
  v_mul_u32_u24 v218, 384, v216
  v_add_u32 v218, v218, v217
  v_mfma_f32_16x16x32_bf16 v[120:123], a[160:163], v[24:27], 0
  v_cmp_gt_u32 vcc, 512, v216
  s_nop 1
  v_mfma_f32_16x16x32_bf16 v[120:123], a[164:167], v[40:43], v[120:123]
  v_cndmask_b32 v2, v219, v218, vcc
  v_add_u32 v216, 11, v216
  v_mfma_f32_16x16x32_bf16 v[120:123], a[168:171], v[56:59], v[120:123]
  buffer_load_dwordx4 v1, s[16:19], s20 offen offset:3072 lds
  v_mul_u32_u24 v218, 384, v216
  v_mfma_f32_16x16x32_bf16 v[120:123], a[172:175], v[72:75], v[120:123]
  v_add_u32 v218, v218, v217
  v_cmp_gt_u32 vcc, 512, v216
  v_mfma_f32_16x16x32_bf16 v[120:123], a[176:179], v[88:91], v[120:123]
  s_nop 1
  v_cndmask_b32 v6, v219, v218, vcc
  v_mfma_f32_16x16x32_bf16 v[120:123], a[180:183], v[104:107], v[120:123]
  s_add_u32 m0, s29, 4096
  s_add_u32 s20, s20, 4096
  v_add_u32 v211, 64, v210
  v_mul_lo_u32 v212, v211, s42
  v_mfma_f32_16x16x32_bf16 v[124:127], a[160:163], v[28:31], 0
  buffer_load_dwordx4 v1, s[16:19], s20 offen offset:0 lds
  v_mfma_f32_16x16x32_bf16 v[124:127], a[164:167], v[44:47], v[124:127]
  v_lshrrev_b32 v212, 13, v212
  v_mul_u32_u24 v213, 11, v212
  v_mfma_f32_16x16x32_bf16 v[124:127], a[168:171], v[60:63], v[124:127]
  v_sub_u32 v213, v211, v213
  v_add_u32 v216, s41, v213
  v_mov_b32 v217, 196608
  v_mfma_f32_16x16x32_bf16 v[124:127], a[172:175], v[76:79], v[124:127]
  v_mul_lo_u32 v217, v212, v217
  v_lshl_add_u32 v217, v209, 4, v217
  v_mfma_f32_16x16x32_bf16 v[124:127], a[176:179], v[92:95], v[124:127]
  buffer_load_dwordx4 v1, s[16:19], s20 offen offset:1024 lds
  v_mfma_f32_16x16x32_bf16 v[124:127], a[180:183], v[108:111], v[124:127]
  s_add_u32 s20, s20, 20480
  v_add_u32 v217, s40, v217
  v_mul_u32_u24 v218, 384, v216
  v_add_u32 v218, v218, v217
  v_mfma_f32_16x16x32_bf16 v[128:131], a[184:187], v[16:19], 0
  v_cmp_gt_u32 vcc, 512, v216
  s_nop 1
  v_mfma_f32_16x16x32_bf16 v[128:131], a[188:191], v[32:35], v[128:131]
  v_cndmask_b32 v3, v219, v218, vcc
  v_add_u32 v216, 11, v216
  v_mfma_f32_16x16x32_bf16 v[128:131], a[192:195], v[48:51], v[128:131]
  v_mul_u32_u24 v218, 384, v216
  v_add_u32 v218, v218, v217
  v_mfma_f32_16x16x32_bf16 v[128:131], a[196:199], v[64:67], v[128:131]
  v_cmp_gt_u32 vcc, 512, v216
  s_nop 1
  v_cndmask_b32 v7, v219, v218, vcc
  v_mfma_f32_16x16x32_bf16 v[128:131], a[200:203], v[80:83], v[128:131]
  v_add_u32 v211, 128, v210
  v_mul_lo_u32 v212, v211, s42
  v_mfma_f32_16x16x32_bf16 v[128:131], a[204:207], v[96:99], v[128:131]
  v_lshrrev_b32 v212, 13, v212
  v_mul_u32_u24 v213, 11, v212
  v_mfma_f32_16x16x32_bf16 v[132:135], a[184:187], v[20:23], 0
  v_sub_u32 v213, v211, v213
  v_add_u32 v216, s41, v213
  v_mov_b32 v217, 196608
  v_mfma_f32_16x16x32_bf16 v[132:135], a[188:191], v[36:39], v[132:135]
  v_mul_lo_u32 v217, v212, v217
  v_lshl_add_u32 v217, v209, 4, v217
  v_mfma_f32_16x16x32_bf16 v[132:135], a[192:195], v[52:55], v[132:135]
  v_add_u32 v217, s40, v217
  v_mul_u32_u24 v218, 384, v216
  v_mfma_f32_16x16x32_bf16 v[132:135], a[196:199], v[68:71], v[132:135]
  v_add_u32 v218, v218, v217
  v_cmp_gt_u32 vcc, 512, v216
  s_nop 1
  v_mfma_f32_16x16x32_bf16 v[132:135], a[200:203], v[84:87], v[132:135]
  v_cndmask_b32 v4, v219, v218, vcc
  v_add_u32 v216, 11, v216
  v_mfma_f32_16x16x32_bf16 v[132:135], a[204:207], v[100:103], v[132:135]
  v_mul_u32_u24 v218, 384, v216
  v_add_u32 v218, v218, v217
  v_mfma_f32_16x16x32_bf16 v[136:139], a[184:187], v[24:27], 0
  v_cmp_gt_u32 vcc, 512, v216
  s_nop 1
  v_cndmask_b32 v8, v219, v218, vcc
  v_mfma_f32_16x16x32_bf16 v[136:139], a[188:191], v[40:43], v[136:139]
  v_add_u32 v211, 192, v210
  v_mul_lo_u32 v212, v211, s42
  v_mfma_f32_16x16x32_bf16 v[136:139], a[192:195], v[56:59], v[136:139]
  v_lshrrev_b32 v212, 13, v212
  v_mul_u32_u24 v213, 11, v212
  v_mfma_f32_16x16x32_bf16 v[136:139], a[196:199], v[72:75], v[136:139]
  v_sub_u32 v213, v211, v213
  v_add_u32 v216, s41, v213
  v_mov_b32 v217, 196608
  v_mfma_f32_16x16x32_bf16 v[136:139], a[200:203], v[88:91], v[136:139]
  v_mul_lo_u32 v217, v212, v217
  v_lshl_add_u32 v217, v209, 4, v217
  v_mfma_f32_16x16x32_bf16 v[136:139], a[204:207], v[104:107], v[136:139]
  v_add_u32 v217, s40, v217
  v_mul_u32_u24 v218, 384, v216
  v_mfma_f32_16x16x32_bf16 v[140:143], a[184:187], v[28:31], 0
  v_add_u32 v218, v218, v217
  v_cmp_gt_u32 vcc, 512, v216
  v_mfma_f32_16x16x32_bf16 v[140:143], a[188:191], v[44:47], v[140:143]
  s_nop 1
  v_cndmask_b32 v5, v219, v218, vcc
  v_add_u32 v216, 11, v216
  v_mfma_f32_16x16x32_bf16 v[140:143], a[192:195], v[60:63], v[140:143]
  v_mul_u32_u24 v218, 384, v216
  v_add_u32 v218, v218, v217
  v_mfma_f32_16x16x32_bf16 v[140:143], a[196:199], v[76:79], v[140:143]
  v_cmp_gt_u32 vcc, 512, v216
  s_nop 1
  v_mfma_f32_16x16x32_bf16 v[140:143], a[200:203], v[92:95], v[140:143]
  v_cndmask_b32 v9, v219, v218, vcc
  v_cmp_gt_u32 vcc, 242, v211
  s_nop 1
  v_mfma_f32_16x16x32_bf16 v[140:143], a[204:207], v[108:111], v[140:143]
  v_cndmask_b32 v5, v219, v5, vcc
  v_cndmask_b32 v9, v219, v9, vcc
  ds_read_b128 a[160:163], v1 offset:24576
  ds_read_b128 a[164:167], v1 offset:25600
  ds_read_b128 a[168:171], v1 offset:26624
  ds_read_b128 a[172:175], v1 offset:27648
  ds_read_b128 a[176:179], v1 offset:28672
  ds_read_b128 a[180:183], v1 offset:29696
  ds_read_b128 a[184:187], v1 offset:30720
  ds_read_b128 a[188:191], v1 offset:31744
  ds_read_b128 a[192:195], v1 offset:32768
  ds_read_b128 a[196:199], v1 offset:33792
  ds_read_b128 a[200:203], v1 offset:34816
  ds_read_b128 a[204:207], v1 offset:35840
  v_cvt_pk_f16_f32 v208, v112, v113
  v_cvt_pk_f16_f32 v211, v114, v115
  v_cvt_pk_f16_f32 v214, v116, v117
  v_cvt_pk_f16_f32 v217, v118, v119
  v_pk_fma_f16 v209, v208, v208, s28
  v_pk_fma_f16 v212, v211, v211, s28
  v_pk_fma_f16 v215, v214, v214, s28
  v_pk_fma_f16 v218, v217, v217, s28
  v_pk_mul_f16 v209, v209, v208
  v_pk_mul_f16 v212, v212, v211
  v_pk_mul_f16 v215, v215, v214
  v_pk_mul_f16 v218, v218, v217
  v_exp_f16 v210, v209
  v_exp_f16 v213, v212
  v_exp_f16 v216, v215
  v_exp_f16 v219, v218
  v_exp_f16_sdwa v210, v209 dst_sel:WORD_1 dst_unused:UNUSED_PRESERVE src0_sel:WORD_1
  v_exp_f16_sdwa v213, v212 dst_sel:WORD_1 dst_unused:UNUSED_PRESERVE src0_sel:WORD_1
  v_exp_f16_sdwa v216, v215 dst_sel:WORD_1 dst_unused:UNUSED_PRESERVE src0_sel:WORD_1
  v_exp_f16_sdwa v219, v218 dst_sel:WORD_1 dst_unused:UNUSED_PRESERVE src0_sel:WORD_1
  v_pk_fma_f16 v210, v210, s56, s56
  v_pk_fma_f16 v213, v213, s56, s56
  v_pk_fma_f16 v216, v216, s56, s56
  v_pk_fma_f16 v219, v219, s56, s56
  v_rcp_f16 v209, v210
  v_rcp_f16 v212, v213
  v_rcp_f16 v215, v216
  v_rcp_f16 v218, v219
  v_rcp_f16_sdwa v209, v210 dst_sel:WORD_1 dst_unused:UNUSED_PRESERVE src0_sel:WORD_1
  v_rcp_f16_sdwa v212, v213 dst_sel:WORD_1 dst_unused:UNUSED_PRESERVE src0_sel:WORD_1
  v_rcp_f16_sdwa v215, v216 dst_sel:WORD_1 dst_unused:UNUSED_PRESERVE src0_sel:WORD_1
  v_rcp_f16_sdwa v218, v219 dst_sel:WORD_1 dst_unused:UNUSED_PRESERVE src0_sel:WORD_1
  v_pk_mul_f16 v176, v208, v209
  v_pk_mul_f16 v177, v211, v212
  v_pk_mul_f16 v180, v214, v215
  v_pk_mul_f16 v181, v217, v218
  v_cvt_pk_f16_f32 v208, v120, v121
  v_cvt_pk_f16_f32 v211, v122, v123
  v_cvt_pk_f16_f32 v214, v124, v125
  v_cvt_pk_f16_f32 v217, v126, v127
  v_pk_fma_f16 v209, v208, v208, s28
  v_pk_fma_f16 v212, v211, v211, s28
  v_pk_fma_f16 v215, v214, v214, s28
  v_pk_fma_f16 v218, v217, v217, s28
  v_pk_mul_f16 v209, v209, v208
  v_pk_mul_f16 v212, v212, v211
  v_pk_mul_f16 v215, v215, v214
  v_pk_mul_f16 v218, v218, v217
  v_exp_f16 v210, v209
  v_exp_f16 v213, v212
  v_exp_f16 v216, v215
  v_exp_f16 v219, v218
  v_exp_f16_sdwa v210, v209 dst_sel:WORD_1 dst_unused:UNUSED_PRESERVE src0_sel:WORD_1
  v_exp_f16_sdwa v213, v212 dst_sel:WORD_1 dst_unused:UNUSED_PRESERVE src0_sel:WORD_1
  v_exp_f16_sdwa v216, v215 dst_sel:WORD_1 dst_unused:UNUSED_PRESERVE src0_sel:WORD_1
  v_exp_f16_sdwa v219, v218 dst_sel:WORD_1 dst_unused:UNUSED_PRESERVE src0_sel:WORD_1
  v_pk_fma_f16 v210, v210, s56, s56
  v_pk_fma_f16 v213, v213, s56, s56
  v_pk_fma_f16 v216, v216, s56, s56
  v_pk_fma_f16 v219, v219, s56, s56
  v_rcp_f16 v209, v210
  v_rcp_f16 v212, v213
  v_rcp_f16 v215, v216
  v_rcp_f16 v218, v219
  v_rcp_f16_sdwa v209, v210 dst_sel:WORD_1 dst_unused:UNUSED_PRESERVE src0_sel:WORD_1
  v_rcp_f16_sdwa v212, v213 dst_sel:WORD_1 dst_unused:UNUSED_PRESERVE src0_sel:WORD_1
  v_rcp_f16_sdwa v215, v216 dst_sel:WORD_1 dst_unused:UNUSED_PRESERVE src0_sel:WORD_1
  v_rcp_f16_sdwa v218, v219 dst_sel:WORD_1 dst_unused:UNUSED_PRESERVE src0_sel:WORD_1
  v_pk_mul_f16 v184, v208, v209
  v_pk_mul_f16 v185, v211, v212
  v_pk_mul_f16 v188, v214, v215
  v_pk_mul_f16 v189, v217, v218
  s_waitcnt lgkmcnt(0)
  s_waitcnt vmcnt(0)
  s_barrier
  v_mfma_f32_16x16x32_bf16 v[144:147], a[160:163], v[16:19], 0
  v_cvt_pk_f16_f32 v208, v128, v129
  v_cvt_pk_f16_f32 v211, v130, v131
  v_cvt_pk_f16_f32 v214, v132, v133
  v_mfma_f32_16x16x32_bf16 v[144:147], a[164:167], v[32:35], v[144:147]
  s_add_u32 m0, s29, 24576
  v_cvt_pk_f16_f32 v217, v134, v135
  v_pk_fma_f16 v209, v208, v208, s28
  v_mfma_f32_16x16x32_bf16 v[144:147], a[168:171], v[48:51], v[144:147]
  buffer_load_dwordx4 v1, s[16:19], s20 offen offset:0 lds
  v_pk_fma_f16 v212, v211, v211, s28
  v_mfma_f32_16x16x32_bf16 v[144:147], a[172:175], v[64:67], v[144:147]
  v_pk_fma_f16 v215, v214, v214, s28
  v_pk_fma_f16 v218, v217, v217, s28
  v_mfma_f32_16x16x32_bf16 v[144:147], a[176:179], v[80:83], v[144:147]
  v_pk_mul_f16 v209, v209, v208
  v_pk_mul_f16 v212, v212, v211
  v_pk_mul_f16 v215, v215, v214
  v_mfma_f32_16x16x32_bf16 v[144:147], a[180:183], v[96:99], v[144:147]
  v_pk_mul_f16 v218, v218, v217
  v_exp_f16 v210, v209
  v_mfma_f32_16x16x32_bf16 v[148:151], a[160:163], v[20:23], 0
  buffer_load_dwordx4 v1, s[16:19], s20 offen offset:1024 lds
  v_mfma_f32_16x16x32_bf16 v[148:151], a[164:167], v[36:39], v[148:151]
  v_exp_f16 v213, v212
  v_mfma_f32_16x16x32_bf16 v[148:151], a[168:171], v[52:55], v[148:151]
  v_exp_f16 v216, v215
  v_mfma_f32_16x16x32_bf16 v[148:151], a[172:175], v[68:71], v[148:151]
  v_exp_f16 v219, v218
  v_mfma_f32_16x16x32_bf16 v[148:151], a[176:179], v[84:87], v[148:151]
  buffer_load_dwordx4 v1, s[16:19], s20 offen offset:2048 lds
  v_exp_f16_sdwa v210, v209 dst_sel:WORD_1 dst_unused:UNUSED_PRESERVE src0_sel:WORD_1
  v_mfma_f32_16x16x32_bf16 v[148:151], a[180:183], v[100:103], v[148:151]
  v_exp_f16_sdwa v213, v212 dst_sel:WORD_1 dst_unused:UNUSED_PRESERVE src0_sel:WORD_1
  v_mfma_f32_16x16x32_bf16 v[152:155], a[160:163], v[24:27], 0
  v_exp_f16_sdwa v216, v215 dst_sel:WORD_1 dst_unused:UNUSED_PRESERVE src0_sel:WORD_1
  v_mfma_f32_16x16x32_bf16 v[152:155], a[164:167], v[40:43], v[152:155]
  v_exp_f16_sdwa v219, v218 dst_sel:WORD_1 dst_unused:UNUSED_PRESERVE src0_sel:WORD_1
  v_pk_fma_f16 v210, v210, s56, s56
  v_mfma_f32_16x16x32_bf16 v[152:155], a[168:171], v[56:59], v[152:155]
  buffer_load_dwordx4 v1, s[16:19], s20 offen offset:3072 lds
  v_pk_fma_f16 v213, v213, s56, s56
  v_mfma_f32_16x16x32_bf16 v[152:155], a[172:175], v[72:75], v[152:155]
  v_pk_fma_f16 v216, v216, s56, s56
  v_pk_fma_f16 v219, v219, s56, s56
  v_mfma_f32_16x16x32_bf16 v[152:155], a[176:179], v[88:91], v[152:155]
  v_rcp_f16 v209, v210
  v_mfma_f32_16x16x32_bf16 v[152:155], a[180:183], v[104:107], v[152:155]
  s_add_u32 m0, s29, 28672
  s_add_u32 s20, s20, 4096
  v_rcp_f16 v212, v213
  v_mfma_f32_16x16x32_bf16 v[156:159], a[160:163], v[28:31], 0
  buffer_load_dwordx4 v1, s[16:19], s20 offen offset:0 lds
  v_mfma_f32_16x16x32_bf16 v[156:159], a[164:167], v[44:47], v[156:159]
  v_rcp_f16 v215, v216
  v_mfma_f32_16x16x32_bf16 v[156:159], a[168:171], v[60:63], v[156:159]
  v_rcp_f16 v218, v219
  v_rcp_f16_sdwa v209, v210 dst_sel:WORD_1 dst_unused:UNUSED_PRESERVE src0_sel:WORD_1
  v_mfma_f32_16x16x32_bf16 v[156:159], a[172:175], v[76:79], v[156:159]
  v_rcp_f16_sdwa v212, v213 dst_sel:WORD_1 dst_unused:UNUSED_PRESERVE src0_sel:WORD_1
  v_mfma_f32_16x16x32_bf16 v[156:159], a[176:179], v[92:95], v[156:159]
  buffer_load_dwordx4 v1, s[16:19], s20 offen offset:1024 lds
  v_mfma_f32_16x16x32_bf16 v[156:159], a[180:183], v[108:111], v[156:159]
  s_add_u32 s20, s20, 20480
  v_rcp_f16_sdwa v215, v216 dst_sel:WORD_1 dst_unused:UNUSED_PRESERVE src0_sel:WORD_1
  v_rcp_f16_sdwa v218, v219 dst_sel:WORD_1 dst_unused:UNUSED_PRESERVE src0_sel:WORD_1
  v_mfma_f32_16x16x32_bf16 v[160:163], a[184:187], v[16:19], 0
  v_pk_mul_f16 v178, v208, v209
  v_pk_mul_f16 v179, v211, v212
  v_mfma_f32_16x16x32_bf16 v[160:163], a[188:191], v[32:35], v[160:163]
  v_pk_mul_f16 v182, v214, v215
  v_pk_mul_f16 v183, v217, v218
  v_cvt_pk_f16_f32 v208, v136, v137
  v_mfma_f32_16x16x32_bf16 v[160:163], a[192:195], v[48:51], v[160:163]
  v_cvt_pk_f16_f32 v211, v138, v139
  v_cvt_pk_f16_f32 v214, v140, v141
  v_mfma_f32_16x16x32_bf16 v[160:163], a[196:199], v[64:67], v[160:163]
  v_cvt_pk_f16_f32 v217, v142, v143
  v_pk_fma_f16 v209, v208, v208, s28
  v_pk_fma_f16 v212, v211, v211, s28
  v_mfma_f32_16x16x32_bf16 v[160:163], a[200:203], v[80:83], v[160:163]
  v_pk_fma_f16 v215, v214, v214, s28
  v_pk_fma_f16 v218, v217, v217, s28
  v_mfma_f32_16x16x32_bf16 v[160:163], a[204:207], v[96:99], v[160:163]
  v_pk_mul_f16 v209, v209, v208
  v_pk_mul_f16 v212, v212, v211
  v_pk_mul_f16 v215, v215, v214
  v_mfma_f32_16x16x32_bf16 v[164:167], a[184:187], v[20:23], 0
  ds_read_b128 a[208:211], v1 offset:12288
  v_pk_mul_f16 v218, v218, v217
  v_mfma_f32_16x16x32_bf16 v[164:167], a[188:191], v[36:39], v[164:167]
  v_exp_f16 v210, v209
  v_mfma_f32_16x16x32_bf16 v[164:167], a[192:195], v[52:55], v[164:167]
  v_exp_f16 v213, v212
  v_mfma_f32_16x16x32_bf16 v[164:167], a[196:199], v[68:71], v[164:167]
  v_exp_f16 v216, v215
  v_exp_f16 v219, v218
  v_mfma_f32_16x16x32_bf16 v[164:167], a[200:203], v[84:87], v[164:167]
  ds_read_b128 a[212:215], v1 offset:13312
  v_exp_f16_sdwa v210, v209 dst_sel:WORD_1 dst_unused:UNUSED_PRESERVE src0_sel:WORD_1
  v_mfma_f32_16x16x32_bf16 v[164:167], a[204:207], v[100:103], v[164:167]
  v_exp_f16_sdwa v213, v212 dst_sel:WORD_1 dst_unused:UNUSED_PRESERVE src0_sel:WORD_1
  v_mfma_f32_16x16x32_bf16 v[168:171], a[184:187], v[24:27], 0
  v_exp_f16_sdwa v216, v215 dst_sel:WORD_1 dst_unused:UNUSED_PRESERVE src0_sel:WORD_1
  v_mfma_f32_16x16x32_bf16 v[168:171], a[188:191], v[40:43], v[168:171]
  v_exp_f16_sdwa v219, v218 dst_sel:WORD_1 dst_unused:UNUSED_PRESERVE src0_sel:WORD_1
  v_pk_fma_f16 v210, v210, s56, s56
  v_mfma_f32_16x16x32_bf16 v[168:171], a[192:195], v[56:59], v[168:171]
  ds_read_b128 a[216:219], v1 offset:14336
  v_pk_fma_f16 v213, v213, s56, s56
  v_mfma_f32_16x16x32_bf16 v[168:171], a[196:199], v[72:75], v[168:171]
  v_pk_fma_f16 v216, v216, s56, s56
  v_pk_fma_f16 v219, v219, s56, s56
  v_mfma_f32_16x16x32_bf16 v[168:171], a[200:203], v[88:91], v[168:171]
  v_rcp_f16 v209, v210
  v_mfma_f32_16x16x32_bf16 v[168:171], a[204:207], v[104:107], v[168:171]
  v_rcp_f16 v212, v213
  v_rcp_f16 v215, v216
  v_mfma_f32_16x16x32_bf16 v[172:175], a[184:187], v[28:31], 0
  ds_read_b128 a[220:223], v1 offset:15360
  v_rcp_f16 v218, v219
  v_mfma_f32_16x16x32_bf16 v[172:175], a[188:191], v[44:47], v[172:175]
  v_rcp_f16_sdwa v209, v210 dst_sel:WORD_1 dst_unused:UNUSED_PRESERVE src0_sel:WORD_1
  v_mfma_f32_16x16x32_bf16 v[172:175], a[192:195], v[60:63], v[172:175]
  v_rcp_f16_sdwa v212, v213 dst_sel:WORD_1 dst_unused:UNUSED_PRESERVE src0_sel:WORD_1
  v_mfma_f32_16x16x32_bf16 v[172:175], a[196:199], v[76:79], v[172:175]
  v_rcp_f16_sdwa v215, v216 dst_sel:WORD_1 dst_unused:UNUSED_PRESERVE src0_sel:WORD_1
  v_mfma_f32_16x16x32_bf16 v[172:175], a[200:203], v[92:95], v[172:175]
  v_rcp_f16_sdwa v218, v219 dst_sel:WORD_1 dst_unused:UNUSED_PRESERVE src0_sel:WORD_1
  v_pk_mul_f16 v186, v208, v209
  v_mfma_f32_16x16x32_bf16 v[172:175], a[204:207], v[108:111], v[172:175]
  v_pk_mul_f16 v187, v211, v212
  v_pk_mul_f16 v190, v214, v215
  v_pk_mul_f16 v191, v217, v218
  s_waitcnt lgkmcnt(3)
  v_mfma_f32_16x16x32_f16 a[0:3], v[176:179], a[208:211], 0
  v_cvt_pk_f16_f32 v208, v144, v145
  v_cvt_pk_f16_f32 v211, v146, v147
  v_cvt_pk_f16_f32 v214, v148, v149
  v_mfma_f32_16x16x32_f16 a[4:7], v[180:183], a[208:211], 0
  ds_read_b128 a[160:163], v1 offset:0
  v_cvt_pk_f16_f32 v217, v150, v151
  v_mfma_f32_16x16x32_f16 a[8:11], v[184:187], a[208:211], 0
  v_pk_fma_f16 v209, v208, v208, s28
  v_pk_fma_f16 v212, v211, v211, s28
  v_pk_fma_f16 v215, v214, v214, s28
  v_mfma_f32_16x16x32_f16 a[12:15], v[188:191], a[208:211], 0
  s_waitcnt lgkmcnt(3)
  ds_read_b128 a[208:211], v1 offset:16384
  v_pk_fma_f16 v218, v217, v217, s28
  v_mfma_f32_16x16x32_f16 a[16:19], v[176:179], a[212:215], 0
  ds_read_b128 a[164:167], v1 offset:1024
  v_pk_mul_f16 v209, v209, v208
  v_pk_mul_f16 v212, v212, v211
  v_mfma_f32_16x16x32_f16 a[20:23], v[180:183], a[212:215], 0
  v_pk_mul_f16 v215, v215, v214
  v_pk_mul_f16 v218, v218, v217
  v_mfma_f32_16x16x32_f16 a[24:27], v[184:187], a[212:215], 0
  v_exp_f16 v210, v209
  v_mfma_f32_16x16x32_f16 a[28:31], v[188:191], a[212:215], 0
  s_waitcnt lgkmcnt(4)
  ds_read_b128 a[212:215], v1 offset:17408
  v_exp_f16 v213, v212
  v_mfma_f32_16x16x32_f16 a[32:35], v[176:179], a[216:219], 0
  ds_read_b128 a[168:171], v1 offset:2048
  v_exp_f16 v216, v215
  v_mfma_f32_16x16x32_f16 a[36:39], v[180:183], a[216:219], 0
  v_exp_f16 v219, v218
  v_mfma_f32_16x16x32_f16 a[40:43], v[184:187], a[216:219], 0
  ds_read_b128 a[172:175], v1 offset:3072
  v_exp_f16_sdwa v210, v209 dst_sel:WORD_1 dst_unused:UNUSED_PRESERVE src0_sel:WORD_1
  v_mfma_f32_16x16x32_f16 a[44:47], v[188:191], a[216:219], 0
  s_waitcnt lgkmcnt(6)
  ds_read_b128 a[216:219], v1 offset:18432
  v_exp_f16_sdwa v213, v212 dst_sel:WORD_1 dst_unused:UNUSED_PRESERVE src0_sel:WORD_1
  v_mfma_f32_16x16x32_f16 a[48:51], v[176:179], a[220:223], 0
  v_exp_f16_sdwa v216, v215 dst_sel:WORD_1 dst_unused:UNUSED_PRESERVE src0_sel:WORD_1
  v_mfma_f32_16x16x32_f16 a[52:55], v[180:183], a[220:223], 0
  ds_read_b128 a[176:179], v1 offset:4096
  v_exp_f16_sdwa v219, v218 dst_sel:WORD_1 dst_unused:UNUSED_PRESERVE src0_sel:WORD_1
  v_mfma_f32_16x16x32_f16 a[56:59], v[184:187], a[220:223], 0
  v_pk_fma_f16 v210, v210, s56, s56
  v_pk_fma_f16 v213, v213, s56, s56
  v_pk_fma_f16 v216, v216, s56, s56
  v_mfma_f32_16x16x32_f16 a[60:63], v[188:191], a[220:223], 0
  s_waitcnt lgkmcnt(6)
  ds_read_b128 a[220:223], v1 offset:19456
  v_pk_fma_f16 v219, v219, s56, s56
  v_mfma_f32_16x16x32_f16 a[64:67], v[176:179], a[208:211], 0
  ds_read_b128 a[180:183], v1 offset:5120
  v_rcp_f16 v209, v210
  v_mfma_f32_16x16x32_f16 a[68:71], v[180:183], a[208:211], 0
  v_rcp_f16 v212, v213
  v_mfma_f32_16x16x32_f16 a[72:75], v[184:187], a[208:211], 0
  v_rcp_f16 v215, v216
  v_mfma_f32_16x16x32_f16 a[76:79], v[188:191], a[208:211], 0
  s_waitcnt lgkmcnt(6)
  ds_read_b128 a[208:211], v1 offset:20480
  v_rcp_f16 v218, v219
  v_mfma_f32_16x16x32_f16 a[80:83], v[176:179], a[212:215], 0
  ds_read_b128 a[184:187], v1 offset:6144
  v_rcp_f16_sdwa v209, v210 dst_sel:WORD_1 dst_unused:UNUSED_PRESERVE src0_sel:WORD_1
  v_mfma_f32_16x16x32_f16 a[84:87], v[180:183], a[212:215], 0
  v_rcp_f16_sdwa v212, v213 dst_sel:WORD_1 dst_unused:UNUSED_PRESERVE src0_sel:WORD_1
  v_mfma_f32_16x16x32_f16 a[88:91], v[184:187], a[212:215], 0
  ds_read_b128 a[188:191], v1 offset:7168
  v_rcp_f16_sdwa v215, v216 dst_sel:WORD_1 dst_unused:UNUSED_PRESERVE src0_sel:WORD_1
  v_mfma_f32_16x16x32_f16 a[92:95], v[188:191], a[212:215], 0
  s_waitcnt lgkmcnt(6)
  ds_read_b128 a[212:215], v1 offset:21504
  v_rcp_f16_sdwa v218, v219 dst_sel:WORD_1 dst_unused:UNUSED_PRESERVE src0_sel:WORD_1
  v_mfma_f32_16x16x32_f16 a[96:99], v[176:179], a[216:219], 0
  v_pk_mul_f16 v192, v208, v209
  v_pk_mul_f16 v193, v211, v212
  v_pk_mul_f16 v196, v214, v215
  v_mfma_f32_16x16x32_f16 a[100:103], v[180:183], a[216:219], 0
  ds_read_b128 a[192:195], v1 offset:8192
  v_pk_mul_f16 v197, v217, v218
  v_mfma_f32_16x16x32_f16 a[104:107], v[184:187], a[216:219], 0
  v_cvt_pk_f16_f32 v208, v152, v153
  v_cvt_pk_f16_f32 v211, v154, v155
  v_cvt_pk_f16_f32 v214, v156, v157
  v_mfma_f32_16x16x32_f16 a[108:111], v[188:191], a[216:219], 0
  s_waitcnt lgkmcnt(6)
  ds_read_b128 a[216:219], v1 offset:22528
  v_cvt_pk_f16_f32 v217, v158, v159
  v_mfma_f32_16x16x32_f16 a[112:115], v[176:179], a[220:223], 0
  ds_read_b128 a[196:199], v1 offset:9216
  v_pk_fma_f16 v209, v208, v208, s28
  v_pk_fma_f16 v212, v211, v211, s28
  v_mfma_f32_16x16x32_f16 a[116:119], v[180:183], a[220:223], 0
  v_pk_fma_f16 v215, v214, v214, s28
  v_pk_fma_f16 v218, v217, v217, s28
  v_pk_mul_f16 v209, v209, v208
  v_mfma_f32_16x16x32_f16 a[120:123], v[184:187], a[220:223], 0
  v_pk_mul_f16 v212, v212, v211
  v_pk_mul_f16 v215, v215, v214
  v_mfma_f32_16x16x32_f16 a[124:127], v[188:191], a[220:223], 0
  s_waitcnt lgkmcnt(6)
  ds_read_b128 a[220:223], v1 offset:23552
  v_pk_mul_f16 v218, v218, v217
  v_mfma_f32_16x16x32_f16 a[128:131], v[176:179], a[208:211], 0
  ds_read_b128 a[200:203], v1 offset:10240
  v_exp_f16 v210, v209
  v_mfma_f32_16x16x32_f16 a[132:135], v[180:183], a[208:211], 0
  v_exp_f16 v213, v212
  v_mfma_f32_16x16x32_f16 a[136:139], v[184:187], a[208:211], 0
  ds_read_b128 a[204:207], v1 offset:11264
  v_exp_f16 v216, v215
  v_mfma_f32_16x16x32_f16 a[140:143], v[188:191], a[208:211], 0
  s_waitcnt lgkmcnt(6)
  v_exp_f16 v219, v218
  v_mfma_f32_16x16x32_f16 a[144:147], v[176:179], a[212:215], 0
  v_exp_f16_sdwa v210, v209 dst_sel:WORD_1 dst_unused:UNUSED_PRESERVE src0_sel:WORD_1
  v_exp_f16_sdwa v213, v212 dst_sel:WORD_1 dst_unused:UNUSED_PRESERVE src0_sel:WORD_1
  v_mfma_f32_16x16x32_f16 a[148:151], v[180:183], a[212:215], 0
  v_exp_f16_sdwa v216, v215 dst_sel:WORD_1 dst_unused:UNUSED_PRESERVE src0_sel:WORD_1
  v_mfma_f32_16x16x32_f16 a[152:155], v[184:187], a[212:215], 0
  v_exp_f16_sdwa v219, v218 dst_sel:WORD_1 dst_unused:UNUSED_PRESERVE src0_sel:WORD_1
  v_pk_fma_f16 v210, v210, s56, s56
  v_mfma_f32_16x16x32_f16 a[156:159], v[188:191], a[212:215], 0
  s_waitcnt lgkmcnt(4)
  v_pk_fma_f16 v213, v213, s56, s56
  v_pk_fma_f16 v216, v216, s56, s56
  v_mfma_f32_16x16x32_f16 v[224:227], v[176:179], a[216:219], 0
  v_pk_fma_f16 v219, v219, s56, s56
  v_rcp_f16 v209, v210
  v_mfma_f32_16x16x32_f16 v[228:231], v[180:183], a[216:219], 0
  v_rcp_f16 v212, v213
  v_mfma_f32_16x16x32_f16 v[232:235], v[184:187], a[216:219], 0
  v_rcp_f16 v215, v216
  v_mfma_f32_16x16x32_f16 v[236:239], v[188:191], a[216:219], 0
  s_waitcnt lgkmcnt(2)
  v_rcp_f16 v218, v219
  v_rcp_f16_sdwa v209, v210 dst_sel:WORD_1 dst_unused:UNUSED_PRESERVE src0_sel:WORD_1
  v_mfma_f32_16x16x32_f16 v[240:243], v[176:179], a[220:223], 0
  v_rcp_f16_sdwa v212, v213 dst_sel:WORD_1 dst_unused:UNUSED_PRESERVE src0_sel:WORD_1
  v_mfma_f32_16x16x32_f16 v[244:247], v[180:183], a[220:223], 0
  v_rcp_f16_sdwa v215, v216 dst_sel:WORD_1 dst_unused:UNUSED_PRESERVE src0_sel:WORD_1
  v_mfma_f32_16x16x32_f16 v[248:251], v[184:187], a[220:223], 0
  v_rcp_f16_sdwa v218, v219 dst_sel:WORD_1 dst_unused:UNUSED_PRESERVE src0_sel:WORD_1
  v_pk_mul_f16 v200, v208, v209
  v_mfma_f32_16x16x32_f16 v[252:255], v[188:191], a[220:223], 0
  v_pk_mul_f16 v201, v211, v212
  v_pk_mul_f16 v204, v214, v215
  v_pk_mul_f16 v205, v217, v218
  s_waitcnt lgkmcnt(0)
  s_waitcnt vmcnt(0)
  s_barrier
  v_mfma_f32_16x16x32_bf16 v[112:115], a[160:163], v[16:19], 0
  v_cvt_pk_f16_f32 v208, v160, v161
  v_cvt_pk_f16_f32 v211, v162, v163
  v_cvt_pk_f16_f32 v214, v164, v165
  v_mfma_f32_16x16x32_bf16 v[112:115], a[164:167], v[32:35], v[112:115]
  s_add_u32 m0, s29, 0
  v_cvt_pk_f16_f32 v217, v166, v167
  v_pk_fma_f16 v209, v208, v208, s28
  v_mfma_f32_16x16x32_bf16 v[112:115], a[168:171], v[48:51], v[112:115]
  buffer_load_dwordx4 v1, s[16:19], s20 offen offset:0 lds
  v_pk_fma_f16 v212, v211, v211, s28
  v_mfma_f32_16x16x32_bf16 v[112:115], a[172:175], v[64:67], v[112:115]
  v_pk_fma_f16 v215, v214, v214, s28
  v_pk_fma_f16 v218, v217, v217, s28
  v_mfma_f32_16x16x32_bf16 v[112:115], a[176:179], v[80:83], v[112:115]
  v_pk_mul_f16 v209, v209, v208
  v_pk_mul_f16 v212, v212, v211
  v_pk_mul_f16 v215, v215, v214
  v_mfma_f32_16x16x32_bf16 v[112:115], a[180:183], v[96:99], v[112:115]
  v_pk_mul_f16 v218, v218, v217
  v_exp_f16 v210, v209
  v_mfma_f32_16x16x32_bf16 v[116:119], a[160:163], v[20:23], 0
  buffer_load_dwordx4 v1, s[16:19], s20 offen offset:1024 lds
  v_mfma_f32_16x16x32_bf16 v[116:119], a[164:167], v[36:39], v[116:119]
  v_exp_f16 v213, v212
  v_mfma_f32_16x16x32_bf16 v[116:119], a[168:171], v[52:55], v[116:119]
  v_exp_f16 v216, v215
  v_mfma_f32_16x16x32_bf16 v[116:119], a[172:175], v[68:71], v[116:119]
  v_exp_f16 v219, v218
  v_mfma_f32_16x16x32_bf16 v[116:119], a[176:179], v[84:87], v[116:119]
  buffer_load_dwordx4 v1, s[16:19], s20 offen offset:2048 lds
  v_exp_f16_sdwa v210, v209 dst_sel:WORD_1 dst_unused:UNUSED_PRESERVE src0_sel:WORD_1
  v_mfma_f32_16x16x32_bf16 v[116:119], a[180:183], v[100:103], v[116:119]
  v_exp_f16_sdwa v213, v212 dst_sel:WORD_1 dst_unused:UNUSED_PRESERVE src0_sel:WORD_1
  v_mfma_f32_16x16x32_bf16 v[120:123], a[160:163], v[24:27], 0
  v_exp_f16_sdwa v216, v215 dst_sel:WORD_1 dst_unused:UNUSED_PRESERVE src0_sel:WORD_1
  v_mfma_f32_16x16x32_bf16 v[120:123], a[164:167], v[40:43], v[120:123]
  v_exp_f16_sdwa v219, v218 dst_sel:WORD_1 dst_unused:UNUSED_PRESERVE src0_sel:WORD_1
  v_pk_fma_f16 v210, v210, s56, s56
  v_mfma_f32_16x16x32_bf16 v[120:123], a[168:171], v[56:59], v[120:123]
  buffer_load_dwordx4 v1, s[16:19], s20 offen offset:3072 lds
  v_pk_fma_f16 v213, v213, s56, s56
  v_mfma_f32_16x16x32_bf16 v[120:123], a[172:175], v[72:75], v[120:123]
  v_pk_fma_f16 v216, v216, s56, s56
  v_pk_fma_f16 v219, v219, s56, s56
  v_mfma_f32_16x16x32_bf16 v[120:123], a[176:179], v[88:91], v[120:123]
  v_rcp_f16 v209, v210
  v_mfma_f32_16x16x32_bf16 v[120:123], a[180:183], v[104:107], v[120:123]
  s_add_u32 m0, s29, 4096
  s_add_u32 s20, s20, 4096
  v_rcp_f16 v212, v213
  v_mfma_f32_16x16x32_bf16 v[124:127], a[160:163], v[28:31], 0
  buffer_load_dwordx4 v1, s[16:19], s20 offen offset:0 lds
  v_mfma_f32_16x16x32_bf16 v[124:127], a[164:167], v[44:47], v[124:127]
  v_rcp_f16 v215, v216
  v_mfma_f32_16x16x32_bf16 v[124:127], a[168:171], v[60:63], v[124:127]
  v_rcp_f16 v218, v219
  v_rcp_f16_sdwa v209, v210 dst_sel:WORD_1 dst_unused:UNUSED_PRESERVE src0_sel:WORD_1
  v_mfma_f32_16x16x32_bf16 v[124:127], a[172:175], v[76:79], v[124:127]
  v_rcp_f16_sdwa v212, v213 dst_sel:WORD_1 dst_unused:UNUSED_PRESERVE src0_sel:WORD_1
  v_mfma_f32_16x16x32_bf16 v[124:127], a[176:179], v[92:95], v[124:127]
  buffer_load_dwordx4 v1, s[16:19], s20 offen offset:1024 lds
  v_mfma_f32_16x16x32_bf16 v[124:127], a[180:183], v[108:111], v[124:127]
  s_add_u32 s20, s20, 20480
  v_rcp_f16_sdwa v215, v216 dst_sel:WORD_1 dst_unused:UNUSED_PRESERVE src0_sel:WORD_1
  v_rcp_f16_sdwa v218, v219 dst_sel:WORD_1 dst_unused:UNUSED_PRESERVE src0_sel:WORD_1
  v_mfma_f32_16x16x32_bf16 v[128:131], a[184:187], v[16:19], 0
  v_pk_mul_f16 v194, v208, v209
  v_pk_mul_f16 v195, v211, v212
  v_mfma_f32_16x16x32_bf16 v[128:131], a[188:191], v[32:35], v[128:131]
  v_pk_mul_f16 v198, v214, v215
  v_pk_mul_f16 v199, v217, v218
  v_cvt_pk_f16_f32 v208, v168, v169
  v_mfma_f32_16x16x32_bf16 v[128:131], a[192:195], v[48:51], v[128:131]
  v_cvt_pk_f16_f32 v211, v170, v171
  v_cvt_pk_f16_f32 v214, v172, v173
  v_mfma_f32_16x16x32_bf16 v[128:131], a[196:199], v[64:67], v[128:131]
  v_cvt_pk_f16_f32 v217, v174, v175
  v_pk_fma_f16 v209, v208, v208, s28
  v_pk_fma_f16 v212, v211, v211, s28
  v_mfma_f32_16x16x32_bf16 v[128:131], a[200:203], v[80:83], v[128:131]
  v_pk_fma_f16 v215, v214, v214, s28
  v_pk_fma_f16 v218, v217, v217, s28
  v_mfma_f32_16x16x32_bf16 v[128:131], a[204:207], v[96:99], v[128:131]
  v_pk_mul_f16 v209, v209, v208
  v_pk_mul_f16 v212, v212, v211
  v_pk_mul_f16 v215, v215, v214
  v_mfma_f32_16x16x32_bf16 v[132:135], a[184:187], v[20:23], 0
  ds_read_b128 a[208:211], v1 offset:36864
  v_pk_mul_f16 v218, v218, v217
  v_mfma_f32_16x16x32_bf16 v[132:135], a[188:191], v[36:39], v[132:135]
  v_exp_f16 v210, v209
  v_mfma_f32_16x16x32_bf16 v[132:135], a[192:195], v[52:55], v[132:135]
  v_exp_f16 v213, v212
  v_mfma_f32_16x16x32_bf16 v[132:135], a[196:199], v[68:71], v[132:135]
  v_exp_f16 v216, v215
  v_exp_f16 v219, v218
  v_mfma_f32_16x16x32_bf16 v[132:135], a[200:203], v[84:87], v[132:135]
  ds_read_b128 a[212:215], v1 offset:37888
  v_exp_f16_sdwa v210, v209 dst_sel:WORD_1 dst_unused:UNUSED_PRESERVE src0_sel:WORD_1
  v_mfma_f32_16x16x32_bf16 v[132:135], a[204:207], v[100:103], v[132:135]
  v_exp_f16_sdwa v213, v212 dst_sel:WORD_1 dst_unused:UNUSED_PRESERVE src0_sel:WORD_1
  v_mfma_f32_16x16x32_bf16 v[136:139], a[184:187], v[24:27], 0
  v_exp_f16_sdwa v216, v215 dst_sel:WORD_1 dst_unused:UNUSED_PRESERVE src0_sel:WORD_1
  v_mfma_f32_16x16x32_bf16 v[136:139], a[188:191], v[40:43], v[136:139]
  v_exp_f16_sdwa v219, v218 dst_sel:WORD_1 dst_unused:UNUSED_PRESERVE src0_sel:WORD_1
  v_pk_fma_f16 v210, v210, s56, s56
  v_mfma_f32_16x16x32_bf16 v[136:139], a[192:195], v[56:59], v[136:139]
  ds_read_b128 a[216:219], v1 offset:38912
  v_pk_fma_f16 v213, v213, s56, s56
  v_mfma_f32_16x16x32_bf16 v[136:139], a[196:199], v[72:75], v[136:139]
  v_pk_fma_f16 v216, v216, s56, s56
  v_pk_fma_f16 v219, v219, s56, s56
  v_mfma_f32_16x16x32_bf16 v[136:139], a[200:203], v[88:91], v[136:139]
  v_rcp_f16 v209, v210
  v_mfma_f32_16x16x32_bf16 v[136:139], a[204:207], v[104:107], v[136:139]
  v_rcp_f16 v212, v213
  v_rcp_f16 v215, v216
  v_mfma_f32_16x16x32_bf16 v[140:143], a[184:187], v[28:31], 0
  ds_read_b128 a[220:223], v1 offset:39936
  v_rcp_f16 v218, v219
  v_mfma_f32_16x16x32_bf16 v[140:143], a[188:191], v[44:47], v[140:143]
  v_rcp_f16_sdwa v209, v210 dst_sel:WORD_1 dst_unused:UNUSED_PRESERVE src0_sel:WORD_1
  v_mfma_f32_16x16x32_bf16 v[140:143], a[192:195], v[60:63], v[140:143]
  v_rcp_f16_sdwa v212, v213 dst_sel:WORD_1 dst_unused:UNUSED_PRESERVE src0_sel:WORD_1
  v_mfma_f32_16x16x32_bf16 v[140:143], a[196:199], v[76:79], v[140:143]
  v_rcp_f16_sdwa v215, v216 dst_sel:WORD_1 dst_unused:UNUSED_PRESERVE src0_sel:WORD_1
  v_mfma_f32_16x16x32_bf16 v[140:143], a[200:203], v[92:95], v[140:143]
  v_rcp_f16_sdwa v218, v219 dst_sel:WORD_1 dst_unused:UNUSED_PRESERVE src0_sel:WORD_1
  v_pk_mul_f16 v202, v208, v209
  v_mfma_f32_16x16x32_bf16 v[140:143], a[204:207], v[108:111], v[140:143]
  v_pk_mul_f16 v203, v211, v212
  v_pk_mul_f16 v206, v214, v215
  v_pk_mul_f16 v207, v217, v218
  s_waitcnt lgkmcnt(3)
  v_mfma_f32_16x16x32_f16 a[0:3], v[192:195], a[208:211], a[0:3]
  v_cvt_pk_f16_f32 v208, v112, v113
  v_cvt_pk_f16_f32 v211, v114, v115
  v_cvt_pk_f16_f32 v214, v116, v117
  v_mfma_f32_16x16x32_f16 a[4:7], v[196:199], a[208:211], a[4:7]
  ds_read_b128 a[160:163], v1 offset:24576
  v_cvt_pk_f16_f32 v217, v118, v119
  v_mfma_f32_16x16x32_f16 a[8:11], v[200:203], a[208:211], a[8:11]
  v_pk_fma_f16 v209, v208, v208, s28
  v_pk_fma_f16 v212, v211, v211, s28
  v_pk_fma_f16 v215, v214, v214, s28
  v_mfma_f32_16x16x32_f16 a[12:15], v[204:207], a[208:211], a[12:15]
  s_waitcnt lgkmcnt(3)
  ds_read_b128 a[208:211], v1 offset:40960
  v_pk_fma_f16 v218, v217, v217, s28
  v_mfma_f32_16x16x32_f16 a[16:19], v[192:195], a[212:215], a[16:19]
  ds_read_b128 a[164:167], v1 offset:25600
  v_pk_mul_f16 v209, v209, v208
  v_pk_mul_f16 v212, v212, v211
  v_mfma_f32_16x16x32_f16 a[20:23], v[196:199], a[212:215], a[20:23]
  v_pk_mul_f16 v215, v215, v214
  v_pk_mul_f16 v218, v218, v217
  v_mfma_f32_16x16x32_f16 a[24:27], v[200:203], a[212:215], a[24:27]
  v_exp_f16 v210, v209
  v_mfma_f32_16x16x32_f16 a[28:31], v[204:207], a[212:215], a[28:31]
  s_waitcnt lgkmcnt(4)
  ds_read_b128 a[212:215], v1 offset:41984
  v_exp_f16 v213, v212
  v_mfma_f32_16x16x32_f16 a[32:35], v[192:195], a[216:219], a[32:35]
  ds_read_b128 a[168:171], v1 offset:26624
  v_exp_f16 v216, v215
  v_mfma_f32_16x16x32_f16 a[36:39], v[196:199], a[216:219], a[36:39]
  v_exp_f16 v219, v218
  v_mfma_f32_16x16x32_f16 a[40:43], v[200:203], a[216:219], a[40:43]
  ds_read_b128 a[172:175], v1 offset:27648
  v_exp_f16_sdwa v210, v209 dst_sel:WORD_1 dst_unused:UNUSED_PRESERVE src0_sel:WORD_1
  v_mfma_f32_16x16x32_f16 a[44:47], v[204:207], a[216:219], a[44:47]
  s_waitcnt lgkmcnt(6)
  ds_read_b128 a[216:219], v1 offset:43008
  v_exp_f16_sdwa v213, v212 dst_sel:WORD_1 dst_unused:UNUSED_PRESERVE src0_sel:WORD_1
  v_mfma_f32_16x16x32_f16 a[48:51], v[192:195], a[220:223], a[48:51]
  v_exp_f16_sdwa v216, v215 dst_sel:WORD_1 dst_unused:UNUSED_PRESERVE src0_sel:WORD_1
  v_mfma_f32_16x16x32_f16 a[52:55], v[196:199], a[220:223], a[52:55]
  ds_read_b128 a[176:179], v1 offset:28672
  v_exp_f16_sdwa v219, v218 dst_sel:WORD_1 dst_unused:UNUSED_PRESERVE src0_sel:WORD_1
  v_mfma_f32_16x16x32_f16 a[56:59], v[200:203], a[220:223], a[56:59]
  v_pk_fma_f16 v210, v210, s56, s56
  v_pk_fma_f16 v213, v213, s56, s56
  v_pk_fma_f16 v216, v216, s56, s56
  v_mfma_f32_16x16x32_f16 a[60:63], v[204:207], a[220:223], a[60:63]
  s_waitcnt lgkmcnt(6)
  ds_read_b128 a[220:223], v1 offset:44032
  v_pk_fma_f16 v219, v219, s56, s56
  v_mfma_f32_16x16x32_f16 a[64:67], v[192:195], a[208:211], a[64:67]
  ds_read_b128 a[180:183], v1 offset:29696
  v_rcp_f16 v209, v210
  v_mfma_f32_16x16x32_f16 a[68:71], v[196:199], a[208:211], a[68:71]
  v_rcp_f16 v212, v213
  v_mfma_f32_16x16x32_f16 a[72:75], v[200:203], a[208:211], a[72:75]
  v_rcp_f16 v215, v216
  v_mfma_f32_16x16x32_f16 a[76:79], v[204:207], a[208:211], a[76:79]
  s_waitcnt lgkmcnt(6)
  ds_read_b128 a[208:211], v1 offset:45056
  v_rcp_f16 v218, v219
  v_mfma_f32_16x16x32_f16 a[80:83], v[192:195], a[212:215], a[80:83]
  ds_read_b128 a[184:187], v1 offset:30720
  v_rcp_f16_sdwa v209, v210 dst_sel:WORD_1 dst_unused:UNUSED_PRESERVE src0_sel:WORD_1
  v_mfma_f32_16x16x32_f16 a[84:87], v[196:199], a[212:215], a[84:87]
  v_rcp_f16_sdwa v212, v213 dst_sel:WORD_1 dst_unused:UNUSED_PRESERVE src0_sel:WORD_1
  v_mfma_f32_16x16x32_f16 a[88:91], v[200:203], a[212:215], a[88:91]
  ds_read_b128 a[188:191], v1 offset:31744
  v_rcp_f16_sdwa v215, v216 dst_sel:WORD_1 dst_unused:UNUSED_PRESERVE src0_sel:WORD_1
  v_mfma_f32_16x16x32_f16 a[92:95], v[204:207], a[212:215], a[92:95]
  s_waitcnt lgkmcnt(6)
  ds_read_b128 a[212:215], v1 offset:46080
  v_rcp_f16_sdwa v218, v219 dst_sel:WORD_1 dst_unused:UNUSED_PRESERVE src0_sel:WORD_1
  v_mfma_f32_16x16x32_f16 a[96:99], v[192:195], a[216:219], a[96:99]
  v_pk_mul_f16 v176, v208, v209
  v_pk_mul_f16 v177, v211, v212
  v_pk_mul_f16 v180, v214, v215
  v_mfma_f32_16x16x32_f16 a[100:103], v[196:199], a[216:219], a[100:103]
  ds_read_b128 a[192:195], v1 offset:32768
  v_pk_mul_f16 v181, v217, v218
  v_mfma_f32_16x16x32_f16 a[104:107], v[200:203], a[216:219], a[104:107]
  v_cvt_pk_f16_f32 v208, v120, v121
  v_cvt_pk_f16_f32 v211, v122, v123
  v_cvt_pk_f16_f32 v214, v124, v125
  v_mfma_f32_16x16x32_f16 a[108:111], v[204:207], a[216:219], a[108:111]
  s_waitcnt lgkmcnt(6)
  ds_read_b128 a[216:219], v1 offset:47104
  v_cvt_pk_f16_f32 v217, v126, v127
  v_mfma_f32_16x16x32_f16 a[112:115], v[192:195], a[220:223], a[112:115]
  ds_read_b128 a[196:199], v1 offset:33792
  v_pk_fma_f16 v209, v208, v208, s28
  v_pk_fma_f16 v212, v211, v211, s28
  v_mfma_f32_16x16x32_f16 a[116:119], v[196:199], a[220:223], a[116:119]
  v_pk_fma_f16 v215, v214, v214, s28
  v_pk_fma_f16 v218, v217, v217, s28
  v_pk_mul_f16 v209, v209, v208
  v_mfma_f32_16x16x32_f16 a[120:123], v[200:203], a[220:223], a[120:123]
  v_pk_mul_f16 v212, v212, v211
  v_pk_mul_f16 v215, v215, v214
  v_mfma_f32_16x16x32_f16 a[124:127], v[204:207], a[220:223], a[124:127]
  s_waitcnt lgkmcnt(6)
  ds_read_b128 a[220:223], v1 offset:48128
  v_pk_mul_f16 v218, v218, v217
  v_mfma_f32_16x16x32_f16 a[128:131], v[192:195], a[208:211], a[128:131]
  ds_read_b128 a[200:203], v1 offset:34816
  v_exp_f16 v210, v209
  v_mfma_f32_16x16x32_f16 a[132:135], v[196:199], a[208:211], a[132:135]
  v_exp_f16 v213, v212
  v_mfma_f32_16x16x32_f16 a[136:139], v[200:203], a[208:211], a[136:139]
  ds_read_b128 a[204:207], v1 offset:35840
  v_exp_f16 v216, v215
  v_mfma_f32_16x16x32_f16 a[140:143], v[204:207], a[208:211], a[140:143]
  s_waitcnt lgkmcnt(6)
  v_exp_f16 v219, v218
  v_mfma_f32_16x16x32_f16 a[144:147], v[192:195], a[212:215], a[144:147]
  v_exp_f16_sdwa v210, v209 dst_sel:WORD_1 dst_unused:UNUSED_PRESERVE src0_sel:WORD_1
  v_exp_f16_sdwa v213, v212 dst_sel:WORD_1 dst_unused:UNUSED_PRESERVE src0_sel:WORD_1
  v_mfma_f32_16x16x32_f16 a[148:151], v[196:199], a[212:215], a[148:151]
  v_exp_f16_sdwa v216, v215 dst_sel:WORD_1 dst_unused:UNUSED_PRESERVE src0_sel:WORD_1
  v_mfma_f32_16x16x32_f16 a[152:155], v[200:203], a[212:215], a[152:155]
  v_exp_f16_sdwa v219, v218 dst_sel:WORD_1 dst_unused:UNUSED_PRESERVE src0_sel:WORD_1
  v_pk_fma_f16 v210, v210, s56, s56
  v_mfma_f32_16x16x32_f16 a[156:159], v[204:207], a[212:215], a[156:159]
  s_waitcnt lgkmcnt(4)
  v_pk_fma_f16 v213, v213, s56, s56
  v_pk_fma_f16 v216, v216, s56, s56
  v_mfma_f32_16x16x32_f16 v[224:227], v[192:195], a[216:219], v[224:227]
  v_pk_fma_f16 v219, v219, s56, s56
  v_rcp_f16 v209, v210
  v_mfma_f32_16x16x32_f16 v[228:231], v[196:199], a[216:219], v[228:231]
  v_rcp_f16 v212, v213
  v_mfma_f32_16x16x32_f16 v[232:235], v[200:203], a[216:219], v[232:235]
  v_rcp_f16 v215, v216
  v_mfma_f32_16x16x32_f16 v[236:239], v[204:207], a[216:219], v[236:239]
  s_waitcnt lgkmcnt(2)
  v_rcp_f16 v218, v219
  v_rcp_f16_sdwa v209, v210 dst_sel:WORD_1 dst_unused:UNUSED_PRESERVE src0_sel:WORD_1
  v_mfma_f32_16x16x32_f16 v[240:243], v[192:195], a[220:223], v[240:243]
  v_rcp_f16_sdwa v212, v213 dst_sel:WORD_1 dst_unused:UNUSED_PRESERVE src0_sel:WORD_1
  v_mfma_f32_16x16x32_f16 v[244:247], v[196:199], a[220:223], v[244:247]
  v_rcp_f16_sdwa v215, v216 dst_sel:WORD_1 dst_unused:UNUSED_PRESERVE src0_sel:WORD_1
  v_mfma_f32_16x16x32_f16 v[248:251], v[200:203], a[220:223], v[248:251]
  v_rcp_f16_sdwa v218, v219 dst_sel:WORD_1 dst_unused:UNUSED_PRESERVE src0_sel:WORD_1
  v_pk_mul_f16 v184, v208, v209
  v_mfma_f32_16x16x32_f16 v[252:255], v[204:207], a[220:223], v[252:255]
  v_pk_mul_f16 v185, v211, v212
  v_pk_mul_f16 v188, v214, v215
  v_pk_mul_f16 v189, v217, v218
  s_waitcnt lgkmcnt(0)
  s_waitcnt vmcnt(0)
  s_barrier
  v_mfma_f32_16x16x32_bf16 v[144:147], a[160:163], v[16:19], 0
  v_cvt_pk_f16_f32 v208, v128, v129
  v_cvt_pk_f16_f32 v211, v130, v131
  v_cvt_pk_f16_f32 v214, v132, v133
  v_mfma_f32_16x16x32_bf16 v[144:147], a[164:167], v[32:35], v[144:147]
  s_add_u32 m0, s29, 24576
  v_cvt_pk_f16_f32 v217, v134, v135
  v_pk_fma_f16 v209, v208, v208, s28
  v_mfma_f32_16x16x32_bf16 v[144:147], a[168:171], v[48:51], v[144:147]
  buffer_load_dwordx4 v1, s[16:19], s20 offen offset:0 lds
  v_pk_fma_f16 v212, v211, v211, s28
  v_mfma_f32_16x16x32_bf16 v[144:147], a[172:175], v[64:67], v[144:147]
  v_pk_fma_f16 v215, v214, v214, s28
  v_pk_fma_f16 v218, v217, v217, s28
  v_mfma_f32_16x16x32_bf16 v[144:147], a[176:179], v[80:83], v[144:147]
  v_pk_mul_f16 v209, v209, v208
  v_pk_mul_f16 v212, v212, v211
  v_pk_mul_f16 v215, v215, v214
  v_mfma_f32_16x16x32_bf16 v[144:147], a[180:183], v[96:99], v[144:147]
  v_pk_mul_f16 v218, v218, v217
  v_exp_f16 v210, v209
  v_mfma_f32_16x16x32_bf16 v[148:151], a[160:163], v[20:23], 0
  buffer_load_dwordx4 v1, s[16:19], s20 offen offset:1024 lds
  v_mfma_f32_16x16x32_bf16 v[148:151], a[164:167], v[36:39], v[148:151]
  v_exp_f16 v213, v212
  v_mfma_f32_16x16x32_bf16 v[148:151], a[168:171], v[52:55], v[148:151]
  v_exp_f16 v216, v215
  v_mfma_f32_16x16x32_bf16 v[148:151], a[172:175], v[68:71], v[148:151]
  v_exp_f16 v219, v218
  v_exp_f16_sdwa v210, v209 dst_sel:WORD_1 dst_unused:UNUSED_PRESERVE src0_sel:WORD_1
  v_mfma_f32_16x16x32_bf16 v[148:151], a[176:179], v[84:87], v[148:151]
  buffer_load_dwordx4 v1, s[16:19], s20 offen offset:2048 lds
  v_mfma_f32_16x16x32_bf16 v[148:151], a[180:183], v[100:103], v[148:151]
  v_exp_f16_sdwa v213, v212 dst_sel:WORD_1 dst_unused:UNUSED_PRESERVE src0_sel:WORD_1
  v_mfma_f32_16x16x32_bf16 v[152:155], a[160:163], v[24:27], 0
  v_exp_f16_sdwa v216, v215 dst_sel:WORD_1 dst_unused:UNUSED_PRESERVE src0_sel:WORD_1
  v_exp_f16_sdwa v219, v218 dst_sel:WORD_1 dst_unused:UNUSED_PRESERVE src0_sel:WORD_1
  v_mfma_f32_16x16x32_bf16 v[152:155], a[164:167], v[40:43], v[152:155]
  v_pk_fma_f16 v210, v210, s56, s56
  v_pk_fma_f16 v213, v213, s56, s56
  v_mfma_f32_16x16x32_bf16 v[152:155], a[168:171], v[56:59], v[152:155]
  buffer_load_dwordx4 v1, s[16:19], s20 offen offset:3072 lds
  v_pk_fma_f16 v216, v216, s56, s56
  v_mfma_f32_16x16x32_bf16 v[152:155], a[172:175], v[72:75], v[152:155]
  v_pk_fma_f16 v219, v219, s56, s56
  v_rcp_f16 v209, v210
  v_mfma_f32_16x16x32_bf16 v[152:155], a[176:179], v[88:91], v[152:155]
  v_rcp_f16 v212, v213
  v_mfma_f32_16x16x32_bf16 v[152:155], a[180:183], v[104:107], v[152:155]
  s_add_u32 m0, s29, 28672
  s_add_u32 s20, s20, 4096
  v_rcp_f16 v215, v216
  v_mfma_f32_16x16x32_bf16 v[156:159], a[160:163], v[28:31], 0
  buffer_load_dwordx4 v1, s[16:19], s20 offen offset:0 lds
  v_mfma_f32_16x16x32_bf16 v[156:159], a[164:167], v[44:47], v[156:159]
  v_rcp_f16 v218, v219
  v_mfma_f32_16x16x32_bf16 v[156:159], a[168:171], v[60:63], v[156:159]
  v_rcp_f16_sdwa v209, v210 dst_sel:WORD_1 dst_unused:UNUSED_PRESERVE src0_sel:WORD_1
  v_rcp_f16_sdwa v212, v213 dst_sel:WORD_1 dst_unused:UNUSED_PRESERVE src0_sel:WORD_1
  v_mfma_f32_16x16x32_bf16 v[156:159], a[172:175], v[76:79], v[156:159]
  v_rcp_f16_sdwa v215, v216 dst_sel:WORD_1 dst_unused:UNUSED_PRESERVE src0_sel:WORD_1
  v_mfma_f32_16x16x32_bf16 v[156:159], a[176:179], v[92:95], v[156:159]
  buffer_load_dwordx4 v1, s[16:19], s20 offen offset:1024 lds
  v_mfma_f32_16x16x32_bf16 v[156:159], a[180:183], v[108:111], v[156:159]
  s_add_u32 s20, s20, 20480
  v_rcp_f16_sdwa v218, v219 dst_sel:WORD_1 dst_unused:UNUSED_PRESERVE src0_sel:WORD_1
  v_pk_mul_f16 v178, v208, v209
  v_pk_mul_f16 v179, v211, v212
  v_mfma_f32_16x16x32_bf16 v[160:163], a[184:187], v[16:19], 0
  v_pk_mul_f16 v182, v214, v215
  v_pk_mul_f16 v183, v217, v218
  v_mfma_f32_16x16x32_bf16 v[160:163], a[188:191], v[32:35], v[160:163]
  v_cvt_pk_f16_f32 v208, v136, v137
  v_cvt_pk_f16_f32 v211, v138, v139
  v_cvt_pk_f16_f32 v214, v140, v141
  v_mfma_f32_16x16x32_bf16 v[160:163], a[192:195], v[48:51], v[160:163]
  buffer_load_dword v223, v0, s[8:11], 0 offen
  v_mfma_f32_16x16x32_bf16 v[160:163], a[196:199], v[64:67], v[160:163]
  v_cvt_pk_f16_f32 v217, v142, v143
  v_pk_fma_f16 v209, v208, v208, s28
  v_pk_fma_f16 v212, v211, v211, s28
  v_mfma_f32_16x16x32_bf16 v[160:163], a[200:203], v[80:83], v[160:163]
  v_pk_fma_f16 v215, v214, v214, s28
  v_pk_fma_f16 v218, v217, v217, s28
  v_pk_mul_f16 v209, v209, v208
  v_mfma_f32_16x16x32_bf16 v[160:163], a[204:207], v[96:99], v[160:163]
  v_pk_mul_f16 v212, v212, v211
  v_pk_mul_f16 v215, v215, v214
  v_mfma_f32_16x16x32_bf16 v[164:167], a[184:187], v[20:23], 0
  ds_read_b128 a[208:211], v1 offset:12288
  buffer_load_dword v223, v0, s[8:11], 0 offen
  v_pk_mul_f16 v218, v218, v217
  v_mfma_f32_16x16x32_bf16 v[164:167], a[188:191], v[36:39], v[164:167]
  v_exp_f16 v210, v209
  v_mfma_f32_16x16x32_bf16 v[164:167], a[192:195], v[52:55], v[164:167]
  v_exp_f16 v213, v212
  v_mfma_f32_16x16x32_bf16 v[164:167], a[196:199], v[68:71], v[164:167]
  v_exp_f16 v216, v215
  v_exp_f16 v219, v218
  v_mfma_f32_16x16x32_bf16 v[164:167], a[200:203], v[84:87], v[164:167]
  ds_read_b128 a[212:215], v1 offset:13312
  v_exp_f16_sdwa v210, v209 dst_sel:WORD_1 dst_unused:UNUSED_PRESERVE src0_sel:WORD_1
  v_mfma_f32_16x16x32_bf16 v[164:167], a[204:207], v[100:103], v[164:167]
  v_exp_f16_sdwa v213, v212 dst_sel:WORD_1 dst_unused:UNUSED_PRESERVE src0_sel:WORD_1
  v_mfma_f32_16x16x32_bf16 v[168:171], a[184:187], v[24:27], 0
  v_exp_f16_sdwa v216, v215 dst_sel:WORD_1 dst_unused:UNUSED_PRESERVE src0_sel:WORD_1
  v_mfma_f32_16x16x32_bf16 v[168:171], a[188:191], v[40:43], v[168:171]
  v_exp_f16_sdwa v219, v218 dst_sel:WORD_1 dst_unused:UNUSED_PRESERVE src0_sel:WORD_1
  v_pk_fma_f16 v210, v210, s56, s56
  v_mfma_f32_16x16x32_bf16 v[168:171], a[192:195], v[56:59], v[168:171]
  ds_read_b128 a[216:219], v1 offset:14336
  v_pk_fma_f16 v213, v213, s56, s56
  v_pk_fma_f16 v216, v216, s56, s56
  v_mfma_f32_16x16x32_bf16 v[168:171], a[196:199], v[72:75], v[168:171]
  v_pk_fma_f16 v219, v219, s56, s56
  v_rcp_f16 v209, v210
  v_mfma_f32_16x16x32_bf16 v[168:171], a[200:203], v[88:91], v[168:171]
  v_rcp_f16 v212, v213
  v_mfma_f32_16x16x32_bf16 v[168:171], a[204:207], v[104:107], v[168:171]
  v_rcp_f16 v215, v216
  v_mfma_f32_16x16x32_bf16 v[172:175], a[184:187], v[28:31], 0
  ds_read_b128 a[220:223], v1 offset:15360
  v_rcp_f16 v218, v219
  v_mfma_f32_16x16x32_bf16 v[172:175], a[188:191], v[44:47], v[172:175]
  v_rcp_f16_sdwa v209, v210 dst_sel:WORD_1 dst_unused:UNUSED_PRESERVE src0_sel:WORD_1
  v_mfma_f32_16x16x32_bf16 v[172:175], a[192:195], v[60:63], v[172:175]
  v_rcp_f16_sdwa v212, v213 dst_sel:WORD_1 dst_unused:UNUSED_PRESERVE src0_sel:WORD_1
  v_mfma_f32_16x16x32_bf16 v[172:175], a[196:199], v[76:79], v[172:175]
  v_rcp_f16_sdwa v215, v216 dst_sel:WORD_1 dst_unused:UNUSED_PRESERVE src0_sel:WORD_1
  v_rcp_f16_sdwa v218, v219 dst_sel:WORD_1 dst_unused:UNUSED_PRESERVE src0_sel:WORD_1
  v_mfma_f32_16x16x32_bf16 v[172:175], a[200:203], v[92:95], v[172:175]
  v_pk_mul_f16 v186, v208, v209
  v_pk_mul_f16 v187, v211, v212
  v_mfma_f32_16x16x32_bf16 v[172:175], a[204:207], v[108:111], v[172:175]
  v_pk_mul_f16 v190, v214, v215
  v_pk_mul_f16 v191, v217, v218
  v_add_u32 v0, 1572864, v0
  s_mov_b32 s30, 3
  s_mov_b32 s55, 0
  s_mov_b32 s54, 130688
.p2align 6
mlp_loop:
  s_waitcnt lgkmcnt(4)
  v_mfma_f32_16x16x32_f16 a[0:3], v[176:179], a[208:211], a[0:3]
  v_cvt_pk_f16_f32 v208, v144, v145
  v_cvt_pk_f16_f32 v211, v146, v147
  v_cvt_pk_f16_f32 v214, v148, v149
  v_mfma_f32_16x16x32_f16 a[4:7], v[180:183], a[208:211], a[4:7]
  ds_read_b128 a[160:163], v1 offset:0
  v_cvt_pk_f16_f32 v217, v150, v151
  v_mfma_f32_16x16x32_f16 a[8:11], v[184:187], a[208:211], a[8:11]
  v_pk_fma_f16 v209, v208, v208, s28
  v_pk_fma_f16 v212, v211, v211, s28
  v_pk_fma_f16 v215, v214, v214, s28
  v_mfma_f32_16x16x32_f16 a[12:15], v[188:191], a[208:211], a[12:15]
  s_waitcnt lgkmcnt(4)
  ds_read_b128 a[208:211], v1 offset:16384
  v_pk_fma_f16 v218, v217, v217, s28
  v_mfma_f32_16x16x32_f16 a[16:19], v[176:179], a[212:215], a[16:19]
  ds_read_b128 a[164:167], v1 offset:1024
  v_pk_mul_f16 v209, v209, v208
  v_pk_mul_f16 v212, v212, v211
  v_mfma_f32_16x16x32_f16 a[20:23], v[180:183], a[212:215], a[20:23]
  v_pk_mul_f16 v215, v215, v214
  v_pk_mul_f16 v218, v218, v217
  v_mfma_f32_16x16x32_f16 a[24:27], v[184:187], a[212:215], a[24:27]
  v_exp_f16 v210, v209
  v_mfma_f32_16x16x32_f16 a[28:31], v[188:191], a[212:215], a[28:31]
  s_waitcnt lgkmcnt(4)
  ds_read_b128 a[212:215], v1 offset:17408
  v_exp_f16 v213, v212
  v_mfma_f32_16x16x32_f16 a[32:35], v[176:179], a[216:219], a[32:35]
  ds_read_b128 a[168:171], v1 offset:2048
  v_exp_f16 v216, v215
  v_mfma_f32_16x16x32_f16 a[36:39], v[180:183], a[216:219], a[36:39]
  v_exp_f16 v219, v218
  v_mfma_f32_16x16x32_f16 a[40:43], v[184:187], a[216:219], a[40:43]
  ds_read_b128 a[172:175], v1 offset:3072
  v_exp_f16_sdwa v210, v209 dst_sel:WORD_1 dst_unused:UNUSED_PRESERVE src0_sel:WORD_1
  v_mfma_f32_16x16x32_f16 a[44:47], v[188:191], a[216:219], a[44:47]
  s_waitcnt lgkmcnt(6)
  ds_read_b128 a[216:219], v1 offset:18432
  v_exp_f16_sdwa v213, v212 dst_sel:WORD_1 dst_unused:UNUSED_PRESERVE src0_sel:WORD_1
  v_mfma_f32_16x16x32_f16 a[48:51], v[176:179], a[220:223], a[48:51]
  v_exp_f16_sdwa v216, v215 dst_sel:WORD_1 dst_unused:UNUSED_PRESERVE src0_sel:WORD_1
  v_mfma_f32_16x16x32_f16 a[52:55], v[180:183], a[220:223], a[52:55]
  ds_read_b128 a[176:179], v1 offset:4096
  v_exp_f16_sdwa v219, v218 dst_sel:WORD_1 dst_unused:UNUSED_PRESERVE src0_sel:WORD_1
  v_mfma_f32_16x16x32_f16 a[56:59], v[184:187], a[220:223], a[56:59]
  v_pk_fma_f16 v210, v210, s56, s56
  v_pk_fma_f16 v213, v213, s56, s56
  v_pk_fma_f16 v216, v216, s56, s56
  v_mfma_f32_16x16x32_f16 a[60:63], v[188:191], a[220:223], a[60:63]
  s_waitcnt lgkmcnt(6)
  ds_read_b128 a[220:223], v1 offset:19456
  v_pk_fma_f16 v219, v219, s56, s56
  v_mfma_f32_16x16x32_f16 a[64:67], v[176:179], a[208:211], a[64:67]
  ds_read_b128 a[180:183], v1 offset:5120
  v_rcp_f16 v209, v210
  v_mfma_f32_16x16x32_f16 a[68:71], v[180:183], a[208:211], a[68:71]
  v_rcp_f16 v212, v213
  v_mfma_f32_16x16x32_f16 a[72:75], v[184:187], a[208:211], a[72:75]
  v_rcp_f16 v215, v216
  v_mfma_f32_16x16x32_f16 a[76:79], v[188:191], a[208:211], a[76:79]
  s_waitcnt lgkmcnt(6)
  ds_read_b128 a[208:211], v1 offset:20480
  v_rcp_f16 v218, v219
  v_mfma_f32_16x16x32_f16 a[80:83], v[176:179], a[212:215], a[80:83]
  ds_read_b128 a[184:187], v1 offset:6144
  v_rcp_f16_sdwa v209, v210 dst_sel:WORD_1 dst_unused:UNUSED_PRESERVE src0_sel:WORD_1
  v_mfma_f32_16x16x32_f16 a[84:87], v[180:183], a[212:215], a[84:87]
  v_rcp_f16_sdwa v212, v213 dst_sel:WORD_1 dst_unused:UNUSED_PRESERVE src0_sel:WORD_1
  v_mfma_f32_16x16x32_f16 a[88:91], v[184:187], a[212:215], a[88:91]
  ds_read_b128 a[188:191], v1 offset:7168
  v_rcp_f16_sdwa v215, v216 dst_sel:WORD_1 dst_unused:UNUSED_PRESERVE src0_sel:WORD_1
  v_mfma_f32_16x16x32_f16 a[92:95], v[188:191], a[212:215], a[92:95]
  s_waitcnt lgkmcnt(6)
  ds_read_b128 a[212:215], v1 offset:21504
  v_rcp_f16_sdwa v218, v219 dst_sel:WORD_1 dst_unused:UNUSED_PRESERVE src0_sel:WORD_1
  v_mfma_f32_16x16x32_f16 a[96:99], v[176:179], a[216:219], a[96:99]
  v_pk_mul_f16 v192, v208, v209
  v_pk_mul_f16 v193, v211, v212
  v_pk_mul_f16 v196, v214, v215
  v_mfma_f32_16x16x32_f16 a[100:103], v[180:183], a[216:219], a[100:103]
  ds_read_b128 a[192:195], v1 offset:8192
  v_pk_mul_f16 v197, v217, v218
  v_mfma_f32_16x16x32_f16 a[104:107], v[184:187], a[216:219], a[104:107]
  v_cvt_pk_f16_f32 v208, v152, v153
  v_cvt_pk_f16_f32 v211, v154, v155
  v_cvt_pk_f16_f32 v214, v156, v157
  v_mfma_f32_16x16x32_f16 a[108:111], v[188:191], a[216:219], a[108:111]
  s_waitcnt lgkmcnt(6)
  ds_read_b128 a[216:219], v1 offset:22528
  v_cvt_pk_f16_f32 v217, v158, v159
  v_mfma_f32_16x16x32_f16 a[112:115], v[176:179], a[220:223], a[112:115]
  ds_read_b128 a[196:199], v1 offset:9216
  v_pk_fma_f16 v209, v208, v208, s28
  v_pk_fma_f16 v212, v211, v211, s28
  v_mfma_f32_16x16x32_f16 a[116:119], v[180:183], a[220:223], a[116:119]
  v_pk_fma_f16 v215, v214, v214, s28
  v_pk_fma_f16 v218, v217, v217, s28
  v_pk_mul_f16 v209, v209, v208
  v_mfma_f32_16x16x32_f16 a[120:123], v[184:187], a[220:223], a[120:123]
  v_pk_mul_f16 v212, v212, v211
  v_pk_mul_f16 v215, v215, v214
  v_mfma_f32_16x16x32_f16 a[124:127], v[188:191], a[220:223], a[124:127]
  s_waitcnt lgkmcnt(6)
  ds_read_b128 a[220:223], v1 offset:23552
  v_pk_mul_f16 v218, v218, v217
  v_mfma_f32_16x16x32_f16 a[128:131], v[176:179], a[208:211], a[128:131]
  ds_read_b128 a[200:203], v1 offset:10240
  v_exp_f16 v210, v209
  v_mfma_f32_16x16x32_f16 a[132:135], v[180:183], a[208:211], a[132:135]
  v_exp_f16 v213, v212
  v_mfma_f32_16x16x32_f16 a[136:139], v[184:187], a[208:211], a[136:139]
  ds_read_b128 a[204:207], v1 offset:11264
  v_exp_f16 v216, v215
  v_mfma_f32_16x16x32_f16 a[140:143], v[188:191], a[208:211], a[140:143]
  s_waitcnt lgkmcnt(6)
  v_exp_f16 v219, v218
  v_mfma_f32_16x16x32_f16 a[144:147], v[176:179], a[212:215], a[144:147]
  v_exp_f16_sdwa v210, v209 dst_sel:WORD_1 dst_unused:UNUSED_PRESERVE src0_sel:WORD_1
  v_exp_f16_sdwa v213, v212 dst_sel:WORD_1 dst_unused:UNUSED_PRESERVE src0_sel:WORD_1
  v_mfma_f32_16x16x32_f16 a[148:151], v[180:183], a[212:215], a[148:151]
  v_exp_f16_sdwa v216, v215 dst_sel:WORD_1 dst_unused:UNUSED_PRESERVE src0_sel:WORD_1
  v_mfma_f32_16x16x32_f16 a[152:155], v[184:187], a[212:215], a[152:155]
  v_exp_f16_sdwa v219, v218 dst_sel:WORD_1 dst_unused:UNUSED_PRESERVE src0_sel:WORD_1
  v_pk_fma_f16 v210, v210, s56, s56
  v_mfma_f32_16x16x32_f16 a[156:159], v[188:191], a[212:215], a[156:159]
  s_waitcnt lgkmcnt(4)
  v_pk_fma_f16 v213, v213, s56, s56
  v_pk_fma_f16 v216, v216, s56, s56
  v_mfma_f32_16x16x32_f16 v[224:227], v[176:179], a[216:219], v[224:227]
  v_pk_fma_f16 v219, v219, s56, s56
  v_rcp_f16 v209, v210
  v_mfma_f32_16x16x32_f16 v[228:231], v[180:183], a[216:219], v[228:231]
  v_rcp_f16 v212, v213
  v_mfma_f32_16x16x32_f16 v[232:235], v[184:187], a[216:219], v[232:235]
  v_rcp_f16 v215, v216
  v_mfma_f32_16x16x32_f16 v[236:239], v[188:191], a[216:219], v[236:239]
  s_waitcnt lgkmcnt(2)
  v_rcp_f16 v218, v219
  v_rcp_f16_sdwa v209, v210 dst_sel:WORD_1 dst_unused:UNUSED_PRESERVE src0_sel:WORD_1
  v_mfma_f32_16x16x32_f16 v[240:243], v[176:179], a[220:223], v[240:243]
  v_rcp_f16_sdwa v212, v213 dst_sel:WORD_1 dst_unused:UNUSED_PRESERVE src0_sel:WORD_1
  v_mfma_f32_16x16x32_f16 v[244:247], v[180:183], a[220:223], v[244:247]
  v_rcp_f16_sdwa v215, v216 dst_sel:WORD_1 dst_unused:UNUSED_PRESERVE src0_sel:WORD_1
  v_mfma_f32_16x16x32_f16 v[248:251], v[184:187], a[220:223], v[248:251]
  v_rcp_f16_sdwa v218, v219 dst_sel:WORD_1 dst_unused:UNUSED_PRESERVE src0_sel:WORD_1
  v_pk_mul_f16 v200, v208, v209
  v_mfma_f32_16x16x32_f16 v[252:255], v[188:191], a[220:223], v[252:255]
  v_pk_mul_f16 v201, v211, v212
  v_pk_mul_f16 v204, v214, v215
  v_pk_mul_f16 v205, v217, v218
  s_waitcnt lgkmcnt(0)
  s_waitcnt vmcnt(2)
  s_barrier
  v_mfma_f32_16x16x32_bf16 v[112:115], a[160:163], v[16:19], 0
  v_add_u32 v220, s54, v10
  v_cvt_pk_f16_f32 v208, v160, v161
  v_cvt_pk_f16_f32 v211, v162, v163
  v_mfma_f32_16x16x32_bf16 v[112:115], a[164:167], v[32:35], v[112:115]
  s_add_u32 m0, s29, 0
  v_cvt_pk_f16_f32 v214, v164, v165
  v_cvt_pk_f16_f32 v217, v166, v167
  v_mfma_f32_16x16x32_bf16 v[112:115], a[168:171], v[48:51], v[112:115]
  buffer_load_dwordx4 v1, s[16:19], s20 offen offset:0 lds
  v_pk_fma_f16 v209, v208, v208, s28
  v_mfma_f32_16x16x32_bf16 v[112:115], a[172:175], v[64:67], v[112:115]
  v_pk_fma_f16 v212, v211, v211, s28
  v_pk_fma_f16 v215, v214, v214, s28
  v_pk_fma_f16 v218, v217, v217, s28
  v_mfma_f32_16x16x32_bf16 v[112:115], a[176:179], v[80:83], v[112:115]
  v_pk_mul_f16 v209, v209, v208
  v_pk_mul_f16 v212, v212, v211
  v_pk_mul_f16 v215, v215, v214
  v_mfma_f32_16x16x32_bf16 v[112:115], a[180:183], v[96:99], v[112:115]
  ds_write2_b32 v220, a224, a228 offset0:0 offset1:11
  v_pk_mul_f16 v218, v218, v217
  v_mfma_f32_16x16x32_bf16 v[116:119], a[160:163], v[20:23], 0
  buffer_load_dwordx4 v1, s[16:19], s20 offen offset:1024 lds
  v_mfma_f32_16x16x32_bf16 v[116:119], a[164:167], v[36:39], v[116:119]
  v_exp_f16 v210, v209
  v_exp_f16 v213, v212
  v_mfma_f32_16x16x32_bf16 v[116:119], a[168:171], v[52:55], v[116:119]
  v_exp_f16 v216, v215
  v_mfma_f32_16x16x32_bf16 v[116:119], a[172:175], v[68:71], v[116:119]
  v_exp_f16 v219, v218
  v_mfma_f32_16x16x32_bf16 v[116:119], a[176:179], v[84:87], v[116:119]
  buffer_load_dwordx4 v1, s[16:19], s20 offen offset:2048 lds
  v_exp_f16_sdwa v210, v209 dst_sel:WORD_1 dst_unused:UNUSED_PRESERVE src0_sel:WORD_1
  v_mfma_f32_16x16x32_bf16 v[116:119], a[180:183], v[100:103], v[116:119]
  v_exp_f16_sdwa v213, v212 dst_sel:WORD_1 dst_unused:UNUSED_PRESERVE src0_sel:WORD_1
  v_mfma_f32_16x16x32_bf16 v[120:123], a[160:163], v[24:27], 0
  v_exp_f16_sdwa v216, v215 dst_sel:WORD_1 dst_unused:UNUSED_PRESERVE src0_sel:WORD_1
  v_mfma_f32_16x16x32_bf16 v[120:123], a[164:167], v[40:43], v[120:123]
  v_exp_f16_sdwa v219, v218 dst_sel:WORD_1 dst_unused:UNUSED_PRESERVE src0_sel:WORD_1
  v_pk_fma_f16 v210, v210, s56, s56
  v_pk_fma_f16 v213, v213, s56, s56
  v_mfma_f32_16x16x32_bf16 v[120:123], a[168:171], v[56:59], v[120:123]
  buffer_load_dwordx4 v1, s[16:19], s20 offen offset:3072 lds
  v_pk_fma_f16 v216, v216, s56, s56
  v_mfma_f32_16x16x32_bf16 v[120:123], a[172:175], v[72:75], v[120:123]
  ds_write2_b32 v220, a225, a229 offset0:22 offset1:33
  v_pk_fma_f16 v219, v219, s56, s56
  v_mfma_f32_16x16x32_bf16 v[120:123], a[176:179], v[88:91], v[120:123]
  v_rcp_f16 v209, v210
  v_mfma_f32_16x16x32_bf16 v[120:123], a[180:183], v[104:107], v[120:123]
  s_add_u32 m0, s29, 4096
  s_add_u32 s20, s20, 4096
  v_rcp_f16 v212, v213
  v_mfma_f32_16x16x32_bf16 v[124:127], a[160:163], v[28:31], 0
  buffer_load_dwordx4 v1, s[16:19], s20 offen offset:0 lds
  v_mfma_f32_16x16x32_bf16 v[124:127], a[164:167], v[44:47], v[124:127]
  v_rcp_f16 v215, v216
  v_rcp_f16 v218, v219
  v_mfma_f32_16x16x32_bf16 v[124:127], a[168:171], v[60:63], v[124:127]
  v_rcp_f16_sdwa v209, v210 dst_sel:WORD_1 dst_unused:UNUSED_PRESERVE src0_sel:WORD_1
  v_mfma_f32_16x16x32_bf16 v[124:127], a[172:175], v[76:79], v[124:127]
  v_rcp_f16_sdwa v212, v213 dst_sel:WORD_1 dst_unused:UNUSED_PRESERVE src0_sel:WORD_1
  v_rcp_f16_sdwa v215, v216 dst_sel:WORD_1 dst_unused:UNUSED_PRESERVE src0_sel:WORD_1
  v_mfma_f32_16x16x32_bf16 v[124:127], a[176:179], v[92:95], v[124:127]
  buffer_load_dwordx4 v1, s[16:19], s20 offen offset:1024 lds
  v_mfma_f32_16x16x32_bf16 v[124:127], a[180:183], v[108:111], v[124:127]
  s_add_u32 s20, s20, 20480
  v_rcp_f16_sdwa v218, v219 dst_sel:WORD_1 dst_unused:UNUSED_PRESERVE src0_sel:WORD_1
  v_pk_mul_f16 v194, v208, v209
  v_mfma_f32_16x16x32_bf16 v[128:131], a[184:187], v[16:19], 0
  v_pk_mul_f16 v195, v211, v212
  v_pk_mul_f16 v198, v214, v215
  v_pk_mul_f16 v199, v217, v218
  v_mfma_f32_16x16x32_bf16 v[128:131], a[188:191], v[32:35], v[128:131]
  ds_write2_b32 v220, a226, a230 offset0:44 offset1:55
  v_cvt_pk_f16_f32 v208, v168, v169
  v_mfma_f32_16x16x32_bf16 v[128:131], a[192:195], v[48:51], v[128:131]
  v_cvt_pk_f16_f32 v211, v170, v171
  v_cvt_pk_f16_f32 v214, v172, v173
  v_cvt_pk_f16_f32 v217, v174, v175
  v_mfma_f32_16x16x32_bf16 v[128:131], a[196:199], v[64:67], v[128:131]
  v_pk_fma_f16 v209, v208, v208, s28
  v_pk_fma_f16 v212, v211, v211, s28
  v_pk_fma_f16 v215, v214, v214, s28
  v_mfma_f32_16x16x32_bf16 v[128:131], a[200:203], v[80:83], v[128:131]
  v_pk_fma_f16 v218, v217, v217, s28
  v_pk_mul_f16 v209, v209, v208
  v_pk_mul_f16 v212, v212, v211
  v_mfma_f32_16x16x32_bf16 v[128:131], a[204:207], v[96:99], v[128:131]
  v_pk_mul_f16 v215, v215, v214
  v_pk_mul_f16 v218, v218, v217
  v_mfma_f32_16x16x32_bf16 v[132:135], a[184:187], v[20:23], 0
  ds_read_b128 a[208:211], v1 offset:36864
  v_exp_f16 v210, v209
  v_mfma_f32_16x16x32_bf16 v[132:135], a[188:191], v[36:39], v[132:135]
  v_exp_f16 v213, v212
  v_mfma_f32_16x16x32_bf16 v[132:135], a[192:195], v[52:55], v[132:135]
  v_exp_f16 v216, v215
  v_mfma_f32_16x16x32_bf16 v[132:135], a[196:199], v[68:71], v[132:135]
  v_exp_f16 v219, v218
  v_exp_f16_sdwa v210, v209 dst_sel:WORD_1 dst_unused:UNUSED_PRESERVE src0_sel:WORD_1
  v_mfma_f32_16x16x32_bf16 v[132:135], a[200:203], v[84:87], v[132:135]
  ds_read_b128 a[212:215], v1 offset:37888
  v_exp_f16_sdwa v213, v212 dst_sel:WORD_1 dst_unused:UNUSED_PRESERVE src0_sel:WORD_1
  v_mfma_f32_16x16x32_bf16 v[132:135], a[204:207], v[100:103], v[132:135]
  ds_write2_b32 v220, a227, a231 offset0:66 offset1:77
  v_exp_f16_sdwa v216, v215 dst_sel:WORD_1 dst_unused:UNUSED_PRESERVE src0_sel:WORD_1
  v_mfma_f32_16x16x32_bf16 v[136:139], a[184:187], v[24:27], 0
  v_exp_f16_sdwa v219, v218 dst_sel:WORD_1 dst_unused:UNUSED_PRESERVE src0_sel:WORD_1
  v_mfma_f32_16x16x32_bf16 v[136:139], a[188:191], v[40:43], v[136:139]
  v_pk_fma_f16 v210, v210, s56, s56
  v_pk_fma_f16 v213, v213, s56, s56
  v_pk_fma_f16 v216, v216, s56, s56
  v_mfma_f32_16x16x32_bf16 v[136:139], a[192:195], v[56:59], v[136:139]
  ds_read_b128 a[216:219], v1 offset:38912
  v_pk_fma_f16 v219, v219, s56, s56
  v_mfma_f32_16x16x32_bf16 v[136:139], a[196:199], v[72:75], v[136:139]
  buffer_load_dwordx4 a[224:227], v2, s[8:11], s55 offen
  v_mfma_f32_16x16x32_bf16 v[136:139], a[200:203], v[88:91], v[136:139]
  v_rcp_f16 v209, v210
  v_rcp_f16 v212, v213
  v_mfma_f32_16x16x32_bf16 v[136:139], a[204:207], v[104:107], v[136:139]
  v_rcp_f16 v215, v216
  v_mfma_f32_16x16x32_bf16 v[140:143], a[184:187], v[28:31], 0
  ds_read_b128 a[220:223], v1 offset:39936
  v_rcp_f16 v218, v219
  v_mfma_f32_16x16x32_bf16 v[140:143], a[188:191], v[44:47], v[140:143]
  v_rcp_f16_sdwa v209, v210 dst_sel:WORD_1 dst_unused:UNUSED_PRESERVE src0_sel:WORD_1
  v_mfma_f32_16x16x32_bf16 v[140:143], a[192:195], v[60:63], v[140:143]
  buffer_load_dwordx4 a[228:231], v6, s[8:11], s55 offen
  v_rcp_f16_sdwa v212, v213 dst_sel:WORD_1 dst_unused:UNUSED_PRESERVE src0_sel:WORD_1
  v_mfma_f32_16x16x32_bf16 v[140:143], a[196:199], v[76:79], v[140:143]
  v_rcp_f16_sdwa v215, v216 dst_sel:WORD_1 dst_unused:UNUSED_PRESERVE src0_sel:WORD_1
  v_mfma_f32_16x16x32_bf16 v[140:143], a[200:203], v[92:95], v[140:143]
  v_rcp_f16_sdwa v218, v219 dst_sel:WORD_1 dst_unused:UNUSED_PRESERVE src0_sel:WORD_1
  v_pk_mul_f16 v202, v208, v209
  v_mfma_f32_16x16x32_bf16 v[140:143], a[204:207], v[108:111], v[140:143]
  v_pk_mul_f16 v203, v211, v212
  v_pk_mul_f16 v206, v214, v215
  v_pk_mul_f16 v207, v217, v218
  s_waitcnt lgkmcnt(4)
  v_mfma_f32_16x16x32_f16 a[0:3], v[192:195], a[208:211], a[0:3]
  v_cvt_pk_f16_f32 v208, v112, v113
  v_cvt_pk_f16_f32 v211, v114, v115
  v_cvt_pk_f16_f32 v214, v116, v117
  v_mfma_f32_16x16x32_f16 a[4:7], v[196:199], a[208:211], a[4:7]
  ds_read_b128 a[160:163], v1 offset:24576
  v_cvt_pk_f16_f32 v217, v118, v119
  v_mfma_f32_16x16x32_f16 a[8:11], v[200:203], a[208:211], a[8:11]
  v_pk_fma_f16 v209, v208, v208, s28
  v_pk_fma_f16 v212, v211, v211, s28
  v_pk_fma_f16 v215, v214, v214, s28
  v_mfma_f32_16x16x32_f16 a[12:15], v[204:207], a[208:211], a[12:15]
  s_waitcnt lgkmcnt(4)
  ds_read_b128 a[208:211], v1 offset:40960
  v_pk_fma_f16 v218, v217, v217, s28
  v_mfma_f32_16x16x32_f16 a[16:19], v[192:195], a[212:215], a[16:19]
  ds_read_b128 a[164:167], v1 offset:25600
  v_pk_mul_f16 v209, v209, v208
  v_pk_mul_f16 v212, v212, v211
  v_mfma_f32_16x16x32_f16 a[20:23], v[196:199], a[212:215], a[20:23]
  v_pk_mul_f16 v215, v215, v214
  v_pk_mul_f16 v218, v218, v217
  v_mfma_f32_16x16x32_f16 a[24:27], v[200:203], a[212:215], a[24:27]
  v_exp_f16 v210, v209
  v_mfma_f32_16x16x32_f16 a[28:31], v[204:207], a[212:215], a[28:31]
  s_waitcnt lgkmcnt(4)
  ds_read_b128 a[212:215], v1 offset:41984
  v_exp_f16 v213, v212
  v_mfma_f32_16x16x32_f16 a[32:35], v[192:195], a[216:219], a[32:35]
  ds_read_b128 a[168:171], v1 offset:26624
  v_exp_f16 v216, v215
  v_mfma_f32_16x16x32_f16 a[36:39], v[196:199], a[216:219], a[36:39]
  v_exp_f16 v219, v218
  v_mfma_f32_16x16x32_f16 a[40:43], v[200:203], a[216:219], a[40:43]
  ds_read_b128 a[172:175], v1 offset:27648
  v_exp_f16_sdwa v210, v209 dst_sel:WORD_1 dst_unused:UNUSED_PRESERVE src0_sel:WORD_1
  v_mfma_f32_16x16x32_f16 a[44:47], v[204:207], a[216:219], a[44:47]
  s_waitcnt lgkmcnt(6)
  ds_read_b128 a[216:219], v1 offset:43008
  v_exp_f16_sdwa v213, v212 dst_sel:WORD_1 dst_unused:UNUSED_PRESERVE src0_sel:WORD_1
  v_mfma_f32_16x16x32_f16 a[48:51], v[192:195], a[220:223], a[48:51]
  v_exp_f16_sdwa v216, v215 dst_sel:WORD_1 dst_unused:UNUSED_PRESERVE src0_sel:WORD_1
  v_mfma_f32_16x16x32_f16 a[52:55], v[196:199], a[220:223], a[52:55]
  ds_read_b128 a[176:179], v1 offset:28672
  v_exp_f16_sdwa v219, v218 dst_sel:WORD_1 dst_unused:UNUSED_PRESERVE src0_sel:WORD_1
  v_mfma_f32_16x16x32_f16 a[56:59], v[200:203], a[220:223], a[56:59]
  v_pk_fma_f16 v210, v210, s56, s56
  v_pk_fma_f16 v213, v213, s56, s56
  v_pk_fma_f16 v216, v216, s56, s56
  v_mfma_f32_16x16x32_f16 a[60:63], v[204:207], a[220:223], a[60:63]
  s_waitcnt lgkmcnt(6)
  ds_read_b128 a[220:223], v1 offset:44032
  v_pk_fma_f16 v219, v219, s56, s56
  v_mfma_f32_16x16x32_f16 a[64:67], v[192:195], a[208:211], a[64:67]
  ds_read_b128 a[180:183], v1 offset:29696
  v_rcp_f16 v209, v210
  v_mfma_f32_16x16x32_f16 a[68:71], v[196:199], a[208:211], a[68:71]
  v_rcp_f16 v212, v213
  v_mfma_f32_16x16x32_f16 a[72:75], v[200:203], a[208:211], a[72:75]
  v_rcp_f16 v215, v216
  v_mfma_f32_16x16x32_f16 a[76:79], v[204:207], a[208:211], a[76:79]
  s_waitcnt lgkmcnt(6)
  ds_read_b128 a[208:211], v1 offset:45056
  v_rcp_f16 v218, v219
  v_mfma_f32_16x16x32_f16 a[80:83], v[192:195], a[212:215], a[80:83]
  ds_read_b128 a[184:187], v1 offset:30720
  v_rcp_f16_sdwa v209, v210 dst_sel:WORD_1 dst_unused:UNUSED_PRESERVE src0_sel:WORD_1
  v_mfma_f32_16x16x32_f16 a[84:87], v[196:199], a[212:215], a[84:87]
  v_rcp_f16_sdwa v212, v213 dst_sel:WORD_1 dst_unused:UNUSED_PRESERVE src0_sel:WORD_1
  v_mfma_f32_16x16x32_f16 a[88:91], v[200:203], a[212:215], a[88:91]
  ds_read_b128 a[188:191], v1 offset:31744
  v_rcp_f16_sdwa v215, v216 dst_sel:WORD_1 dst_unused:UNUSED_PRESERVE src0_sel:WORD_1
  v_mfma_f32_16x16x32_f16 a[92:95], v[204:207], a[212:215], a[92:95]
  s_waitcnt lgkmcnt(6)
  ds_read_b128 a[212:215], v1 offset:46080
  v_rcp_f16_sdwa v218, v219 dst_sel:WORD_1 dst_unused:UNUSED_PRESERVE src0_sel:WORD_1
  v_mfma_f32_16x16x32_f16 a[96:99], v[192:195], a[216:219], a[96:99]
  v_pk_mul_f16 v176, v208, v209
  v_pk_mul_f16 v177, v211, v212
  v_pk_mul_f16 v180, v214, v215
  v_mfma_f32_16x16x32_f16 a[100:103], v[196:199], a[216:219], a[100:103]
  ds_read_b128 a[192:195], v1 offset:32768
  v_pk_mul_f16 v181, v217, v218
  v_mfma_f32_16x16x32_f16 a[104:107], v[200:203], a[216:219], a[104:107]
  v_cvt_pk_f16_f32 v208, v120, v121
  v_cvt_pk_f16_f32 v211, v122, v123
  v_cvt_pk_f16_f32 v214, v124, v125
  v_mfma_f32_16x16x32_f16 a[108:111], v[204:207], a[216:219], a[108:111]
  s_waitcnt lgkmcnt(6)
  ds_read_b128 a[216:219], v1 offset:47104
  v_cvt_pk_f16_f32 v217, v126, v127
  v_mfma_f32_16x16x32_f16 a[112:115], v[192:195], a[220:223], a[112:115]
  ds_read_b128 a[196:199], v1 offset:33792
  v_pk_fma_f16 v209, v208, v208, s28
  v_pk_fma_f16 v212, v211, v211, s28
  v_mfma_f32_16x16x32_f16 a[116:119], v[196:199], a[220:223], a[116:119]
  v_pk_fma_f16 v215, v214, v214, s28
  v_pk_fma_f16 v218, v217, v217, s28
  v_pk_mul_f16 v209, v209, v208
  v_mfma_f32_16x16x32_f16 a[120:123], v[200:203], a[220:223], a[120:123]
  v_pk_mul_f16 v212, v212, v211
  v_pk_mul_f16 v215, v215, v214
  v_mfma_f32_16x16x32_f16 a[124:127], v[204:207], a[220:223], a[124:127]
  s_waitcnt lgkmcnt(6)
  ds_read_b128 a[220:223], v1 offset:48128
  v_pk_mul_f16 v218, v218, v217
  v_mfma_f32_16x16x32_f16 a[128:131], v[192:195], a[208:211], a[128:131]
  ds_read_b128 a[200:203], v1 offset:34816
  v_exp_f16 v210, v209
  v_mfma_f32_16x16x32_f16 a[132:135], v[196:199], a[208:211], a[132:135]
  v_exp_f16 v213, v212
  v_mfma_f32_16x16x32_f16 a[136:139], v[200:203], a[208:211], a[136:139]
  ds_read_b128 a[204:207], v1 offset:35840
  v_exp_f16 v216, v215
  v_mfma_f32_16x16x32_f16 a[140:143], v[204:207], a[208:211], a[140:143]
  s_waitcnt lgkmcnt(6)
  v_exp_f16 v219, v218
  v_mfma_f32_16x16x32_f16 a[144:147], v[192:195], a[212:215], a[144:147]
  v_exp_f16_sdwa v210, v209 dst_sel:WORD_1 dst_unused:UNUSED_PRESERVE src0_sel:WORD_1
  v_exp_f16_sdwa v213, v212 dst_sel:WORD_1 dst_unused:UNUSED_PRESERVE src0_sel:WORD_1
  v_mfma_f32_16x16x32_f16 a[148:151], v[196:199], a[212:215], a[148:151]
  v_exp_f16_sdwa v216, v215 dst_sel:WORD_1 dst_unused:UNUSED_PRESERVE src0_sel:WORD_1
  v_mfma_f32_16x16x32_f16 a[152:155], v[200:203], a[212:215], a[152:155]
  v_exp_f16_sdwa v219, v218 dst_sel:WORD_1 dst_unused:UNUSED_PRESERVE src0_sel:WORD_1
  v_pk_fma_f16 v210, v210, s56, s56
  v_mfma_f32_16x16x32_f16 a[156:159], v[204:207], a[212:215], a[156:159]
  s_waitcnt lgkmcnt(4)
  v_pk_fma_f16 v213, v213, s56, s56
  v_pk_fma_f16 v216, v216, s56, s56
  v_mfma_f32_16x16x32_f16 v[224:227], v[192:195], a[216:219], v[224:227]
  v_pk_fma_f16 v219, v219, s56, s56
  v_rcp_f16 v209, v210
  v_mfma_f32_16x16x32_f16 v[228:231], v[196:199], a[216:219], v[228:231]
  v_rcp_f16 v212, v213
  v_mfma_f32_16x16x32_f16 v[232:235], v[200:203], a[216:219], v[232:235]
  v_rcp_f16 v215, v216
  v_mfma_f32_16x16x32_f16 v[236:239], v[204:207], a[216:219], v[236:239]
  s_waitcnt lgkmcnt(2)
  v_rcp_f16 v218, v219
  v_rcp_f16_sdwa v209, v210 dst_sel:WORD_1 dst_unused:UNUSED_PRESERVE src0_sel:WORD_1
  v_mfma_f32_16x16x32_f16 v[240:243], v[192:195], a[220:223], v[240:243]
  v_rcp_f16_sdwa v212, v213 dst_sel:WORD_1 dst_unused:UNUSED_PRESERVE src0_sel:WORD_1
  v_mfma_f32_16x16x32_f16 v[244:247], v[196:199], a[220:223], v[244:247]
  v_rcp_f16_sdwa v215, v216 dst_sel:WORD_1 dst_unused:UNUSED_PRESERVE src0_sel:WORD_1
  v_mfma_f32_16x16x32_f16 v[248:251], v[200:203], a[220:223], v[248:251]
  v_rcp_f16_sdwa v218, v219 dst_sel:WORD_1 dst_unused:UNUSED_PRESERVE src0_sel:WORD_1
  v_pk_mul_f16 v184, v208, v209
  v_mfma_f32_16x16x32_f16 v[252:255], v[204:207], a[220:223], v[252:255]
  v_pk_mul_f16 v185, v211, v212
  v_pk_mul_f16 v188, v214, v215
  v_pk_mul_f16 v189, v217, v218
  s_waitcnt lgkmcnt(0)
  s_waitcnt vmcnt(2)
  s_barrier
  v_mfma_f32_16x16x32_bf16 v[144:147], a[160:163], v[16:19], 0
  v_add_u32 v220, s54, v11
  v_cvt_pk_f16_f32 v208, v128, v129
  v_cvt_pk_f16_f32 v211, v130, v131
  v_mfma_f32_16x16x32_bf16 v[144:147], a[164:167], v[32:35], v[144:147]
  s_add_u32 m0, s29, 24576
  v_cvt_pk_f16_f32 v214, v132, v133
  v_cvt_pk_f16_f32 v217, v134, v135
  v_mfma_f32_16x16x32_bf16 v[144:147], a[168:171], v[48:51], v[144:147]
  buffer_load_dwordx4 v1, s[16:19], s20 offen offset:0 lds
  v_pk_fma_f16 v209, v208, v208, s28
  v_mfma_f32_16x16x32_bf16 v[144:147], a[172:175], v[64:67], v[144:147]
  v_pk_fma_f16 v212, v211, v211, s28
  v_pk_fma_f16 v215, v214, v214, s28
  v_pk_fma_f16 v218, v217, v217, s28
  v_mfma_f32_16x16x32_bf16 v[144:147], a[176:179], v[80:83], v[144:147]
  v_pk_mul_f16 v209, v209, v208
  v_pk_mul_f16 v212, v212, v211
  v_pk_mul_f16 v215, v215, v214
  v_mfma_f32_16x16x32_bf16 v[144:147], a[180:183], v[96:99], v[144:147]
  ds_write2_b32 v220, a232, a236 offset0:0 offset1:11
  v_pk_mul_f16 v218, v218, v217
  v_mfma_f32_16x16x32_bf16 v[148:151], a[160:163], v[20:23], 0
  buffer_load_dwordx4 v1, s[16:19], s20 offen offset:1024 lds
  v_mfma_f32_16x16x32_bf16 v[148:151], a[164:167], v[36:39], v[148:151]
  v_exp_f16 v210, v209
  v_exp_f16 v213, v212
  v_mfma_f32_16x16x32_bf16 v[148:151], a[168:171], v[52:55], v[148:151]
  v_exp_f16 v216, v215
  v_mfma_f32_16x16x32_bf16 v[148:151], a[172:175], v[68:71], v[148:151]
  v_exp_f16 v219, v218
  v_mfma_f32_16x16x32_bf16 v[148:151], a[176:179], v[84:87], v[148:151]
  buffer_load_dwordx4 v1, s[16:19], s20 offen offset:2048 lds
  v_exp_f16_sdwa v210, v209 dst_sel:WORD_1 dst_unused:UNUSED_PRESERVE src0_sel:WORD_1
  v_mfma_f32_16x16x32_bf16 v[148:151], a[180:183], v[100:103], v[148:151]
  v_exp_f16_sdwa v213, v212 dst_sel:WORD_1 dst_unused:UNUSED_PRESERVE src0_sel:WORD_1
  v_mfma_f32_16x16x32_bf16 v[152:155], a[160:163], v[24:27], 0
  v_exp_f16_sdwa v216, v215 dst_sel:WORD_1 dst_unused:UNUSED_PRESERVE src0_sel:WORD_1
  v_mfma_f32_16x16x32_bf16 v[152:155], a[164:167], v[40:43], v[152:155]
  v_exp_f16_sdwa v219, v218 dst_sel:WORD_1 dst_unused:UNUSED_PRESERVE src0_sel:WORD_1
  v_pk_fma_f16 v210, v210, s56, s56
  v_pk_fma_f16 v213, v213, s56, s56
  v_mfma_f32_16x16x32_bf16 v[152:155], a[168:171], v[56:59], v[152:155]
  buffer_load_dwordx4 v1, s[16:19], s20 offen offset:3072 lds
  v_pk_fma_f16 v216, v216, s56, s56
  v_mfma_f32_16x16x32_bf16 v[152:155], a[172:175], v[72:75], v[152:155]
  ds_write2_b32 v220, a233, a237 offset0:22 offset1:33
  v_pk_fma_f16 v219, v219, s56, s56
  v_mfma_f32_16x16x32_bf16 v[152:155], a[176:179], v[88:91], v[152:155]
  v_rcp_f16 v209, v210
  v_mfma_f32_16x16x32_bf16 v[152:155], a[180:183], v[104:107], v[152:155]
  s_add_u32 m0, s29, 28672
  s_add_u32 s20, s20, 4096
  v_rcp_f16 v212, v213
  v_mfma_f32_16x16x32_bf16 v[156:159], a[160:163], v[28:31], 0
  buffer_load_dwordx4 v1, s[16:19], s20 offen offset:0 lds
  v_mfma_f32_16x16x32_bf16 v[156:159], a[164:167], v[44:47], v[156:159]
  v_rcp_f16 v215, v216
  v_rcp_f16 v218, v219
  v_mfma_f32_16x16x32_bf16 v[156:159], a[168:171], v[60:63], v[156:159]
  v_rcp_f16_sdwa v209, v210 dst_sel:WORD_1 dst_unused:UNUSED_PRESERVE src0_sel:WORD_1
  v_mfma_f32_16x16x32_bf16 v[156:159], a[172:175], v[76:79], v[156:159]
  v_rcp_f16_sdwa v212, v213 dst_sel:WORD_1 dst_unused:UNUSED_PRESERVE src0_sel:WORD_1
  v_rcp_f16_sdwa v215, v216 dst_sel:WORD_1 dst_unused:UNUSED_PRESERVE src0_sel:WORD_1
  v_mfma_f32_16x16x32_bf16 v[156:159], a[176:179], v[92:95], v[156:159]
  buffer_load_dwordx4 v1, s[16:19], s20 offen offset:1024 lds
  v_mfma_f32_16x16x32_bf16 v[156:159], a[180:183], v[108:111], v[156:159]
  s_add_u32 s20, s20, 20480
  v_rcp_f16_sdwa v218, v219 dst_sel:WORD_1 dst_unused:UNUSED_PRESERVE src0_sel:WORD_1
  v_pk_mul_f16 v178, v208, v209
  v_mfma_f32_16x16x32_bf16 v[160:163], a[184:187], v[16:19], 0
  v_pk_mul_f16 v179, v211, v212
  v_pk_mul_f16 v182, v214, v215
  v_pk_mul_f16 v183, v217, v218
  v_mfma_f32_16x16x32_bf16 v[160:163], a[188:191], v[32:35], v[160:163]
  ds_write2_b32 v220, a234, a238 offset0:44 offset1:55
  v_cvt_pk_f16_f32 v208, v136, v137
  v_mfma_f32_16x16x32_bf16 v[160:163], a[192:195], v[48:51], v[160:163]
  v_cvt_pk_f16_f32 v211, v138, v139
  v_cvt_pk_f16_f32 v214, v140, v141
  v_cvt_pk_f16_f32 v217, v142, v143
  v_mfma_f32_16x16x32_bf16 v[160:163], a[196:199], v[64:67], v[160:163]
  v_pk_fma_f16 v209, v208, v208, s28
  v_pk_fma_f16 v212, v211, v211, s28
  v_pk_fma_f16 v215, v214, v214, s28
  v_mfma_f32_16x16x32_bf16 v[160:163], a[200:203], v[80:83], v[160:163]
  v_pk_fma_f16 v218, v217, v217, s28
  v_pk_mul_f16 v209, v209, v208
  v_pk_mul_f16 v212, v212, v211
  v_mfma_f32_16x16x32_bf16 v[160:163], a[204:207], v[96:99], v[160:163]
  v_pk_mul_f16 v215, v215, v214
  v_pk_mul_f16 v218, v218, v217
  v_mfma_f32_16x16x32_bf16 v[164:167], a[184:187], v[20:23], 0
  ds_read_b128 a[208:211], v1 offset:12288
  v_exp_f16 v210, v209
  v_mfma_f32_16x16x32_bf16 v[164:167], a[188:191], v[36:39], v[164:167]
  v_exp_f16 v213, v212
  v_mfma_f32_16x16x32_bf16 v[164:167], a[192:195], v[52:55], v[164:167]
  v_exp_f16 v216, v215
  v_mfma_f32_16x16x32_bf16 v[164:167], a[196:199], v[68:71], v[164:167]
  v_exp_f16 v219, v218
  v_exp_f16_sdwa v210, v209 dst_sel:WORD_1 dst_unused:UNUSED_PRESERVE src0_sel:WORD_1
  v_mfma_f32_16x16x32_bf16 v[164:167], a[200:203], v[84:87], v[164:167]
  ds_read_b128 a[212:215], v1 offset:13312
  v_exp_f16_sdwa v213, v212 dst_sel:WORD_1 dst_unused:UNUSED_PRESERVE src0_sel:WORD_1
  v_mfma_f32_16x16x32_bf16 v[164:167], a[204:207], v[100:103], v[164:167]
  ds_write2_b32 v220, a235, a239 offset0:66 offset1:77
  v_exp_f16_sdwa v216, v215 dst_sel:WORD_1 dst_unused:UNUSED_PRESERVE src0_sel:WORD_1
  v_mfma_f32_16x16x32_bf16 v[168:171], a[184:187], v[24:27], 0
  v_exp_f16_sdwa v219, v218 dst_sel:WORD_1 dst_unused:UNUSED_PRESERVE src0_sel:WORD_1
  v_mfma_f32_16x16x32_bf16 v[168:171], a[188:191], v[40:43], v[168:171]
  v_pk_fma_f16 v210, v210, s56, s56
  v_pk_fma_f16 v213, v213, s56, s56
  v_pk_fma_f16 v216, v216, s56, s56
  v_mfma_f32_16x16x32_bf16 v[168:171], a[192:195], v[56:59], v[168:171]
  ds_read_b128 a[216:219], v1 offset:14336
  v_pk_fma_f16 v219, v219, s56, s56
  v_mfma_f32_16x16x32_bf16 v[168:171], a[196:199], v[72:75], v[168:171]
  buffer_load_dwordx4 a[232:235], v3, s[8:11], s55 offen
  v_mfma_f32_16x16x32_bf16 v[168:171], a[200:203], v[88:91], v[168:171]
  v_rcp_f16 v209, v210
  v_rcp_f16 v212, v213
  v_mfma_f32_16x16x32_bf16 v[168:171], a[204:207], v[104:107], v[168:171]
  v_rcp_f16 v215, v216
  v_mfma_f32_16x16x32_bf16 v[172:175], a[184:187], v[28:31], 0
  ds_read_b128 a[220:223], v1 offset:15360
  v_rcp_f16 v218, v219
  v_mfma_f32_16x16x32_bf16 v[172:175], a[188:191], v[44:47], v[172:175]
  v_rcp_f16_sdwa v209, v210 dst_sel:WORD_1 dst_unused:UNUSED_PRESERVE src0_sel:WORD_1
  v_mfma_f32_16x16x32_bf16 v[172:175], a[192:195], v[60:63], v[172:175]
  buffer_load_dwordx4 a[236:239], v7, s[8:11], s55 offen
  v_rcp_f16_sdwa v212, v213 dst_sel:WORD_1 dst_unused:UNUSED_PRESERVE src0_sel:WORD_1
  v_mfma_f32_16x16x32_bf16 v[172:175], a[196:199], v[76:79], v[172:175]
  v_rcp_f16_sdwa v215, v216 dst_sel:WORD_1 dst_unused:UNUSED_PRESERVE src0_sel:WORD_1
  v_mfma_f32_16x16x32_bf16 v[172:175], a[200:203], v[92:95], v[172:175]
  v_rcp_f16_sdwa v218, v219 dst_sel:WORD_1 dst_unused:UNUSED_PRESERVE src0_sel:WORD_1
  v_pk_mul_f16 v186, v208, v209
  v_mfma_f32_16x16x32_bf16 v[172:175], a[204:207], v[108:111], v[172:175]
  v_pk_mul_f16 v187, v211, v212
  v_pk_mul_f16 v190, v214, v215
  v_pk_mul_f16 v191, v217, v218
  s_waitcnt lgkmcnt(4)
  v_mfma_f32_16x16x32_f16 a[0:3], v[176:179], a[208:211], a[0:3]
  v_cvt_pk_f16_f32 v208, v144, v145
  v_cvt_pk_f16_f32 v211, v146, v147
  v_cvt_pk_f16_f32 v214, v148, v149
  v_mfma_f32_16x16x32_f16 a[4:7], v[180:183], a[208:211], a[4:7]
  ds_read_b128 a[160:163], v1 offset:0
  v_cvt_pk_f16_f32 v217, v150, v151
  v_mfma_f32_16x16x32_f16 a[8:11], v[184:187], a[208:211], a[8:11]
  v_pk_fma_f16 v209, v208, v208, s28
  v_pk_fma_f16 v212, v211, v211, s28
  v_pk_fma_f16 v215, v214, v214, s28
  v_mfma_f32_16x16x32_f16 a[12:15], v[188:191], a[208:211], a[12:15]
  s_waitcnt lgkmcnt(4)
  ds_read_b128 a[208:211], v1 offset:16384
  v_pk_fma_f16 v218, v217, v217, s28
  v_mfma_f32_16x16x32_f16 a[16:19], v[176:179], a[212:215], a[16:19]
  ds_read_b128 a[164:167], v1 offset:1024
  v_pk_mul_f16 v209, v209, v208
  v_pk_mul_f16 v212, v212, v211
  v_mfma_f32_16x16x32_f16 a[20:23], v[180:183], a[212:215], a[20:23]
  v_pk_mul_f16 v215, v215, v214
  v_pk_mul_f16 v218, v218, v217
  v_mfma_f32_16x16x32_f16 a[24:27], v[184:187], a[212:215], a[24:27]
  v_exp_f16 v210, v209
  v_mfma_f32_16x16x32_f16 a[28:31], v[188:191], a[212:215], a[28:31]
  s_waitcnt lgkmcnt(4)
  ds_read_b128 a[212:215], v1 offset:17408
  v_exp_f16 v213, v212
  v_mfma_f32_16x16x32_f16 a[32:35], v[176:179], a[216:219], a[32:35]
  ds_read_b128 a[168:171], v1 offset:2048
  v_exp_f16 v216, v215
  v_mfma_f32_16x16x32_f16 a[36:39], v[180:183], a[216:219], a[36:39]
  v_exp_f16 v219, v218
  v_mfma_f32_16x16x32_f16 a[40:43], v[184:187], a[216:219], a[40:43]
  ds_read_b128 a[172:175], v1 offset:3072
  v_exp_f16_sdwa v210, v209 dst_sel:WORD_1 dst_unused:UNUSED_PRESERVE src0_sel:WORD_1
  v_mfma_f32_16x16x32_f16 a[44:47], v[188:191], a[216:219], a[44:47]
  s_waitcnt lgkmcnt(6)
  ds_read_b128 a[216:219], v1 offset:18432
  v_exp_f16_sdwa v213, v212 dst_sel:WORD_1 dst_unused:UNUSED_PRESERVE src0_sel:WORD_1
  v_mfma_f32_16x16x32_f16 a[48:51], v[176:179], a[220:223], a[48:51]
  v_exp_f16_sdwa v216, v215 dst_sel:WORD_1 dst_unused:UNUSED_PRESERVE src0_sel:WORD_1
  v_mfma_f32_16x16x32_f16 a[52:55], v[180:183], a[220:223], a[52:55]
  ds_read_b128 a[176:179], v1 offset:4096
  v_exp_f16_sdwa v219, v218 dst_sel:WORD_1 dst_unused:UNUSED_PRESERVE src0_sel:WORD_1
  v_mfma_f32_16x16x32_f16 a[56:59], v[184:187], a[220:223], a[56:59]
  v_pk_fma_f16 v210, v210, s56, s56
  v_pk_fma_f16 v213, v213, s56, s56
  v_pk_fma_f16 v216, v216, s56, s56
  v_mfma_f32_16x16x32_f16 a[60:63], v[188:191], a[220:223], a[60:63]
  s_waitcnt lgkmcnt(6)
  ds_read_b128 a[220:223], v1 offset:19456
  v_pk_fma_f16 v219, v219, s56, s56
  v_mfma_f32_16x16x32_f16 a[64:67], v[176:179], a[208:211], a[64:67]
  ds_read_b128 a[180:183], v1 offset:5120
  v_rcp_f16 v209, v210
  v_mfma_f32_16x16x32_f16 a[68:71], v[180:183], a[208:211], a[68:71]
  v_rcp_f16 v212, v213
  v_mfma_f32_16x16x32_f16 a[72:75], v[184:187], a[208:211], a[72:75]
  v_rcp_f16 v215, v216
  v_mfma_f32_16x16x32_f16 a[76:79], v[188:191], a[208:211], a[76:79]
  s_waitcnt lgkmcnt(6)
  ds_read_b128 a[208:211], v1 offset:20480
  v_rcp_f16 v218, v219
  v_mfma_f32_16x16x32_f16 a[80:83], v[176:179], a[212:215], a[80:83]
  ds_read_b128 a[184:187], v1 offset:6144
  v_rcp_f16_sdwa v209, v210 dst_sel:WORD_1 dst_unused:UNUSED_PRESERVE src0_sel:WORD_1
  v_mfma_f32_16x16x32_f16 a[84:87], v[180:183], a[212:215], a[84:87]
  v_rcp_f16_sdwa v212, v213 dst_sel:WORD_1 dst_unused:UNUSED_PRESERVE src0_sel:WORD_1
  v_mfma_f32_16x16x32_f16 a[88:91], v[184:187], a[212:215], a[88:91]
  ds_read_b128 a[188:191], v1 offset:7168
  v_rcp_f16_sdwa v215, v216 dst_sel:WORD_1 dst_unused:UNUSED_PRESERVE src0_sel:WORD_1
  v_mfma_f32_16x16x32_f16 a[92:95], v[188:191], a[212:215], a[92:95]
  s_waitcnt lgkmcnt(6)
  ds_read_b128 a[212:215], v1 offset:21504
  v_rcp_f16_sdwa v218, v219 dst_sel:WORD_1 dst_unused:UNUSED_PRESERVE src0_sel:WORD_1
  v_mfma_f32_16x16x32_f16 a[96:99], v[176:179], a[216:219], a[96:99]
  v_pk_mul_f16 v192, v208, v209
  v_pk_mul_f16 v193, v211, v212
  v_pk_mul_f16 v196, v214, v215
  v_mfma_f32_16x16x32_f16 a[100:103], v[180:183], a[216:219], a[100:103]
  ds_read_b128 a[192:195], v1 offset:8192
  v_pk_mul_f16 v197, v217, v218
  v_mfma_f32_16x16x32_f16 a[104:107], v[184:187], a[216:219], a[104:107]
  v_cvt_pk_f16_f32 v208, v152, v153
  v_cvt_pk_f16_f32 v211, v154, v155
  v_cvt_pk_f16_f32 v214, v156, v157
  v_mfma_f32_16x16x32_f16 a[108:111], v[188:191], a[216:219], a[108:111]
  s_waitcnt lgkmcnt(6)
  ds_read_b128 a[216:219], v1 offset:22528
  v_cvt_pk_f16_f32 v217, v158, v159
  v_mfma_f32_16x16x32_f16 a[112:115], v[176:179], a[220:223], a[112:115]
  ds_read_b128 a[196:199], v1 offset:9216
  v_pk_fma_f16 v209, v208, v208, s28
  v_pk_fma_f16 v212, v211, v211, s28
  v_mfma_f32_16x16x32_f16 a[116:119], v[180:183], a[220:223], a[116:119]
  v_pk_fma_f16 v215, v214, v214, s28
  v_pk_fma_f16 v218, v217, v217, s28
  v_pk_mul_f16 v209, v209, v208
  v_mfma_f32_16x16x32_f16 a[120:123], v[184:187], a[220:223], a[120:123]
  v_pk_mul_f16 v212, v212, v211
  v_pk_mul_f16 v215, v215, v214
  v_mfma_f32_16x16x32_f16 a[124:127], v[188:191], a[220:223], a[124:127]
  s_waitcnt lgkmcnt(6)
  ds_read_b128 a[220:223], v1 offset:23552
  v_pk_mul_f16 v218, v218, v217
  v_mfma_f32_16x16x32_f16 a[128:131], v[176:179], a[208:211], a[128:131]
  ds_read_b128 a[200:203], v1 offset:10240
  v_exp_f16 v210, v209
  v_mfma_f32_16x16x32_f16 a[132:135], v[180:183], a[208:211], a[132:135]
  v_exp_f16 v213, v212
  v_mfma_f32_16x16x32_f16 a[136:139], v[184:187], a[208:211], a[136:139]
  ds_read_b128 a[204:207], v1 offset:11264
  v_exp_f16 v216, v215
  v_mfma_f32_16x16x32_f16 a[140:143], v[188:191], a[208:211], a[140:143]
  s_waitcnt lgkmcnt(6)
  v_exp_f16 v219, v218
  v_mfma_f32_16x16x32_f16 a[144:147], v[176:179], a[212:215], a[144:147]
  v_exp_f16_sdwa v210, v209 dst_sel:WORD_1 dst_unused:UNUSED_PRESERVE src0_sel:WORD_1
  v_exp_f16_sdwa v213, v212 dst_sel:WORD_1 dst_unused:UNUSED_PRESERVE src0_sel:WORD_1
  v_mfma_f32_16x16x32_f16 a[148:151], v[180:183], a[212:215], a[148:151]
  v_exp_f16_sdwa v216, v215 dst_sel:WORD_1 dst_unused:UNUSED_PRESERVE src0_sel:WORD_1
  v_mfma_f32_16x16x32_f16 a[152:155], v[184:187], a[212:215], a[152:155]
  v_exp_f16_sdwa v219, v218 dst_sel:WORD_1 dst_unused:UNUSED_PRESERVE src0_sel:WORD_1
  v_pk_fma_f16 v210, v210, s56, s56
  v_mfma_f32_16x16x32_f16 a[156:159], v[188:191], a[212:215], a[156:159]
  s_waitcnt lgkmcnt(4)
  v_pk_fma_f16 v213, v213, s56, s56
  v_pk_fma_f16 v216, v216, s56, s56
  v_mfma_f32_16x16x32_f16 v[224:227], v[176:179], a[216:219], v[224:227]
  v_pk_fma_f16 v219, v219, s56, s56
  v_rcp_f16 v209, v210
  v_mfma_f32_16x16x32_f16 v[228:231], v[180:183], a[216:219], v[228:231]
  v_rcp_f16 v212, v213
  v_mfma_f32_16x16x32_f16 v[232:235], v[184:187], a[216:219], v[232:235]
  v_rcp_f16 v215, v216
  v_mfma_f32_16x16x32_f16 v[236:239], v[188:191], a[216:219], v[236:239]
  s_waitcnt lgkmcnt(2)
  v_rcp_f16 v218, v219
  v_rcp_f16_sdwa v209, v210 dst_sel:WORD_1 dst_unused:UNUSED_PRESERVE src0_sel:WORD_1
  v_mfma_f32_16x16x32_f16 v[240:243], v[176:179], a[220:223], v[240:243]
  v_rcp_f16_sdwa v212, v213 dst_sel:WORD_1 dst_unused:UNUSED_PRESERVE src0_sel:WORD_1
  v_mfma_f32_16x16x32_f16 v[244:247], v[180:183], a[220:223], v[244:247]
  v_rcp_f16_sdwa v215, v216 dst_sel:WORD_1 dst_unused:UNUSED_PRESERVE src0_sel:WORD_1
  v_mfma_f32_16x16x32_f16 v[248:251], v[184:187], a[220:223], v[248:251]
  v_rcp_f16_sdwa v218, v219 dst_sel:WORD_1 dst_unused:UNUSED_PRESERVE src0_sel:WORD_1
  v_pk_mul_f16 v200, v208, v209
  v_mfma_f32_16x16x32_f16 v[252:255], v[188:191], a[220:223], v[252:255]
  v_pk_mul_f16 v201, v211, v212
  v_pk_mul_f16 v204, v214, v215
  v_pk_mul_f16 v205, v217, v218
  s_waitcnt lgkmcnt(0)
  s_waitcnt vmcnt(2)
  s_barrier
  v_mfma_f32_16x16x32_bf16 v[112:115], a[160:163], v[16:19], 0
  v_add_u32 v220, s54, v12
  v_cvt_pk_f16_f32 v208, v160, v161
  v_cvt_pk_f16_f32 v211, v162, v163
  v_mfma_f32_16x16x32_bf16 v[112:115], a[164:167], v[32:35], v[112:115]
  s_add_u32 m0, s29, 0
  v_cvt_pk_f16_f32 v214, v164, v165
  v_cvt_pk_f16_f32 v217, v166, v167
  v_mfma_f32_16x16x32_bf16 v[112:115], a[168:171], v[48:51], v[112:115]
  buffer_load_dwordx4 v1, s[16:19], s20 offen offset:0 lds
  v_pk_fma_f16 v209, v208, v208, s28
  v_mfma_f32_16x16x32_bf16 v[112:115], a[172:175], v[64:67], v[112:115]
  v_pk_fma_f16 v212, v211, v211, s28
  v_pk_fma_f16 v215, v214, v214, s28
  v_pk_fma_f16 v218, v217, v217, s28
  v_mfma_f32_16x16x32_bf16 v[112:115], a[176:179], v[80:83], v[112:115]
  v_pk_mul_f16 v209, v209, v208
  v_pk_mul_f16 v212, v212, v211
  v_pk_mul_f16 v215, v215, v214
  v_mfma_f32_16x16x32_bf16 v[112:115], a[180:183], v[96:99], v[112:115]
  ds_write2_b32 v220, a240, a244 offset0:0 offset1:11
  v_pk_mul_f16 v218, v218, v217
  v_mfma_f32_16x16x32_bf16 v[116:119], a[160:163], v[20:23], 0
  buffer_load_dwordx4 v1, s[16:19], s20 offen offset:1024 lds
  v_mfma_f32_16x16x32_bf16 v[116:119], a[164:167], v[36:39], v[116:119]
  v_exp_f16 v210, v209
  v_exp_f16 v213, v212
  v_mfma_f32_16x16x32_bf16 v[116:119], a[168:171], v[52:55], v[116:119]
  v_exp_f16 v216, v215
  v_mfma_f32_16x16x32_bf16 v[116:119], a[172:175], v[68:71], v[116:119]
  v_exp_f16 v219, v218
  v_mfma_f32_16x16x32_bf16 v[116:119], a[176:179], v[84:87], v[116:119]
  buffer_load_dwordx4 v1, s[16:19], s20 offen offset:2048 lds
  v_exp_f16_sdwa v210, v209 dst_sel:WORD_1 dst_unused:UNUSED_PRESERVE src0_sel:WORD_1
  v_mfma_f32_16x16x32_bf16 v[116:119], a[180:183], v[100:103], v[116:119]
  v_exp_f16_sdwa v213, v212 dst_sel:WORD_1 dst_unused:UNUSED_PRESERVE src0_sel:WORD_1
  v_mfma_f32_16x16x32_bf16 v[120:123], a[160:163], v[24:27], 0
  v_exp_f16_sdwa v216, v215 dst_sel:WORD_1 dst_unused:UNUSED_PRESERVE src0_sel:WORD_1
  v_mfma_f32_16x16x32_bf16 v[120:123], a[164:167], v[40:43], v[120:123]
  v_exp_f16_sdwa v219, v218 dst_sel:WORD_1 dst_unused:UNUSED_PRESERVE src0_sel:WORD_1
  v_pk_fma_f16 v210, v210, s56, s56
  v_pk_fma_f16 v213, v213, s56, s56
  v_mfma_f32_16x16x32_bf16 v[120:123], a[168:171], v[56:59], v[120:123]
  buffer_load_dwordx4 v1, s[16:19], s20 offen offset:3072 lds
  v_pk_fma_f16 v216, v216, s56, s56
  v_mfma_f32_16x16x32_bf16 v[120:123], a[172:175], v[72:75], v[120:123]
  ds_write2_b32 v220, a241, a245 offset0:22 offset1:33
  v_pk_fma_f16 v219, v219, s56, s56
  v_mfma_f32_16x16x32_bf16 v[120:123], a[176:179], v[88:91], v[120:123]
  v_rcp_f16 v209, v210
  v_mfma_f32_16x16x32_bf16 v[120:123], a[180:183], v[104:107], v[120:123]
  s_add_u32 m0, s29, 4096
  s_add_u32 s20, s20, 4096
  v_rcp_f16 v212, v213
  v_mfma_f32_16x16x32_bf16 v[124:127], a[160:163], v[28:31], 0
  buffer_load_dwordx4 v1, s[16:19], s20 offen offset:0 lds
  v_mfma_f32_16x16x32_bf16 v[124:127], a[164:167], v[44:47], v[124:127]
  v_rcp_f16 v215, v216
  v_rcp_f16 v218, v219
  v_mfma_f32_16x16x32_bf16 v[124:127], a[168:171], v[60:63], v[124:127]
  v_rcp_f16_sdwa v209, v210 dst_sel:WORD_1 dst_unused:UNUSED_PRESERVE src0_sel:WORD_1
  v_mfma_f32_16x16x32_bf16 v[124:127], a[172:175], v[76:79], v[124:127]
  v_rcp_f16_sdwa v212, v213 dst_sel:WORD_1 dst_unused:UNUSED_PRESERVE src0_sel:WORD_1
  v_rcp_f16_sdwa v215, v216 dst_sel:WORD_1 dst_unused:UNUSED_PRESERVE src0_sel:WORD_1
  v_mfma_f32_16x16x32_bf16 v[124:127], a[176:179], v[92:95], v[124:127]
  buffer_load_dwordx4 v1, s[16:19], s20 offen offset:1024 lds
  v_mfma_f32_16x16x32_bf16 v[124:127], a[180:183], v[108:111], v[124:127]
  s_add_u32 s20, s20, 20480
  v_rcp_f16_sdwa v218, v219 dst_sel:WORD_1 dst_unused:UNUSED_PRESERVE src0_sel:WORD_1
  v_pk_mul_f16 v194, v208, v209
  v_mfma_f32_16x16x32_bf16 v[128:131], a[184:187], v[16:19], 0
  v_pk_mul_f16 v195, v211, v212
  v_pk_mul_f16 v198, v214, v215
  v_pk_mul_f16 v199, v217, v218
  v_mfma_f32_16x16x32_bf16 v[128:131], a[188:191], v[32:35], v[128:131]
  ds_write2_b32 v220, a242, a246 offset0:44 offset1:55
  v_cvt_pk_f16_f32 v208, v168, v169
  v_mfma_f32_16x16x32_bf16 v[128:131], a[192:195], v[48:51], v[128:131]
  v_cvt_pk_f16_f32 v211, v170, v171
  v_cvt_pk_f16_f32 v214, v172, v173
  v_cvt_pk_f16_f32 v217, v174, v175
  v_mfma_f32_16x16x32_bf16 v[128:131], a[196:199], v[64:67], v[128:131]
  v_pk_fma_f16 v209, v208, v208, s28
  v_pk_fma_f16 v212, v211, v211, s28
  v_pk_fma_f16 v215, v214, v214, s28
  v_mfma_f32_16x16x32_bf16 v[128:131], a[200:203], v[80:83], v[128:131]
  v_pk_fma_f16 v218, v217, v217, s28
  v_pk_mul_f16 v209, v209, v208
  v_pk_mul_f16 v212, v212, v211
  v_mfma_f32_16x16x32_bf16 v[128:131], a[204:207], v[96:99], v[128:131]
  v_pk_mul_f16 v215, v215, v214
  v_pk_mul_f16 v218, v218, v217
  v_mfma_f32_16x16x32_bf16 v[132:135], a[184:187], v[20:23], 0
  ds_read_b128 a[208:211], v1 offset:36864
  v_exp_f16 v210, v209
  v_mfma_f32_16x16x32_bf16 v[132:135], a[188:191], v[36:39], v[132:135]
  v_exp_f16 v213, v212
  v_mfma_f32_16x16x32_bf16 v[132:135], a[192:195], v[52:55], v[132:135]
  v_exp_f16 v216, v215
  v_mfma_f32_16x16x32_bf16 v[132:135], a[196:199], v[68:71], v[132:135]
  v_exp_f16 v219, v218
  v_exp_f16_sdwa v210, v209 dst_sel:WORD_1 dst_unused:UNUSED_PRESERVE src0_sel:WORD_1
  v_mfma_f32_16x16x32_bf16 v[132:135], a[200:203], v[84:87], v[132:135]
  ds_read_b128 a[212:215], v1 offset:37888
  v_exp_f16_sdwa v213, v212 dst_sel:WORD_1 dst_unused:UNUSED_PRESERVE src0_sel:WORD_1
  v_mfma_f32_16x16x32_bf16 v[132:135], a[204:207], v[100:103], v[132:135]
  ds_write2_b32 v220, a243, a247 offset0:66 offset1:77
  v_exp_f16_sdwa v216, v215 dst_sel:WORD_1 dst_unused:UNUSED_PRESERVE src0_sel:WORD_1
  v_mfma_f32_16x16x32_bf16 v[136:139], a[184:187], v[24:27], 0
  v_exp_f16_sdwa v219, v218 dst_sel:WORD_1 dst_unused:UNUSED_PRESERVE src0_sel:WORD_1
  v_mfma_f32_16x16x32_bf16 v[136:139], a[188:191], v[40:43], v[136:139]
  v_pk_fma_f16 v210, v210, s56, s56
  v_pk_fma_f16 v213, v213, s56, s56
  v_pk_fma_f16 v216, v216, s56, s56
  v_mfma_f32_16x16x32_bf16 v[136:139], a[192:195], v[56:59], v[136:139]
  ds_read_b128 a[216:219], v1 offset:38912
  v_pk_fma_f16 v219, v219, s56, s56
  v_mfma_f32_16x16x32_bf16 v[136:139], a[196:199], v[72:75], v[136:139]
  buffer_load_dwordx4 a[240:243], v4, s[8:11], s55 offen
  v_mfma_f32_16x16x32_bf16 v[136:139], a[200:203], v[88:91], v[136:139]
  v_rcp_f16 v209, v210
  v_rcp_f16 v212, v213
  v_mfma_f32_16x16x32_bf16 v[136:139], a[204:207], v[104:107], v[136:139]
  v_rcp_f16 v215, v216
  v_mfma_f32_16x16x32_bf16 v[140:143], a[184:187], v[28:31], 0
  ds_read_b128 a[220:223], v1 offset:39936
  v_rcp_f16 v218, v219
  v_mfma_f32_16x16x32_bf16 v[140:143], a[188:191], v[44:47], v[140:143]
  v_rcp_f16_sdwa v209, v210 dst_sel:WORD_1 dst_unused:UNUSED_PRESERVE src0_sel:WORD_1
  v_mfma_f32_16x16x32_bf16 v[140:143], a[192:195], v[60:63], v[140:143]
  buffer_load_dwordx4 a[244:247], v8, s[8:11], s55 offen
  v_rcp_f16_sdwa v212, v213 dst_sel:WORD_1 dst_unused:UNUSED_PRESERVE src0_sel:WORD_1
  v_mfma_f32_16x16x32_bf16 v[140:143], a[196:199], v[76:79], v[140:143]
  v_rcp_f16_sdwa v215, v216 dst_sel:WORD_1 dst_unused:UNUSED_PRESERVE src0_sel:WORD_1
  v_mfma_f32_16x16x32_bf16 v[140:143], a[200:203], v[92:95], v[140:143]
  v_rcp_f16_sdwa v218, v219 dst_sel:WORD_1 dst_unused:UNUSED_PRESERVE src0_sel:WORD_1
  v_pk_mul_f16 v202, v208, v209
  v_mfma_f32_16x16x32_bf16 v[140:143], a[204:207], v[108:111], v[140:143]
  v_pk_mul_f16 v203, v211, v212
  v_pk_mul_f16 v206, v214, v215
  v_pk_mul_f16 v207, v217, v218
  s_waitcnt lgkmcnt(4)
  v_mfma_f32_16x16x32_f16 a[0:3], v[192:195], a[208:211], a[0:3]
  v_cvt_pk_f16_f32 v208, v112, v113
  v_cvt_pk_f16_f32 v211, v114, v115
  v_cvt_pk_f16_f32 v214, v116, v117
  v_mfma_f32_16x16x32_f16 a[4:7], v[196:199], a[208:211], a[4:7]
  ds_read_b128 a[160:163], v1 offset:24576
  v_cvt_pk_f16_f32 v217, v118, v119
  v_mfma_f32_16x16x32_f16 a[8:11], v[200:203], a[208:211], a[8:11]
  v_pk_fma_f16 v209, v208, v208, s28
  v_pk_fma_f16 v212, v211, v211, s28
  v_pk_fma_f16 v215, v214, v214, s28
  v_mfma_f32_16x16x32_f16 a[12:15], v[204:207], a[208:211], a[12:15]
  s_waitcnt lgkmcnt(4)
  ds_read_b128 a[208:211], v1 offset:40960
  v_pk_fma_f16 v218, v217, v217, s28
  v_mfma_f32_16x16x32_f16 a[16:19], v[192:195], a[212:215], a[16:19]
  ds_read_b128 a[164:167], v1 offset:25600
  v_pk_mul_f16 v209, v209, v208
  v_pk_mul_f16 v212, v212, v211
  v_mfma_f32_16x16x32_f16 a[20:23], v[196:199], a[212:215], a[20:23]
  v_pk_mul_f16 v215, v215, v214
  v_pk_mul_f16 v218, v218, v217
  v_mfma_f32_16x16x32_f16 a[24:27], v[200:203], a[212:215], a[24:27]
  v_exp_f16 v210, v209
  v_mfma_f32_16x16x32_f16 a[28:31], v[204:207], a[212:215], a[28:31]
  s_waitcnt lgkmcnt(4)
  ds_read_b128 a[212:215], v1 offset:41984
  v_exp_f16 v213, v212
  v_mfma_f32_16x16x32_f16 a[32:35], v[192:195], a[216:219], a[32:35]
  ds_read_b128 a[168:171], v1 offset:26624
  v_exp_f16 v216, v215
  v_mfma_f32_16x16x32_f16 a[36:39], v[196:199], a[216:219], a[36:39]
  v_exp_f16 v219, v218
  v_mfma_f32_16x16x32_f16 a[40:43], v[200:203], a[216:219], a[40:43]
  ds_read_b128 a[172:175], v1 offset:27648
  v_exp_f16_sdwa v210, v209 dst_sel:WORD_1 dst_unused:UNUSED_PRESERVE src0_sel:WORD_1
  v_mfma_f32_16x16x32_f16 a[44:47], v[204:207], a[216:219], a[44:47]
  s_waitcnt lgkmcnt(6)
  ds_read_b128 a[216:219], v1 offset:43008
  v_exp_f16_sdwa v213, v212 dst_sel:WORD_1 dst_unused:UNUSED_PRESERVE src0_sel:WORD_1
  v_mfma_f32_16x16x32_f16 a[48:51], v[192:195], a[220:223], a[48:51]
  v_exp_f16_sdwa v216, v215 dst_sel:WORD_1 dst_unused:UNUSED_PRESERVE src0_sel:WORD_1
  v_mfma_f32_16x16x32_f16 a[52:55], v[196:199], a[220:223], a[52:55]
  ds_read_b128 a[176:179], v1 offset:28672
  v_exp_f16_sdwa v219, v218 dst_sel:WORD_1 dst_unused:UNUSED_PRESERVE src0_sel:WORD_1
  v_mfma_f32_16x16x32_f16 a[56:59], v[200:203], a[220:223], a[56:59]
  v_pk_fma_f16 v210, v210, s56, s56
  v_pk_fma_f16 v213, v213, s56, s56
  v_pk_fma_f16 v216, v216, s56, s56
  v_mfma_f32_16x16x32_f16 a[60:63], v[204:207], a[220:223], a[60:63]
  s_waitcnt lgkmcnt(6)
  ds_read_b128 a[220:223], v1 offset:44032
  v_pk_fma_f16 v219, v219, s56, s56
  v_mfma_f32_16x16x32_f16 a[64:67], v[192:195], a[208:211], a[64:67]
  ds_read_b128 a[180:183], v1 offset:29696
  v_rcp_f16 v209, v210
  v_mfma_f32_16x16x32_f16 a[68:71], v[196:199], a[208:211], a[68:71]
  v_rcp_f16 v212, v213
  v_mfma_f32_16x16x32_f16 a[72:75], v[200:203], a[208:211], a[72:75]
  v_rcp_f16 v215, v216
  v_mfma_f32_16x16x32_f16 a[76:79], v[204:207], a[208:211], a[76:79]
  s_waitcnt lgkmcnt(6)
  ds_read_b128 a[208:211], v1 offset:45056
  v_rcp_f16 v218, v219
  v_mfma_f32_16x16x32_f16 a[80:83], v[192:195], a[212:215], a[80:83]
  ds_read_b128 a[184:187], v1 offset:30720
  v_rcp_f16_sdwa v209, v210 dst_sel:WORD_1 dst_unused:UNUSED_PRESERVE src0_sel:WORD_1
  v_mfma_f32_16x16x32_f16 a[84:87], v[196:199], a[212:215], a[84:87]
  v_rcp_f16_sdwa v212, v213 dst_sel:WORD_1 dst_unused:UNUSED_PRESERVE src0_sel:WORD_1
  v_mfma_f32_16x16x32_f16 a[88:91], v[200:203], a[212:215], a[88:91]
  ds_read_b128 a[188:191], v1 offset:31744
  v_rcp_f16_sdwa v215, v216 dst_sel:WORD_1 dst_unused:UNUSED_PRESERVE src0_sel:WORD_1
  v_mfma_f32_16x16x32_f16 a[92:95], v[204:207], a[212:215], a[92:95]
  s_waitcnt lgkmcnt(6)
  ds_read_b128 a[212:215], v1 offset:46080
  v_rcp_f16_sdwa v218, v219 dst_sel:WORD_1 dst_unused:UNUSED_PRESERVE src0_sel:WORD_1
  v_mfma_f32_16x16x32_f16 a[96:99], v[192:195], a[216:219], a[96:99]
  v_pk_mul_f16 v176, v208, v209
  v_pk_mul_f16 v177, v211, v212
  v_pk_mul_f16 v180, v214, v215
  v_mfma_f32_16x16x32_f16 a[100:103], v[196:199], a[216:219], a[100:103]
  ds_read_b128 a[192:195], v1 offset:32768
  v_pk_mul_f16 v181, v217, v218
  v_mfma_f32_16x16x32_f16 a[104:107], v[200:203], a[216:219], a[104:107]
  v_cvt_pk_f16_f32 v208, v120, v121
  v_cvt_pk_f16_f32 v211, v122, v123
  v_cvt_pk_f16_f32 v214, v124, v125
  v_mfma_f32_16x16x32_f16 a[108:111], v[204:207], a[216:219], a[108:111]
  s_waitcnt lgkmcnt(6)
  ds_read_b128 a[216:219], v1 offset:47104
  v_cvt_pk_f16_f32 v217, v126, v127
  v_mfma_f32_16x16x32_f16 a[112:115], v[192:195], a[220:223], a[112:115]
  ds_read_b128 a[196:199], v1 offset:33792
  v_pk_fma_f16 v209, v208, v208, s28
  v_pk_fma_f16 v212, v211, v211, s28
  v_mfma_f32_16x16x32_f16 a[116:119], v[196:199], a[220:223], a[116:119]
  v_pk_fma_f16 v215, v214, v214, s28
  v_pk_fma_f16 v218, v217, v217, s28
  v_pk_mul_f16 v209, v209, v208
  v_mfma_f32_16x16x32_f16 a[120:123], v[200:203], a[220:223], a[120:123]
  v_pk_mul_f16 v212, v212, v211
  v_pk_mul_f16 v215, v215, v214
  v_mfma_f32_16x16x32_f16 a[124:127], v[204:207], a[220:223], a[124:127]
  s_waitcnt lgkmcnt(6)
  ds_read_b128 a[220:223], v1 offset:48128
  v_pk_mul_f16 v218, v218, v217
  v_mfma_f32_16x16x32_f16 a[128:131], v[192:195], a[208:211], a[128:131]
  ds_read_b128 a[200:203], v1 offset:34816
  v_exp_f16 v210, v209
  v_mfma_f32_16x16x32_f16 a[132:135], v[196:199], a[208:211], a[132:135]
  v_exp_f16 v213, v212
  v_mfma_f32_16x16x32_f16 a[136:139], v[200:203], a[208:211], a[136:139]
  ds_read_b128 a[204:207], v1 offset:35840
  v_exp_f16 v216, v215
  v_mfma_f32_16x16x32_f16 a[140:143], v[204:207], a[208:211], a[140:143]
  s_waitcnt lgkmcnt(6)
  v_exp_f16 v219, v218
  v_mfma_f32_16x16x32_f16 a[144:147], v[192:195], a[212:215], a[144:147]
  v_exp_f16_sdwa v210, v209 dst_sel:WORD_1 dst_unused:UNUSED_PRESERVE src0_sel:WORD_1
  v_exp_f16_sdwa v213, v212 dst_sel:WORD_1 dst_unused:UNUSED_PRESERVE src0_sel:WORD_1
  v_mfma_f32_16x16x32_f16 a[148:151], v[196:199], a[212:215], a[148:151]
  v_exp_f16_sdwa v216, v215 dst_sel:WORD_1 dst_unused:UNUSED_PRESERVE src0_sel:WORD_1
  v_mfma_f32_16x16x32_f16 a[152:155], v[200:203], a[212:215], a[152:155]
  v_exp_f16_sdwa v219, v218 dst_sel:WORD_1 dst_unused:UNUSED_PRESERVE src0_sel:WORD_1
  v_pk_fma_f16 v210, v210, s56, s56
  v_mfma_f32_16x16x32_f16 a[156:159], v[204:207], a[212:215], a[156:159]
  s_waitcnt lgkmcnt(4)
  v_pk_fma_f16 v213, v213, s56, s56
  v_pk_fma_f16 v216, v216, s56, s56
  v_mfma_f32_16x16x32_f16 v[224:227], v[192:195], a[216:219], v[224:227]
  v_pk_fma_f16 v219, v219, s56, s56
  v_rcp_f16 v209, v210
  v_mfma_f32_16x16x32_f16 v[228:231], v[196:199], a[216:219], v[228:231]
  v_rcp_f16 v212, v213
  v_mfma_f32_16x16x32_f16 v[232:235], v[200:203], a[216:219], v[232:235]
  v_rcp_f16 v215, v216
  v_mfma_f32_16x16x32_f16 v[236:239], v[204:207], a[216:219], v[236:239]
  s_waitcnt lgkmcnt(2)
  v_rcp_f16 v218, v219
  v_rcp_f16_sdwa v209, v210 dst_sel:WORD_1 dst_unused:UNUSED_PRESERVE src0_sel:WORD_1
  v_mfma_f32_16x16x32_f16 v[240:243], v[192:195], a[220:223], v[240:243]
  v_rcp_f16_sdwa v212, v213 dst_sel:WORD_1 dst_unused:UNUSED_PRESERVE src0_sel:WORD_1
  v_mfma_f32_16x16x32_f16 v[244:247], v[196:199], a[220:223], v[244:247]
  v_rcp_f16_sdwa v215, v216 dst_sel:WORD_1 dst_unused:UNUSED_PRESERVE src0_sel:WORD_1
  v_mfma_f32_16x16x32_f16 v[248:251], v[200:203], a[220:223], v[248:251]
  v_rcp_f16_sdwa v218, v219 dst_sel:WORD_1 dst_unused:UNUSED_PRESERVE src0_sel:WORD_1
  v_pk_mul_f16 v184, v208, v209
  v_mfma_f32_16x16x32_f16 v[252:255], v[204:207], a[220:223], v[252:255]
  v_pk_mul_f16 v185, v211, v212
  v_pk_mul_f16 v188, v214, v215
  v_pk_mul_f16 v189, v217, v218
  s_waitcnt lgkmcnt(0)
  s_waitcnt vmcnt(2)
  s_barrier
  v_mfma_f32_16x16x32_bf16 v[144:147], a[160:163], v[16:19], 0
  v_add_u32 v220, s54, v13
  v_cvt_pk_f16_f32 v208, v128, v129
  v_cvt_pk_f16_f32 v211, v130, v131
  v_mfma_f32_16x16x32_bf16 v[144:147], a[164:167], v[32:35], v[144:147]
  s_add_u32 m0, s29, 24576
  v_cvt_pk_f16_f32 v214, v132, v133
  v_cvt_pk_f16_f32 v217, v134, v135
  v_pk_fma_f16 v209, v208, v208, s28
  v_mfma_f32_16x16x32_bf16 v[144:147], a[168:171], v[48:51], v[144:147]
  buffer_load_dwordx4 v1, s[16:19], s20 offen offset:0 lds
  v_mfma_f32_16x16x32_bf16 v[144:147], a[172:175], v[64:67], v[144:147]
  v_pk_fma_f16 v212, v211, v211, s28
  v_pk_fma_f16 v215, v214, v214, s28
  v_pk_fma_f16 v218, v217, v217, s28
  v_mfma_f32_16x16x32_bf16 v[144:147], a[176:179], v[80:83], v[144:147]
  v_pk_mul_f16 v209, v209, v208
  v_pk_mul_f16 v212, v212, v211
  v_pk_mul_f16 v215, v215, v214
  v_mfma_f32_16x16x32_bf16 v[144:147], a[180:183], v[96:99], v[144:147]
  s_mov_b64 exec, s[38:39]
  ds_write2_b32 v220, a248, a252 offset0:0 offset1:11
  s_mov_b64 exec, -1
  v_pk_mul_f16 v218, v218, v217
  v_mfma_f32_16x16x32_bf16 v[148:151], a[160:163], v[20:23], 0
  buffer_load_dwordx4 v1, s[16:19], s20 offen offset:1024 lds
  v_mfma_f32_16x16x32_bf16 v[148:151], a[164:167], v[36:39], v[148:151]
  v_exp_f16 v210, v209
  v_mfma_f32_16x16x32_bf16 v[148:151], a[168:171], v[52:55], v[148:151]
  v_exp_f16 v213, v212
  v_exp_f16 v216, v215
  v_mfma_f32_16x16x32_bf16 v[148:151], a[172:175], v[68:71], v[148:151]
  v_exp_f16 v219, v218
  v_mfma_f32_16x16x32_bf16 v[148:151], a[176:179], v[84:87], v[148:151]
  buffer_load_dwordx4 v1, s[16:19], s20 offen offset:2048 lds
  v_exp_f16_sdwa v210, v209 dst_sel:WORD_1 dst_unused:UNUSED_PRESERVE src0_sel:WORD_1
  v_mfma_f32_16x16x32_bf16 v[148:151], a[180:183], v[100:103], v[148:151]
  v_exp_f16_sdwa v213, v212 dst_sel:WORD_1 dst_unused:UNUSED_PRESERVE src0_sel:WORD_1
  v_mfma_f32_16x16x32_bf16 v[152:155], a[160:163], v[24:27], 0
  v_exp_f16_sdwa v216, v215 dst_sel:WORD_1 dst_unused:UNUSED_PRESERVE src0_sel:WORD_1
  v_mfma_f32_16x16x32_bf16 v[152:155], a[164:167], v[40:43], v[152:155]
  v_exp_f16_sdwa v219, v218 dst_sel:WORD_1 dst_unused:UNUSED_PRESERVE src0_sel:WORD_1
  v_pk_fma_f16 v210, v210, s56, s56
  v_pk_fma_f16 v213, v213, s56, s56
  v_mfma_f32_16x16x32_bf16 v[152:155], a[168:171], v[56:59], v[152:155]
  buffer_load_dwordx4 v1, s[16:19], s20 offen offset:3072 lds
  v_pk_fma_f16 v216, v216, s56, s56
  v_mfma_f32_16x16x32_bf16 v[152:155], a[172:175], v[72:75], v[152:155]
  s_mov_b64 exec, s[38:39]
  ds_write2_b32 v220, a249, a253 offset0:22 offset1:33
  s_mov_b64 exec, -1
  v_pk_fma_f16 v219, v219, s56, s56
  v_mfma_f32_16x16x32_bf16 v[152:155], a[176:179], v[88:91], v[152:155]
  v_rcp_f16 v209, v210
  v_mfma_f32_16x16x32_bf16 v[152:155], a[180:183], v[104:107], v[152:155]
  s_add_u32 m0, s29, 28672
  s_add_u32 s20, s20, 4096
  v_rcp_f16 v212, v213
  v_mfma_f32_16x16x32_bf16 v[156:159], a[160:163], v[28:31], 0
  buffer_load_dwordx4 v1, s[16:19], s20 offen offset:0 lds
  v_mfma_f32_16x16x32_bf16 v[156:159], a[164:167], v[44:47], v[156:159]
  v_rcp_f16 v215, v216
  v_rcp_f16 v218, v219
  v_mfma_f32_16x16x32_bf16 v[156:159], a[168:171], v[60:63], v[156:159]
  v_rcp_f16_sdwa v209, v210 dst_sel:WORD_1 dst_unused:UNUSED_PRESERVE src0_sel:WORD_1
  v_mfma_f32_16x16x32_bf16 v[156:159], a[172:175], v[76:79], v[156:159]
  v_rcp_f16_sdwa v212, v213 dst_sel:WORD_1 dst_unused:UNUSED_PRESERVE src0_sel:WORD_1
  v_mfma_f32_16x16x32_bf16 v[156:159], a[176:179], v[92:95], v[156:159]
  buffer_load_dwordx4 v1, s[16:19], s20 offen offset:1024 lds
  v_rcp_f16_sdwa v215, v216 dst_sel:WORD_1 dst_unused:UNUSED_PRESERVE src0_sel:WORD_1
  v_mfma_f32_16x16x32_bf16 v[156:159], a[180:183], v[108:111], v[156:159]
  s_add_u32 s20, s20, 20480
  v_rcp_f16_sdwa v218, v219 dst_sel:WORD_1 dst_unused:UNUSED_PRESERVE src0_sel:WORD_1
  v_pk_mul_f16 v178, v208, v209
  v_mfma_f32_16x16x32_bf16 v[160:163], a[184:187], v[16:19], 0
  v_pk_mul_f16 v179, v211, v212
  v_pk_mul_f16 v182, v214, v215
  v_pk_mul_f16 v183, v217, v218
  v_mfma_f32_16x16x32_bf16 v[160:163], a[188:191], v[32:35], v[160:163]
  s_mov_b64 exec, s[38:39]
  ds_write2_b32 v220, a250, a254 offset0:44 offset1:55
  s_mov_b64 exec, -1
  v_cvt_pk_f16_f32 v208, v136, v137
  v_mfma_f32_16x16x32_bf16 v[160:163], a[192:195], v[48:51], v[160:163]
  v_cvt_pk_f16_f32 v211, v138, v139
  v_cvt_pk_f16_f32 v214, v140, v141
  v_mfma_f32_16x16x32_bf16 v[160:163], a[196:199], v[64:67], v[160:163]
  v_cvt_pk_f16_f32 v217, v142, v143
  v_pk_fma_f16 v209, v208, v208, s28
  v_pk_fma_f16 v212, v211, v211, s28
  v_mfma_f32_16x16x32_bf16 v[160:163], a[200:203], v[80:83], v[160:163]
  v_pk_fma_f16 v215, v214, v214, s28
  v_pk_fma_f16 v218, v217, v217, s28
  v_pk_mul_f16 v209, v209, v208
  v_mfma_f32_16x16x32_bf16 v[160:163], a[204:207], v[96:99], v[160:163]
  v_pk_mul_f16 v212, v212, v211
  v_pk_mul_f16 v215, v215, v214
  v_pk_mul_f16 v218, v218, v217
  v_mfma_f32_16x16x32_bf16 v[164:167], a[184:187], v[20:23], 0
  ds_read_b128 a[208:211], v1 offset:12288
  v_exp_f16 v210, v209
  v_mfma_f32_16x16x32_bf16 v[164:167], a[188:191], v[36:39], v[164:167]
  v_exp_f16 v213, v212
  v_mfma_f32_16x16x32_bf16 v[164:167], a[192:195], v[52:55], v[164:167]
  v_exp_f16 v216, v215
  v_mfma_f32_16x16x32_bf16 v[164:167], a[196:199], v[68:71], v[164:167]
  v_exp_f16 v219, v218
  v_exp_f16_sdwa v210, v209 dst_sel:WORD_1 dst_unused:UNUSED_PRESERVE src0_sel:WORD_1
  v_mfma_f32_16x16x32_bf16 v[164:167], a[200:203], v[84:87], v[164:167]
  ds_read_b128 a[212:215], v1 offset:13312
  v_exp_f16_sdwa v213, v212 dst_sel:WORD_1 dst_unused:UNUSED_PRESERVE src0_sel:WORD_1
  v_mfma_f32_16x16x32_bf16 v[164:167], a[204:207], v[100:103], v[164:167]
  s_mov_b64 exec, s[38:39]
  ds_write2_b32 v220, a251, a255 offset0:66 offset1:77
  s_mov_b64 exec, -1
  v_mfma_f32_16x16x32_bf16 v[168:171], a[184:187], v[24:27], 0
  v_exp_f16_sdwa v216, v215 dst_sel:WORD_1 dst_unused:UNUSED_PRESERVE src0_sel:WORD_1
  v_mfma_f32_16x16x32_bf16 v[168:171], a[188:191], v[40:43], v[168:171]
  v_exp_f16_sdwa v219, v218 dst_sel:WORD_1 dst_unused:UNUSED_PRESERVE src0_sel:WORD_1
  v_pk_fma_f16 v210, v210, s56, s56
  v_pk_fma_f16 v213, v213, s56, s56
  v_mfma_f32_16x16x32_bf16 v[168:171], a[192:195], v[56:59], v[168:171]
  ds_read_b128 a[216:219], v1 offset:14336
  v_pk_fma_f16 v216, v216, s56, s56
  v_pk_fma_f16 v219, v219, s56, s56
  v_mfma_f32_16x16x32_bf16 v[168:171], a[196:199], v[72:75], v[168:171]
  buffer_load_dwordx4 a[248:251], v5, s[8:11], s55 offen
  v_mfma_f32_16x16x32_bf16 v[168:171], a[200:203], v[88:91], v[168:171]
  v_rcp_f16 v209, v210
  v_mfma_f32_16x16x32_bf16 v[168:171], a[204:207], v[104:107], v[168:171]
  v_rcp_f16 v212, v213
  v_rcp_f16 v215, v216
  v_mfma_f32_16x16x32_bf16 v[172:175], a[184:187], v[28:31], 0
  ds_read_b128 a[220:223], v1 offset:15360
  v_rcp_f16 v218, v219
  v_mfma_f32_16x16x32_bf16 v[172:175], a[188:191], v[44:47], v[172:175]
  v_rcp_f16_sdwa v209, v210 dst_sel:WORD_1 dst_unused:UNUSED_PRESERVE src0_sel:WORD_1
  v_mfma_f32_16x16x32_bf16 v[172:175], a[192:195], v[60:63], v[172:175]
  buffer_load_dwordx4 a[252:255], v9, s[8:11], s55 offen
  v_rcp_f16_sdwa v212, v213 dst_sel:WORD_1 dst_unused:UNUSED_PRESERVE src0_sel:WORD_1
  v_mfma_f32_16x16x32_bf16 v[172:175], a[196:199], v[76:79], v[172:175]
  v_rcp_f16_sdwa v215, v216 dst_sel:WORD_1 dst_unused:UNUSED_PRESERVE src0_sel:WORD_1
  v_mfma_f32_16x16x32_bf16 v[172:175], a[200:203], v[92:95], v[172:175]
  v_rcp_f16_sdwa v218, v219 dst_sel:WORD_1 dst_unused:UNUSED_PRESERVE src0_sel:WORD_1
  v_pk_mul_f16 v186, v208, v209
  v_mfma_f32_16x16x32_bf16 v[172:175], a[204:207], v[108:111], v[172:175]
  v_pk_mul_f16 v187, v211, v212
  v_pk_mul_f16 v190, v214, v215
  v_pk_mul_f16 v191, v217, v218
  s_add_u32 s55, s55, 64
  s_mov_b32 s54, 130688
  s_cmp_eq_u32 s55, 64
  s_cselect_b32 s54, 98304, s54
  s_sub_u32 s30, s30, 1
  s_cmp_lg_u32 s30, 0
  s_cbranch_scc1 mlp_loop
  s_lshl_b32 s40, s32, 1
  s_add_u32 s40, s40, s36
  s_add_u32 s40, s40, 13
  s_mul_i32 s40, s40, 196608
  s_sub_u32 s41, s37, 3
  s_mul_i32 s41, s41, 384
  s_add_u32 s40, s40, s41
  s_add_u32 s40, s40, 256
  s_cmp_eq_u32 s31, 3
  s_cselect_b32 s40, 0x40000000, s40
  s_mov_b32 s40, 0x40000000
  v_lshrrev_b32 v220, 4, v1
  v_cmp_le_u32 vcc, 22, v220
  v_mov_b32 v221, 188160
  s_nop 0
  v_cndmask_b32 v221, 0, v221, vcc
  v_mul_u32_u24 v0, 384, v220
  v_add3_u32 v0, v0, v221, s40
  v_cmp_gt_u32 vcc, 44, v220
  v_mov_b32 v221, 0x40000000
  s_nop 0
  v_cndmask_b32 v0, v221, v0, vcc
  s_add_u32 s40, s36, s32
  s_mul_i32 s40, s40, 196608
  s_mul_i32 s41, s37, 384
  s_add_u32 s40, s40, s41
  v_lshlrev_b32 v14, 7, v220
  v_add_u32 v14, s40, v14
  v_cmp_gt_u32 vcc, 48, v220
  s_nop 1
  v_cndmask_b32 v14, v221, v14, vcc
  s_mov_b32 s30, 4
.p2align 6
mlp_loop2:
  s_waitcnt lgkmcnt(3)
  v_mfma_f32_16x16x32_f16 a[0:3], v[176:179], a[208:211], a[0:3]
  v_cvt_pk_f16_f32 v208, v144, v145
  v_cvt_pk_f16_f32 v211, v146, v147
  v_cvt_pk_f16_f32 v214, v148, v149
  v_mfma_f32_16x16x32_f16 a[4:7], v[180:183], a[208:211], a[4:7]
  ds_read_b128 a[160:163], v1 offset:0
  v_cvt_pk_f16_f32 v217, v150, v151
  v_mfma_f32_16x16x32_f16 a[8:11], v[184:187], a[208:211], a[8:11]
  v_pk_fma_f16 v209, v208, v208, s28
  v_pk_fma_f16 v212, v211, v211, s28
  v_pk_fma_f16 v215, v214, v214, s28
  v_mfma_f32_16x16x32_f16 a[12:15], v[188:191], a[208:211], a[12:15]
  s_waitcnt lgkmcnt(3)
  ds_read_b128 a[208:211], v1 offset:16384
  v_pk_fma_f16 v218, v217, v217, s28
  v_mfma_f32_16x16x32_f16 a[16:19], v[176:179], a[212:215], a[16:19]
  ds_read_b128 a[164:167], v1 offset:1024
  v_pk_mul_f16 v209, v209, v208
  v_pk_mul_f16 v212, v212, v211
  v_mfma_f32_16x16x32_f16 a[20:23], v[180:183], a[212:215], a[20:23]
  v_pk_mul_f16 v215, v215, v214
  v_pk_mul_f16 v218, v218, v217
  v_mfma_f32_16x16x32_f16 a[24:27], v[184:187], a[212:215], a[24:27]
  v_exp_f16 v210, v209
  v_mfma_f32_16x16x32_f16 a[28:31], v[188:191], a[212:215], a[28:31]
  s_waitcnt lgkmcnt(4)
  ds_read_b128 a[212:215], v1 offset:17408
  v_exp_f16 v213, v212
  v_mfma_f32_16x16x32_f16 a[32:35], v[176:179], a[216:219], a[32:35]
  ds_read_b128 a[168:171], v1 offset:2048
  v_exp_f16 v216, v215
  v_mfma_f32_16x16x32_f16 a[36:39], v[180:183], a[216:219], a[36:39]
  v_exp_f16 v219, v218
  v_mfma_f32_16x16x32_f16 a[40:43], v[184:187], a[216:219], a[40:43]
  ds_read_b128 a[172:175], v1 offset:3072
  v_exp_f16_sdwa v210, v209 dst_sel:WORD_1 dst_unused:UNUSED_PRESERVE src0_sel:WORD_1
  v_mfma_f32_16x16x32_f16 a[44:47], v[188:191], a[216:219], a[44:47]
  s_waitcnt lgkmcnt(6)
  ds_read_b128 a[216:219], v1 offset:18432
  v_exp_f16_sdwa v213, v212 dst_sel:WORD_1 dst_unused:UNUSED_PRESERVE src0_sel:WORD_1
  v_mfma_f32_16x16x32_f16 a[48:51], v[176:179], a[220:223], a[48:51]
  v_exp_f16_sdwa v216, v215 dst_sel:WORD_1 dst_unused:UNUSED_PRESERVE src0_sel:WORD_1
  v_mfma_f32_16x16x32_f16 a[52:55], v[180:183], a[220:223], a[52:55]
  ds_read_b128 a[176:179], v1 offset:4096
  v_exp_f16_sdwa v219, v218 dst_sel:WORD_1 dst_unused:UNUSED_PRESERVE src0_sel:WORD_1
  v_mfma_f32_16x16x32_f16 a[56:59], v[184:187], a[220:223], a[56:59]
  v_pk_fma_f16 v210, v210, s56, s56
  v_pk_fma_f16 v213, v213, s56, s56
  v_pk_fma_f16 v216, v216, s56, s56
  v_mfma_f32_16x16x32_f16 a[60:63], v[188:191], a[220:223], a[60:63]
  s_waitcnt lgkmcnt(6)
  ds_read_b128 a[220:223], v1 offset:19456
  v_pk_fma_f16 v219, v219, s56, s56
  v_mfma_f32_16x16x32_f16 a[64:67], v[176:179], a[208:211], a[64:67]
  ds_read_b128 a[180:183], v1 offset:5120
  v_rcp_f16 v209, v210
  v_mfma_f32_16x16x32_f16 a[68:71], v[180:183], a[208:211], a[68:71]
  v_rcp_f16 v212, v213
  v_mfma_f32_16x16x32_f16 a[72:75], v[184:187], a[208:211], a[72:75]
  v_rcp_f16 v215, v216
  v_mfma_f32_16x16x32_f16 a[76:79], v[188:191], a[208:211], a[76:79]
  s_waitcnt lgkmcnt(6)
  ds_read_b128 a[208:211], v1 offset:20480
  v_rcp_f16 v218, v219
  v_mfma_f32_16x16x32_f16 a[80:83], v[176:179], a[212:215], a[80:83]
  ds_read_b128 a[184:187], v1 offset:6144
  v_rcp_f16_sdwa v209, v210 dst_sel:WORD_1 dst_unused:UNUSED_PRESERVE src0_sel:WORD_1
  v_mfma_f32_16x16x32_f16 a[84:87], v[180:183], a[212:215], a[84:87]
  v_rcp_f16_sdwa v212, v213 dst_sel:WORD_1 dst_unused:UNUSED_PRESERVE src0_sel:WORD_1
  v_mfma_f32_16x16x32_f16 a[88:91], v[184:187], a[212:215], a[88:91]
  ds_read_b128 a[188:191], v1 offset:7168
  v_rcp_f16_sdwa v215, v216 dst_sel:WORD_1 dst_unused:UNUSED_PRESERVE src0_sel:WORD_1
  v_mfma_f32_16x16x32_f16 a[92:95], v[188:191], a[212:215], a[92:95]
  s_waitcnt lgkmcnt(6)
  ds_read_b128 a[212:215], v1 offset:21504
  v_rcp_f16_sdwa v218, v219 dst_sel:WORD_1 dst_unused:UNUSED_PRESERVE src0_sel:WORD_1
  v_mfma_f32_16x16x32_f16 a[96:99], v[176:179], a[216:219], a[96:99]
  v_pk_mul_f16 v192, v208, v209
  v_pk_mul_f16 v193, v211, v212
  v_pk_mul_f16 v196, v214, v215
  v_mfma_f32_16x16x32_f16 a[100:103], v[180:183], a[216:219], a[100:103]
  ds_read_b128 a[192:195], v1 offset:8192
  v_pk_mul_f16 v197, v217, v218
  v_mfma_f32_16x16x32_f16 a[104:107], v[184:187], a[216:219], a[104:107]
  v_cvt_pk_f16_f32 v208, v152, v153
  v_cvt_pk_f16_f32 v211, v154, v155
  v_cvt_pk_f16_f32 v214, v156, v157
  v_mfma_f32_16x16x32_f16 a[108:111], v[188:191], a[216:219], a[108:111]
  s_waitcnt lgkmcnt(6)
  ds_read_b128 a[216:219], v1 offset:22528
  v_cvt_pk_f16_f32 v217, v158, v159
  v_mfma_f32_16x16x32_f16 a[112:115], v[176:179], a[220:223], a[112:115]
  ds_read_b128 a[196:199], v1 offset:9216
  v_pk_fma_f16 v209, v208, v208, s28
  v_pk_fma_f16 v212, v211, v211, s28
  v_mfma_f32_16x16x32_f16 a[116:119], v[180:183], a[220:223], a[116:119]
  v_pk_fma_f16 v215, v214, v214, s28
  v_pk_fma_f16 v218, v217, v217, s28
  v_pk_mul_f16 v209, v209, v208
  v_mfma_f32_16x16x32_f16 a[120:123], v[184:187], a[220:223], a[120:123]
  v_pk_mul_f16 v212, v212, v211
  v_pk_mul_f16 v215, v215, v214
  v_mfma_f32_16x16x32_f16 a[124:127], v[188:191], a[220:223], a[124:127]
  s_waitcnt lgkmcnt(6)
  ds_read_b128 a[220:223], v1 offset:23552
  v_pk_mul_f16 v218, v218, v217
  v_mfma_f32_16x16x32_f16 a[128:131], v[176:179], a[208:211], a[128:131]
  ds_read_b128 a[200:203], v1 offset:10240
  v_exp_f16 v210, v209
  v_mfma_f32_16x16x32_f16 a[132:135], v[180:183], a[208:211], a[132:135]
  v_exp_f16 v213, v212
  v_mfma_f32_16x16x32_f16 a[136:139], v[184:187], a[208:211], a[136:139]
  ds_read_b128 a[204:207], v1 offset:11264
  v_exp_f16 v216, v215
  v_mfma_f32_16x16x32_f16 a[140:143], v[188:191], a[208:211], a[140:143]
  s_waitcnt lgkmcnt(6)
  v_exp_f16 v219, v218
  v_mfma_f32_16x16x32_f16 a[144:147], v[176:179], a[212:215], a[144:147]
  v_exp_f16_sdwa v210, v209 dst_sel:WORD_1 dst_unused:UNUSED_PRESERVE src0_sel:WORD_1
  v_exp_f16_sdwa v213, v212 dst_sel:WORD_1 dst_unused:UNUSED_PRESERVE src0_sel:WORD_1
  v_mfma_f32_16x16x32_f16 a[148:151], v[180:183], a[212:215], a[148:151]
  v_exp_f16_sdwa v216, v215 dst_sel:WORD_1 dst_unused:UNUSED_PRESERVE src0_sel:WORD_1
  v_mfma_f32_16x16x32_f16 a[152:155], v[184:187], a[212:215], a[152:155]
  v_exp_f16_sdwa v219, v218 dst_sel:WORD_1 dst_unused:UNUSED_PRESERVE src0_sel:WORD_1
  v_pk_fma_f16 v210, v210, s56, s56
  v_mfma_f32_16x16x32_f16 a[156:159], v[188:191], a[212:215], a[156:159]
  s_waitcnt lgkmcnt(4)
  v_pk_fma_f16 v213, v213, s56, s56
  v_pk_fma_f16 v216, v216, s56, s56
  v_mfma_f32_16x16x32_f16 v[224:227], v[176:179], a[216:219], v[224:227]
  v_pk_fma_f16 v219, v219, s56, s56
  v_rcp_f16 v209, v210
  v_mfma_f32_16x16x32_f16 v[228:231], v[180:183], a[216:219], v[228:231]
  v_rcp_f16 v212, v213
  v_mfma_f32_16x16x32_f16 v[232:235], v[184:187], a[216:219], v[232:235]
  v_rcp_f16 v215, v216
  v_mfma_f32_16x16x32_f16 v[236:239], v[188:191], a[216:219], v[236:239]
  s_waitcnt lgkmcnt(2)
  v_rcp_f16 v218, v219
  v_rcp_f16_sdwa v209, v210 dst_sel:WORD_1 dst_unused:UNUSED_PRESERVE src0_sel:WORD_1
  v_mfma_f32_16x16x32_f16 v[240:243], v[176:179], a[220:223], v[240:243]
  v_rcp_f16_sdwa v212, v213 dst_sel:WORD_1 dst_unused:UNUSED_PRESERVE src0_sel:WORD_1
  v_mfma_f32_16x16x32_f16 v[244:247], v[180:183], a[220:223], v[244:247]
  v_rcp_f16_sdwa v215, v216 dst_sel:WORD_1 dst_unused:UNUSED_PRESERVE src0_sel:WORD_1
  v_mfma_f32_16x16x32_f16 v[248:251], v[184:187], a[220:223], v[248:251]
  v_rcp_f16_sdwa v218, v219 dst_sel:WORD_1 dst_unused:UNUSED_PRESERVE src0_sel:WORD_1
  v_pk_mul_f16 v200, v208, v209
  v_mfma_f32_16x16x32_f16 v[252:255], v[188:191], a[220:223], v[252:255]
  v_pk_mul_f16 v201, v211, v212
  v_pk_mul_f16 v204, v214, v215
  v_pk_mul_f16 v205, v217, v218
  s_waitcnt lgkmcnt(0)
  s_waitcnt vmcnt(2)
  s_barrier
  v_mfma_f32_16x16x32_bf16 v[112:115], a[160:163], v[16:19], 0
  v_cvt_pk_f16_f32 v208, v160, v161
  v_cvt_pk_f16_f32 v211, v162, v163
  v_cvt_pk_f16_f32 v214, v164, v165
  v_mfma_f32_16x16x32_bf16 v[112:115], a[164:167], v[32:35], v[112:115]
  s_add_u32 m0, s29, 0
  v_cvt_pk_f16_f32 v217, v166, v167
  v_pk_fma_f16 v209, v208, v208, s28
  v_mfma_f32_16x16x32_bf16 v[112:115], a[168:171], v[48:51], v[112:115]
  buffer_load_dwordx4 v1, s[16:19], s20 offen offset:0 lds
  v_pk_fma_f16 v212, v211, v211, s28
  v_mfma_f32_16x16x32_bf16 v[112:115], a[172:175], v[64:67], v[112:115]
  v_pk_fma_f16 v215, v214, v214, s28
  v_pk_fma_f16 v218, v217, v217, s28
  v_mfma_f32_16x16x32_bf16 v[112:115], a[176:179], v[80:83], v[112:115]
  v_pk_mul_f16 v209, v209, v208
  v_pk_mul_f16 v212, v212, v211
  v_pk_mul_f16 v215, v215, v214
  v_mfma_f32_16x16x32_bf16 v[112:115], a[180:183], v[96:99], v[112:115]
  v_pk_mul_f16 v218, v218, v217
  v_exp_f16 v210, v209
  v_mfma_f32_16x16x32_bf16 v[116:119], a[160:163], v[20:23], 0
  buffer_load_dwordx4 v1, s[16:19], s20 offen offset:1024 lds
  v_mfma_f32_16x16x32_bf16 v[116:119], a[164:167], v[36:39], v[116:119]
  v_exp_f16 v213, v212
  v_mfma_f32_16x16x32_bf16 v[116:119], a[168:171], v[52:55], v[116:119]
  v_exp_f16 v216, v215
  v_mfma_f32_16x16x32_bf16 v[116:119], a[172:175], v[68:71], v[116:119]
  v_exp_f16 v219, v218
  v_mfma_f32_16x16x32_bf16 v[116:119], a[176:179], v[84:87], v[116:119]
  buffer_load_dwordx4 v1, s[16:19], s20 offen offset:2048 lds
  v_exp_f16_sdwa v210, v209 dst_sel:WORD_1 dst_unused:UNUSED_PRESERVE src0_sel:WORD_1
  v_mfma_f32_16x16x32_bf16 v[116:119], a[180:183], v[100:103], v[116:119]
  v_exp_f16_sdwa v213, v212 dst_sel:WORD_1 dst_unused:UNUSED_PRESERVE src0_sel:WORD_1
  v_mfma_f32_16x16x32_bf16 v[120:123], a[160:163], v[24:27], 0
  v_exp_f16_sdwa v216, v215 dst_sel:WORD_1 dst_unused:UNUSED_PRESERVE src0_sel:WORD_1
  v_mfma_f32_16x16x32_bf16 v[120:123], a[164:167], v[40:43], v[120:123]
  v_exp_f16_sdwa v219, v218 dst_sel:WORD_1 dst_unused:UNUSED_PRESERVE src0_sel:WORD_1
  v_pk_fma_f16 v210, v210, s56, s56
  v_mfma_f32_16x16x32_bf16 v[120:123], a[168:171], v[56:59], v[120:123]
  buffer_load_dwordx4 v1, s[16:19], s20 offen offset:3072 lds
  v_pk_fma_f16 v213, v213, s56, s56
  v_mfma_f32_16x16x32_bf16 v[120:123], a[172:175], v[72:75], v[120:123]
  v_pk_fma_f16 v216, v216, s56, s56
  v_pk_fma_f16 v219, v219, s56, s56
  v_mfma_f32_16x16x32_bf16 v[120:123], a[176:179], v[88:91], v[120:123]
  v_rcp_f16 v209, v210
  v_mfma_f32_16x16x32_bf16 v[120:123], a[180:183], v[104:107], v[120:123]
  s_add_u32 m0, s29, 4096
  s_add_u32 s20, s20, 4096
  v_rcp_f16 v212, v213
  v_mfma_f32_16x16x32_bf16 v[124:127], a[160:163], v[28:31], 0
  buffer_load_dwordx4 v1, s[16:19], s20 offen offset:0 lds
  v_mfma_f32_16x16x32_bf16 v[124:127], a[164:167], v[44:47], v[124:127]
  v_rcp_f16 v215, v216
  v_mfma_f32_16x16x32_bf16 v[124:127], a[168:171], v[60:63], v[124:127]
  v_rcp_f16 v218, v219
  v_rcp_f16_sdwa v209, v210 dst_sel:WORD_1 dst_unused:UNUSED_PRESERVE src0_sel:WORD_1
  v_mfma_f32_16x16x32_bf16 v[124:127], a[172:175], v[76:79], v[124:127]
  v_rcp_f16_sdwa v212, v213 dst_sel:WORD_1 dst_unused:UNUSED_PRESERVE src0_sel:WORD_1
  v_mfma_f32_16x16x32_bf16 v[124:127], a[176:179], v[92:95], v[124:127]
  buffer_load_dwordx4 v1, s[16:19], s20 offen offset:1024 lds
  v_mfma_f32_16x16x32_bf16 v[124:127], a[180:183], v[108:111], v[124:127]
  s_add_u32 s20, s20, 20480
  v_rcp_f16_sdwa v215, v216 dst_sel:WORD_1 dst_unused:UNUSED_PRESERVE src0_sel:WORD_1
  v_rcp_f16_sdwa v218, v219 dst_sel:WORD_1 dst_unused:UNUSED_PRESERVE src0_sel:WORD_1
  v_mfma_f32_16x16x32_bf16 v[128:131], a[184:187], v[16:19], 0
  v_pk_mul_f16 v194, v208, v209
  v_pk_mul_f16 v195, v211, v212
  v_mfma_f32_16x16x32_bf16 v[128:131], a[188:191], v[32:35], v[128:131]
  v_pk_mul_f16 v198, v214, v215
  v_pk_mul_f16 v199, v217, v218
  v_cvt_pk_f16_f32 v208, v168, v169
  v_mfma_f32_16x16x32_bf16 v[128:131], a[192:195], v[48:51], v[128:131]
  v_cvt_pk_f16_f32 v211, v170, v171
  v_cvt_pk_f16_f32 v214, v172, v173
  v_mfma_f32_16x16x32_bf16 v[128:131], a[196:199], v[64:67], v[128:131]
  v_cvt_pk_f16_f32 v217, v174, v175
  v_pk_fma_f16 v209, v208, v208, s28
  v_pk_fma_f16 v212, v211, v211, s28
  v_mfma_f32_16x16x32_bf16 v[128:131], a[200:203], v[80:83], v[128:131]
  v_pk_fma_f16 v215, v214, v214, s28
  v_pk_fma_f16 v218, v217, v217, s28
  v_mfma_f32_16x16x32_bf16 v[128:131], a[204:207], v[96:99], v[128:131]
  v_pk_mul_f16 v209, v209, v208
  v_pk_mul_f16 v212, v212, v211
  v_pk_mul_f16 v215, v215, v214
  v_mfma_f32_16x16x32_bf16 v[132:135], a[184:187], v[20:23], 0
  ds_read_b128 a[208:211], v1 offset:36864
  v_pk_mul_f16 v218, v218, v217
  v_mfma_f32_16x16x32_bf16 v[132:135], a[188:191], v[36:39], v[132:135]
  v_exp_f16 v210, v209
  v_mfma_f32_16x16x32_bf16 v[132:135], a[192:195], v[52:55], v[132:135]
  v_exp_f16 v213, v212
  v_mfma_f32_16x16x32_bf16 v[132:135], a[196:199], v[68:71], v[132:135]
  v_exp_f16 v216, v215
  v_exp_f16 v219, v218
  v_mfma_f32_16x16x32_bf16 v[132:135], a[200:203], v[84:87], v[132:135]
  ds_read_b128 a[212:215], v1 offset:37888
  v_exp_f16_sdwa v210, v209 dst_sel:WORD_1 dst_unused:UNUSED_PRESERVE src0_sel:WORD_1
  v_mfma_f32_16x16x32_bf16 v[132:135], a[204:207], v[100:103], v[132:135]
  v_exp_f16_sdwa v213, v212 dst_sel:WORD_1 dst_unused:UNUSED_PRESERVE src0_sel:WORD_1
  v_mfma_f32_16x16x32_bf16 v[136:139], a[184:187], v[24:27], 0
  v_exp_f16_sdwa v216, v215 dst_sel:WORD_1 dst_unused:UNUSED_PRESERVE src0_sel:WORD_1
  v_mfma_f32_16x16x32_bf16 v[136:139], a[188:191], v[40:43], v[136:139]
  v_exp_f16_sdwa v219, v218 dst_sel:WORD_1 dst_unused:UNUSED_PRESERVE src0_sel:WORD_1
  v_pk_fma_f16 v210, v210, s56, s56
  v_mfma_f32_16x16x32_bf16 v[136:139], a[192:195], v[56:59], v[136:139]
  ds_read_b128 a[216:219], v1 offset:38912
  v_pk_fma_f16 v213, v213, s56, s56
  v_mfma_f32_16x16x32_bf16 v[136:139], a[196:199], v[72:75], v[136:139]
  v_pk_fma_f16 v216, v216, s56, s56
  v_pk_fma_f16 v219, v219, s56, s56
  v_mfma_f32_16x16x32_bf16 v[136:139], a[200:203], v[88:91], v[136:139]
  v_rcp_f16 v209, v210
  v_mfma_f32_16x16x32_bf16 v[136:139], a[204:207], v[104:107], v[136:139]
  v_rcp_f16 v212, v213
  v_rcp_f16 v215, v216
  v_mfma_f32_16x16x32_bf16 v[140:143], a[184:187], v[28:31], 0
  ds_read_b128 a[220:223], v1 offset:39936
  v_rcp_f16 v218, v219
  v_mfma_f32_16x16x32_bf16 v[140:143], a[188:191], v[44:47], v[140:143]
  v_rcp_f16_sdwa v209, v210 dst_sel:WORD_1 dst_unused:UNUSED_PRESERVE src0_sel:WORD_1
  v_mfma_f32_16x16x32_bf16 v[140:143], a[192:195], v[60:63], v[140:143]
  v_rcp_f16_sdwa v212, v213 dst_sel:WORD_1 dst_unused:UNUSED_PRESERVE src0_sel:WORD_1
  v_mfma_f32_16x16x32_bf16 v[140:143], a[196:199], v[76:79], v[140:143]
  v_rcp_f16_sdwa v215, v216 dst_sel:WORD_1 dst_unused:UNUSED_PRESERVE src0_sel:WORD_1
  v_mfma_f32_16x16x32_bf16 v[140:143], a[200:203], v[92:95], v[140:143]
  v_rcp_f16_sdwa v218, v219 dst_sel:WORD_1 dst_unused:UNUSED_PRESERVE src0_sel:WORD_1
  v_pk_mul_f16 v202, v208, v209
  v_mfma_f32_16x16x32_bf16 v[140:143], a[204:207], v[108:111], v[140:143]
  v_pk_mul_f16 v203, v211, v212
  v_pk_mul_f16 v206, v214, v215
  v_pk_mul_f16 v207, v217, v218
  s_waitcnt lgkmcnt(3)
  v_mfma_f32_16x16x32_f16 a[0:3], v[192:195], a[208:211], a[0:3]
  v_cvt_pk_f16_f32 v208, v112, v113
  v_cvt_pk_f16_f32 v211, v114, v115
  v_cvt_pk_f16_f32 v214, v116, v117
  v_mfma_f32_16x16x32_f16 a[4:7], v[196:199], a[208:211], a[4:7]
  ds_read_b128 a[160:163], v1 offset:24576
  v_cvt_pk_f16_f32 v217, v118, v119
  v_mfma_f32_16x16x32_f16 a[8:11], v[200:203], a[208:211], a[8:11]
  v_pk_fma_f16 v209, v208, v208, s28
  v_pk_fma_f16 v212, v211, v211, s28
  v_pk_fma_f16 v215, v214, v214, s28
  v_mfma_f32_16x16x32_f16 a[12:15], v[204:207], a[208:211], a[12:15]
  s_waitcnt lgkmcnt(3)
  ds_read_b128 a[208:211], v1 offset:40960
  v_pk_fma_f16 v218, v217, v217, s28
  v_mfma_f32_16x16x32_f16 a[16:19], v[192:195], a[212:215], a[16:19]
  ds_read_b128 a[164:167], v1 offset:25600
  v_pk_mul_f16 v209, v209, v208
  v_pk_mul_f16 v212, v212, v211
  v_mfma_f32_16x16x32_f16 a[20:23], v[196:199], a[212:215], a[20:23]
  v_pk_mul_f16 v215, v215, v214
  v_pk_mul_f16 v218, v218, v217
  v_mfma_f32_16x16x32_f16 a[24:27], v[200:203], a[212:215], a[24:27]
  v_exp_f16 v210, v209
  v_mfma_f32_16x16x32_f16 a[28:31], v[204:207], a[212:215], a[28:31]
  s_waitcnt lgkmcnt(4)
  ds_read_b128 a[212:215], v1 offset:41984
  v_exp_f16 v213, v212
  v_mfma_f32_16x16x32_f16 a[32:35], v[192:195], a[216:219], a[32:35]
  ds_read_b128 a[168:171], v1 offset:26624
  v_exp_f16 v216, v215
  v_mfma_f32_16x16x32_f16 a[36:39], v[196:199], a[216:219], a[36:39]
  v_exp_f16 v219, v218
  v_mfma_f32_16x16x32_f16 a[40:43], v[200:203], a[216:219], a[40:43]
  ds_read_b128 a[172:175], v1 offset:27648
  v_exp_f16_sdwa v210, v209 dst_sel:WORD_1 dst_unused:UNUSED_PRESERVE src0_sel:WORD_1
  v_mfma_f32_16x16x32_f16 a[44:47], v[204:207], a[216:219], a[44:47]
  s_waitcnt lgkmcnt(6)
  ds_read_b128 a[216:219], v1 offset:43008
  v_exp_f16_sdwa v213, v212 dst_sel:WORD_1 dst_unused:UNUSED_PRESERVE src0_sel:WORD_1
  v_mfma_f32_16x16x32_f16 a[48:51], v[192:195], a[220:223], a[48:51]
  v_exp_f16_sdwa v216, v215 dst_sel:WORD_1 dst_unused:UNUSED_PRESERVE src0_sel:WORD_1
  v_mfma_f32_16x16x32_f16 a[52:55], v[196:199], a[220:223], a[52:55]
  ds_read_b128 a[176:179], v1 offset:28672
  v_exp_f16_sdwa v219, v218 dst_sel:WORD_1 dst_unused:UNUSED_PRESERVE src0_sel:WORD_1
  v_mfma_f32_16x16x32_f16 a[56:59], v[200:203], a[220:223], a[56:59]
  v_pk_fma_f16 v210, v210, s56, s56
  v_pk_fma_f16 v213, v213, s56, s56
  v_pk_fma_f16 v216, v216, s56, s56
  v_mfma_f32_16x16x32_f16 a[60:63], v[204:207], a[220:223], a[60:63]
  s_waitcnt lgkmcnt(6)
  ds_read_b128 a[220:223], v1 offset:44032
  v_pk_fma_f16 v219, v219, s56, s56
  v_mfma_f32_16x16x32_f16 a[64:67], v[192:195], a[208:211], a[64:67]
  ds_read_b128 a[180:183], v1 offset:29696
  v_rcp_f16 v209, v210
  v_mfma_f32_16x16x32_f16 a[68:71], v[196:199], a[208:211], a[68:71]
  v_rcp_f16 v212, v213
  v_mfma_f32_16x16x32_f16 a[72:75], v[200:203], a[208:211], a[72:75]
  v_rcp_f16 v215, v216
  v_mfma_f32_16x16x32_f16 a[76:79], v[204:207], a[208:211], a[76:79]
  s_waitcnt lgkmcnt(6)
  ds_read_b128 a[208:211], v1 offset:45056
  v_rcp_f16 v218, v219
  v_mfma_f32_16x16x32_f16 a[80:83], v[192:195], a[212:215], a[80:83]
  ds_read_b128 a[184:187], v1 offset:30720
  v_rcp_f16_sdwa v209, v210 dst_sel:WORD_1 dst_unused:UNUSED_PRESERVE src0_sel:WORD_1
  v_mfma_f32_16x16x32_f16 a[84:87], v[196:199], a[212:215], a[84:87]
  v_rcp_f16_sdwa v212, v213 dst_sel:WORD_1 dst_unused:UNUSED_PRESERVE src0_sel:WORD_1
  v_mfma_f32_16x16x32_f16 a[88:91], v[200:203], a[212:215], a[88:91]
  ds_read_b128 a[188:191], v1 offset:31744
  v_rcp_f16_sdwa v215, v216 dst_sel:WORD_1 dst_unused:UNUSED_PRESERVE src0_sel:WORD_1
  v_mfma_f32_16x16x32_f16 a[92:95], v[204:207], a[212:215], a[92:95]
  s_waitcnt lgkmcnt(6)
  ds_read_b128 a[212:215], v1 offset:46080
  v_rcp_f16_sdwa v218, v219 dst_sel:WORD_1 dst_unused:UNUSED_PRESERVE src0_sel:WORD_1
  v_mfma_f32_16x16x32_f16 a[96:99], v[192:195], a[216:219], a[96:99]
  v_pk_mul_f16 v176, v208, v209
  v_pk_mul_f16 v177, v211, v212
  v_pk_mul_f16 v180, v214, v215
  v_mfma_f32_16x16x32_f16 a[100:103], v[196:199], a[216:219], a[100:103]
  ds_read_b128 a[192:195], v1 offset:32768
  v_pk_mul_f16 v181, v217, v218
  v_mfma_f32_16x16x32_f16 a[104:107], v[200:203], a[216:219], a[104:107]
  v_cvt_pk_f16_f32 v208, v120, v121
  v_cvt_pk_f16_f32 v211, v122, v123
  v_cvt_pk_f16_f32 v214, v124, v125
  v_mfma_f32_16x16x32_f16 a[108:111], v[204:207], a[216:219], a[108:111]
  s_waitcnt lgkmcnt(6)
  ds_read_b128 a[216:219], v1 offset:47104
  v_cvt_pk_f16_f32 v217, v126, v127
  v_mfma_f32_16x16x32_f16 a[112:115], v[192:195], a[220:223], a[112:115]
  ds_read_b128 a[196:199], v1 offset:33792
  v_pk_fma_f16 v209, v208, v208, s28
  v_pk_fma_f16 v212, v211, v211, s28
  v_mfma_f32_16x16x32_f16 a[116:119], v[196:199], a[220:223], a[116:119]
  v_pk_fma_f16 v215, v214, v214, s28
  v_pk_fma_f16 v218, v217, v217, s28
  v_pk_mul_f16 v209, v209, v208
  v_mfma_f32_16x16x32_f16 a[120:123], v[200:203], a[220:223], a[120:123]
  v_pk_mul_f16 v212, v212, v211
  v_pk_mul_f16 v215, v215, v214
  v_mfma_f32_16x16x32_f16 a[124:127], v[204:207], a[220:223], a[124:127]
  s_waitcnt lgkmcnt(6)
  ds_read_b128 a[220:223], v1 offset:48128
  v_pk_mul_f16 v218, v218, v217
  v_mfma_f32_16x16x32_f16 a[128:131], v[192:195], a[208:211], a[128:131]
  ds_read_b128 a[200:203], v1 offset:34816
  v_exp_f16 v210, v209
  v_mfma_f32_16x16x32_f16 a[132:135], v[196:199], a[208:211], a[132:135]
  v_exp_f16 v213, v212
  v_mfma_f32_16x16x32_f16 a[136:139], v[200:203], a[208:211], a[136:139]
  ds_read_b128 a[204:207], v1 offset:35840
  v_exp_f16 v216, v215
  v_mfma_f32_16x16x32_f16 a[140:143], v[204:207], a[208:211], a[140:143]
  s_waitcnt lgkmcnt(6)
  v_exp_f16 v219, v218
  v_mfma_f32_16x16x32_f16 a[144:147], v[192:195], a[212:215], a[144:147]
  v_exp_f16_sdwa v210, v209 dst_sel:WORD_1 dst_unused:UNUSED_PRESERVE src0_sel:WORD_1
  v_exp_f16_sdwa v213, v212 dst_sel:WORD_1 dst_unused:UNUSED_PRESERVE src0_sel:WORD_1
  v_mfma_f32_16x16x32_f16 a[148:151], v[196:199], a[212:215], a[148:151]
  v_exp_f16_sdwa v216, v215 dst_sel:WORD_1 dst_unused:UNUSED_PRESERVE src0_sel:WORD_1
  v_mfma_f32_16x16x32_f16 a[152:155], v[200:203], a[212:215], a[152:155]
  v_exp_f16_sdwa v219, v218 dst_sel:WORD_1 dst_unused:UNUSED_PRESERVE src0_sel:WORD_1
  v_pk_fma_f16 v210, v210, s56, s56
  v_mfma_f32_16x16x32_f16 a[156:159], v[204:207], a[212:215], a[156:159]
  s_waitcnt lgkmcnt(4)
  v_pk_fma_f16 v213, v213, s56, s56
  v_pk_fma_f16 v216, v216, s56, s56
  v_mfma_f32_16x16x32_f16 v[224:227], v[192:195], a[216:219], v[224:227]
  v_pk_fma_f16 v219, v219, s56, s56
  v_rcp_f16 v209, v210
  v_mfma_f32_16x16x32_f16 v[228:231], v[196:199], a[216:219], v[228:231]
  v_rcp_f16 v212, v213
  v_mfma_f32_16x16x32_f16 v[232:235], v[200:203], a[216:219], v[232:235]
  v_rcp_f16 v215, v216
  v_mfma_f32_16x16x32_f16 v[236:239], v[204:207], a[216:219], v[236:239]
  s_waitcnt lgkmcnt(2)
  v_rcp_f16 v218, v219
  v_rcp_f16_sdwa v209, v210 dst_sel:WORD_1 dst_unused:UNUSED_PRESERVE src0_sel:WORD_1
  v_mfma_f32_16x16x32_f16 v[240:243], v[192:195], a[220:223], v[240:243]
  v_rcp_f16_sdwa v212, v213 dst_sel:WORD_1 dst_unused:UNUSED_PRESERVE src0_sel:WORD_1
  v_mfma_f32_16x16x32_f16 v[244:247], v[196:199], a[220:223], v[244:247]
  v_rcp_f16_sdwa v215, v216 dst_sel:WORD_1 dst_unused:UNUSED_PRESERVE src0_sel:WORD_1
  v_mfma_f32_16x16x32_f16 v[248:251], v[200:203], a[220:223], v[248:251]
  v_rcp_f16_sdwa v218, v219 dst_sel:WORD_1 dst_unused:UNUSED_PRESERVE src0_sel:WORD_1
  v_pk_mul_f16 v184, v208, v209
  v_mfma_f32_16x16x32_f16 v[252:255], v[204:207], a[220:223], v[252:255]
  v_pk_mul_f16 v185, v211, v212
  v_pk_mul_f16 v188, v214, v215
  v_pk_mul_f16 v189, v217, v218
  s_waitcnt lgkmcnt(0)
  s_waitcnt vmcnt(0)
  s_barrier
  v_mfma_f32_16x16x32_bf16 v[144:147], a[160:163], v[16:19], 0
  v_cvt_pk_f16_f32 v208, v128, v129
  v_cvt_pk_f16_f32 v211, v130, v131
  v_cvt_pk_f16_f32 v214, v132, v133
  v_mfma_f32_16x16x32_bf16 v[144:147], a[164:167], v[32:35], v[144:147]
  s_add_u32 m0, s29, 24576
  v_cvt_pk_f16_f32 v217, v134, v135
  v_pk_fma_f16 v209, v208, v208, s28
  v_mfma_f32_16x16x32_bf16 v[144:147], a[168:171], v[48:51], v[144:147]
  buffer_load_dwordx4 v1, s[16:19], s20 offen offset:0 lds
  v_pk_fma_f16 v212, v211, v211, s28
  v_mfma_f32_16x16x32_bf16 v[144:147], a[172:175], v[64:67], v[144:147]
  v_pk_fma_f16 v215, v214, v214, s28
  v_pk_fma_f16 v218, v217, v217, s28
  v_pk_mul_f16 v209, v209, v208
  v_mfma_f32_16x16x32_bf16 v[144:147], a[176:179], v[80:83], v[144:147]
  v_pk_mul_f16 v212, v212, v211
  v_pk_mul_f16 v215, v215, v214
  v_mfma_f32_16x16x32_bf16 v[144:147], a[180:183], v[96:99], v[144:147]
  v_pk_mul_f16 v218, v218, v217
  v_exp_f16 v210, v209
  v_mfma_f32_16x16x32_bf16 v[148:151], a[160:163], v[20:23], 0
  buffer_load_dwordx4 v1, s[16:19], s20 offen offset:1024 lds
  v_mfma_f32_16x16x32_bf16 v[148:151], a[164:167], v[36:39], v[148:151]
  v_exp_f16 v213, v212
  v_mfma_f32_16x16x32_bf16 v[148:151], a[168:171], v[52:55], v[148:151]
  v_exp_f16 v216, v215
  v_exp_f16 v219, v218
  v_mfma_f32_16x16x32_bf16 v[148:151], a[172:175], v[68:71], v[148:151]
  v_exp_f16_sdwa v210, v209 dst_sel:WORD_1 dst_unused:UNUSED_PRESERVE src0_sel:WORD_1
  v_mfma_f32_16x16x32_bf16 v[148:151], a[176:179], v[84:87], v[148:151]
  buffer_load_dwordx4 v1, s[16:19], s20 offen offset:2048 lds
  v_mfma_f32_16x16x32_bf16 v[148:151], a[180:183], v[100:103], v[148:151]
  v_exp_f16_sdwa v213, v212 dst_sel:WORD_1 dst_unused:UNUSED_PRESERVE src0_sel:WORD_1
  v_exp_f16_sdwa v216, v215 dst_sel:WORD_1 dst_unused:UNUSED_PRESERVE src0_sel:WORD_1
  v_mfma_f32_16x16x32_bf16 v[152:155], a[160:163], v[24:27], 0
  v_exp_f16_sdwa v219, v218 dst_sel:WORD_1 dst_unused:UNUSED_PRESERVE src0_sel:WORD_1
  v_mfma_f32_16x16x32_bf16 v[152:155], a[164:167], v[40:43], v[152:155]
  v_pk_fma_f16 v210, v210, s56, s56
  v_pk_fma_f16 v213, v213, s56, s56
  v_pk_fma_f16 v216, v216, s56, s56
  v_mfma_f32_16x16x32_bf16 v[152:155], a[168:171], v[56:59], v[152:155]
  buffer_load_dwordx4 v1, s[16:19], s20 offen offset:3072 lds
  v_pk_fma_f16 v219, v219, s56, s56
  v_mfma_f32_16x16x32_bf16 v[152:155], a[172:175], v[72:75], v[152:155]
  v_rcp_f16 v209, v210
  v_mfma_f32_16x16x32_bf16 v[152:155], a[176:179], v[88:91], v[152:155]
  v_rcp_f16 v212, v213
  v_mfma_f32_16x16x32_bf16 v[152:155], a[180:183], v[104:107], v[152:155]
  s_add_u32 m0, s29, 28672
  s_add_u32 s20, s20, 4096
  v_rcp_f16 v215, v216
  v_mfma_f32_16x16x32_bf16 v[156:159], a[160:163], v[28:31], 0
  buffer_load_dwordx4 v1, s[16:19], s20 offen offset:0 lds
  v_mfma_f32_16x16x32_bf16 v[156:159], a[164:167], v[44:47], v[156:159]
  v_rcp_f16 v218, v219
  v_rcp_f16_sdwa v209, v210 dst_sel:WORD_1 dst_unused:UNUSED_PRESERVE src0_sel:WORD_1
  v_mfma_f32_16x16x32_bf16 v[156:159], a[168:171], v[60:63], v[156:159]
  v_rcp_f16_sdwa v212, v213 dst_sel:WORD_1 dst_unused:UNUSED_PRESERVE src0_sel:WORD_1
  v_mfma_f32_16x16x32_bf16 v[156:159], a[172:175], v[76:79], v[156:159]
  v_rcp_f16_sdwa v215, v216 dst_sel:WORD_1 dst_unused:UNUSED_PRESERVE src0_sel:WORD_1
  v_mfma_f32_16x16x32_bf16 v[156:159], a[176:179], v[92:95], v[156:159]
  buffer_load_dwordx4 v1, s[16:19], s20 offen offset:1024 lds
  v_rcp_f16_sdwa v218, v219 dst_sel:WORD_1 dst_unused:UNUSED_PRESERVE src0_sel:WORD_1
  v_mfma_f32_16x16x32_bf16 v[156:159], a[180:183], v[108:111], v[156:159]
  s_add_u32 s20, s20, 20480
  v_pk_mul_f16 v178, v208, v209
  v_pk_mul_f16 v179, v211, v212
  v_pk_mul_f16 v182, v214, v215
  v_mfma_f32_16x16x32_bf16 v[160:163], a[184:187], v[16:19], 0
  v_pk_mul_f16 v183, v217, v218
  v_cvt_pk_f16_f32 v208, v136, v137
  v_mfma_f32_16x16x32_bf16 v[160:163], a[188:191], v[32:35], v[160:163]
  v_cvt_pk_f16_f32 v211, v138, v139
  v_cvt_pk_f16_f32 v214, v140, v141
  v_cvt_pk_f16_f32 v217, v142, v143
  v_mfma_f32_16x16x32_bf16 v[160:163], a[192:195], v[48:51], v[160:163]
  buffer_load_dword v223, v0, s[8:11], 0 offen
  v_mfma_f32_16x16x32_bf16 v[160:163], a[196:199], v[64:67], v[160:163]
  v_pk_fma_f16 v209, v208, v208, s28
  v_pk_fma_f16 v212, v211, v211, s28
  v_pk_fma_f16 v215, v214, v214, s28
  v_mfma_f32_16x16x32_bf16 v[160:163], a[200:203], v[80:83], v[160:163]
  v_pk_fma_f16 v218, v217, v217, s28
  v_pk_mul_f16 v209, v209, v208
  v_pk_mul_f16 v212, v212, v211
  v_mfma_f32_16x16x32_bf16 v[160:163], a[204:207], v[96:99], v[160:163]
  v_pk_mul_f16 v215, v215, v214
  v_pk_mul_f16 v218, v218, v217
  v_mfma_f32_16x16x32_bf16 v[164:167], a[184:187], v[20:23], 0
  ds_read_b128 a[208:211], v1 offset:12288
  v_exp_f16 v210, v209
  v_mfma_f32_16x16x32_bf16 v[164:167], a[188:191], v[36:39], v[164:167]
  v_exp_f16 v213, v212
  v_mfma_f32_16x16x32_bf16 v[164:167], a[192:195], v[52:55], v[164:167]
  buffer_load_dword v223, v14, s[8:11], 0 offen
  v_mfma_f32_16x16x32_bf16 v[164:167], a[196:199], v[68:71], v[164:167]
  v_exp_f16 v216, v215
  v_exp_f16 v219, v218
  v_mfma_f32_16x16x32_bf16 v[164:167], a[200:203], v[84:87], v[164:167]
  ds_read_b128 a[212:215], v1 offset:13312
  v_exp_f16_sdwa v210, v209 dst_sel:WORD_1 dst_unused:UNUSED_PRESERVE src0_sel:WORD_1
  v_mfma_f32_16x16x32_bf16 v[164:167], a[204:207], v[100:103], v[164:167]
  v_exp_f16_sdwa v213, v212 dst_sel:WORD_1 dst_unused:UNUSED_PRESERVE src0_sel:WORD_1
  v_mfma_f32_16x16x32_bf16 v[168:171], a[184:187], v[24:27], 0
  v_exp_f16_sdwa v216, v215 dst_sel:WORD_1 dst_unused:UNUSED_PRESERVE src0_sel:WORD_1
  v_mfma_f32_16x16x32_bf16 v[168:171], a[188:191], v[40:43], v[168:171]
  v_exp_f16_sdwa v219, v218 dst_sel:WORD_1 dst_unused:UNUSED_PRESERVE src0_sel:WORD_1
  v_pk_fma_f16 v210, v210, s56, s56
  v_pk_fma_f16 v213, v213, s56, s56
  v_mfma_f32_16x16x32_bf16 v[168:171], a[192:195], v[56:59], v[168:171]
  ds_read_b128 a[216:219], v1 offset:14336
  v_pk_fma_f16 v216, v216, s56, s56
  v_mfma_f32_16x16x32_bf16 v[168:171], a[196:199], v[72:75], v[168:171]
  v_pk_fma_f16 v219, v219, s56, s56
  v_rcp_f16 v209, v210
  v_mfma_f32_16x16x32_bf16 v[168:171], a[200:203], v[88:91], v[168:171]
  v_rcp_f16 v212, v213
  v_mfma_f32_16x16x32_bf16 v[168:171], a[204:207], v[104:107], v[168:171]
  v_rcp_f16 v215, v216
  v_mfma_f32_16x16x32_bf16 v[172:175], a[184:187], v[28:31], 0
  ds_read_b128 a[220:223], v1 offset:15360
  v_rcp_f16 v218, v219
  v_mfma_f32_16x16x32_bf16 v[172:175], a[188:191], v[44:47], v[172:175]
  v_rcp_f16_sdwa v209, v210 dst_sel:WORD_1 dst_unused:UNUSED_PRESERVE src0_sel:WORD_1
  v_mfma_f32_16x16x32_bf16 v[172:175], a[192:195], v[60:63], v[172:175]
  v_rcp_f16_sdwa v212, v213 dst_sel:WORD_1 dst_unused:UNUSED_PRESERVE src0_sel:WORD_1
  v_rcp_f16_sdwa v215, v216 dst_sel:WORD_1 dst_unused:UNUSED_PRESERVE src0_sel:WORD_1
  v_mfma_f32_16x16x32_bf16 v[172:175], a[196:199], v[76:79], v[172:175]
  v_rcp_f16_sdwa v218, v219 dst_sel:WORD_1 dst_unused:UNUSED_PRESERVE src0_sel:WORD_1
  v_pk_mul_f16 v186, v208, v209
  v_mfma_f32_16x16x32_bf16 v[172:175], a[200:203], v[92:95], v[172:175]
  v_pk_mul_f16 v187, v211, v212
  v_pk_mul_f16 v190, v214, v215
  v_mfma_f32_16x16x32_bf16 v[172:175], a[204:207], v[108:111], v[172:175]
  v_pk_mul_f16 v191, v217, v218
  v_add_u32 v0, 1572864, v0
  v_add_u32 v14, 786432, v14
  s_sub_u32 s30, s30, 1
  s_cmp_lg_u32 s30, 0
  s_cbranch_scc1 mlp_loop2
  s_lshr_b32 s40, s32, 1
  s_lshl_b32 s40, s40, 2
  s_add_u32 s40, s40, s36
  s_and_b32 s41, s32, 1
  s_add_u32 s41, s41, s37
  s_lshl_b32 s40, s40, 9
  s_add_u32 s40, s40, s41
  s_mul_i32 s40, s40, 384
  v_lshrrev_b32 v14, 9, v1
  v_mul_u32_u24 v14, 8*512*384, v14
  v_bfe_u32 v15, v1, 8, 1
  v_mul_u32_u24 v15, 8*384, v15
  v_add3_u32 v14, v14, v15, s40
  v_and_b32 v15, 0xf0, v1
  v_add_u32 v14, v14, v15
  v_lshrrev_b32 v15, 1, v15
  v_sub_u32 v15, v14, v15
  v_add_u32 v15, 256, v15
  s_waitcnt lgkmcnt(3)
  v_mfma_f32_16x16x32_f16 a[0:3], v[176:179], a[208:211], a[0:3]
  buffer_load_dwordx2 v[80:81], v15, s[8:11], s24 offen offset:0
  v_cvt_pk_f16_f32 v208, v144, v145
  v_cvt_pk_f16_f32 v211, v146, v147
  v_cvt_pk_f16_f32 v214, v148, v149
  v_mfma_f32_16x16x32_f16 a[4:7], v[180:183], a[208:211], a[4:7]
  v_cvt_pk_f16_f32 v217, v150, v151
  v_pk_fma_f16 v209, v208, v208, s28
  v_pk_fma_f16 v212, v211, v211, s28
  v_pk_fma_f16 v215, v214, v214, s28
  v_pk_fma_f16 v218, v217, v217, s28
  v_mfma_f32_16x16x32_f16 a[8:11], v[184:187], a[208:211], a[8:11]
  v_pk_mul_f16 v209, v209, v208
  v_pk_mul_f16 v212, v212, v211
  v_pk_mul_f16 v215, v215, v214
  v_pk_mul_f16 v218, v218, v217
  v_mfma_f32_16x16x32_f16 a[12:15], v[188:191], a[208:211], a[12:15]
  s_waitcnt lgkmcnt(2)
  ds_read_b128 a[208:211], v1 offset:16384
  buffer_load_dwordx2 v[82:83], v15, s[8:11], s24 offen offset:768
  v_exp_f16 v210, v209
  v_exp_f16 v213, v212
  v_mfma_f32_16x16x32_f16 a[16:19], v[176:179], a[212:215], a[16:19]
  v_exp_f16 v216, v215
  v_exp_f16 v219, v218
  v_exp_f16_sdwa v210, v209 dst_sel:WORD_1 dst_unused:UNUSED_PRESERVE src0_sel:WORD_1
  v_mfma_f32_16x16x32_f16 a[20:23], v[180:183], a[212:215], a[20:23]
  v_exp_f16_sdwa v213, v212 dst_sel:WORD_1 dst_unused:UNUSED_PRESERVE src0_sel:WORD_1
  v_exp_f16_sdwa v216, v215 dst_sel:WORD_1 dst_unused:UNUSED_PRESERVE src0_sel:WORD_1
  v_mfma_f32_16x16x32_f16 a[24:27], v[184:187], a[212:215], a[24:27]
  buffer_load_dwordx2 v[84:85], v15, s[8:11], s24 offen offset:1536
  v_exp_f16_sdwa v219, v218 dst_sel:WORD_1 dst_unused:UNUSED_PRESERVE src0_sel:WORD_1
  v_pk_fma_f16 v210, v210, s56, s56
  v_pk_fma_f16 v213, v213, s56, s56
  v_mfma_f32_16x16x32_f16 a[28:31], v[188:191], a[212:215], a[28:31]
  s_waitcnt lgkmcnt(2)
  ds_read_b128 a[212:215], v1 offset:17408
  v_pk_fma_f16 v216, v216, s56, s56
  v_pk_fma_f16 v219, v219, s56, s56
  v_rcp_f16 v209, v210
  v_mfma_f32_16x16x32_f16 a[32:35], v[176:179], a[216:219], a[32:35]
  v_rcp_f16 v212, v213
  v_rcp_f16 v215, v216
  v_mfma_f32_16x16x32_f16 a[36:39], v[180:183], a[216:219], a[36:39]
  buffer_load_dwordx2 v[86:87], v15, s[8:11], s24 offen offset:2304
  v_rcp_f16 v218, v219
  v_rcp_f16_sdwa v209, v210 dst_sel:WORD_1 dst_unused:UNUSED_PRESERVE src0_sel:WORD_1
  v_mfma_f32_16x16x32_f16 a[40:43], v[184:187], a[216:219], a[40:43]
  v_rcp_f16_sdwa v212, v213 dst_sel:WORD_1 dst_unused:UNUSED_PRESERVE src0_sel:WORD_1
  v_rcp_f16_sdwa v215, v216 dst_sel:WORD_1 dst_unused:UNUSED_PRESERVE src0_sel:WORD_1
  v_mfma_f32_16x16x32_f16 a[44:47], v[188:191], a[216:219], a[44:47]
  s_waitcnt lgkmcnt(2)
  ds_read_b128 a[216:219], v1 offset:18432
  v_rcp_f16_sdwa v218, v219 dst_sel:WORD_1 dst_unused:UNUSED_PRESERVE src0_sel:WORD_1
  v_pk_mul_f16 v192, v208, v209
  v_pk_mul_f16 v193, v211, v212
  v_pk_mul_f16 v196, v214, v215
  v_mfma_f32_16x16x32_f16 a[48:51], v[176:179], a[220:223], a[48:51]
  buffer_load_dwordx2 v[88:89], v15, s[8:11], s25 offen offset:0
  v_pk_mul_f16 v197, v217, v218
  v_cvt_pk_f16_f32 v208, v152, v153
  v_cvt_pk_f16_f32 v211, v154, v155
  v_mfma_f32_16x16x32_f16 a[52:55], v[180:183], a[220:223], a[52:55]
  v_cvt_pk_f16_f32 v214, v156, v157
  v_cvt_pk_f16_f32 v217, v158, v159
  v_pk_fma_f16 v209, v208, v208, s28
  v_pk_fma_f16 v212, v211, v211, s28
  v_pk_fma_f16 v215, v214, v214, s28
  v_mfma_f32_16x16x32_f16 a[56:59], v[184:187], a[220:223], a[56:59]
  v_pk_fma_f16 v218, v217, v217, s28
  v_pk_mul_f16 v209, v209, v208
  v_pk_mul_f16 v212, v212, v211
  v_pk_mul_f16 v215, v215, v214
  v_pk_mul_f16 v218, v218, v217
  v_mfma_f32_16x16x32_f16 a[60:63], v[188:191], a[220:223], a[60:63]
  s_waitcnt lgkmcnt(2)
  ds_read_b128 a[220:223], v1 offset:19456
  buffer_load_dwordx2 v[90:91], v15, s[8:11], s25 offen offset:768
  v_exp_f16 v210, v209
  v_exp_f16 v213, v212
  v_mfma_f32_16x16x32_f16 a[64:67], v[176:179], a[208:211], a[64:67]
  v_exp_f16 v216, v215
  v_exp_f16 v219, v218
  v_mfma_f32_16x16x32_f16 a[68:71], v[180:183], a[208:211], a[68:71]
  v_exp_f16_sdwa v210, v209 dst_sel:WORD_1 dst_unused:UNUSED_PRESERVE src0_sel:WORD_1
  v_exp_f16_sdwa v213, v212 dst_sel:WORD_1 dst_unused:UNUSED_PRESERVE src0_sel:WORD_1
  v_exp_f16_sdwa v216, v215 dst_sel:WORD_1 dst_unused:UNUSED_PRESERVE src0_sel:WORD_1
  v_mfma_f32_16x16x32_f16 a[72:75], v[184:187], a[208:211], a[72:75]
  buffer_load_dwordx2 v[92:93], v15, s[8:11], s25 offen offset:1536
  v_exp_f16_sdwa v219, v218 dst_sel:WORD_1 dst_unused:UNUSED_PRESERVE src0_sel:WORD_1
  v_pk_fma_f16 v210, v210, s56, s56
  v_mfma_f32_16x16x32_f16 a[76:79], v[188:191], a[208:211], a[76:79]
  s_waitcnt lgkmcnt(2)
  ds_read_b128 a[208:211], v1 offset:20480
  v_pk_fma_f16 v213, v213, s56, s56
  v_pk_fma_f16 v216, v216, s56, s56
  v_pk_fma_f16 v219, v219, s56, s56
  v_mfma_f32_16x16x32_f16 a[80:83], v[176:179], a[212:215], a[80:83]
  v_rcp_f16 v209, v210
  v_rcp_f16 v212, v213
  v_rcp_f16 v215, v216
  v_mfma_f32_16x16x32_f16 a[84:87], v[180:183], a[212:215], a[84:87]
  buffer_load_dwordx2 v[94:95], v15, s[8:11], s25 offen offset:2304
  v_rcp_f16 v218, v219
  v_mfma_f32_16x16x32_f16 a[88:91], v[184:187], a[212:215], a[88:91]
  v_rcp_f16_sdwa v209, v210 dst_sel:WORD_1 dst_unused:UNUSED_PRESERVE src0_sel:WORD_1
  v_rcp_f16_sdwa v212, v213 dst_sel:WORD_1 dst_unused:UNUSED_PRESERVE src0_sel:WORD_1
  v_rcp_f16_sdwa v215, v216 dst_sel:WORD_1 dst_unused:UNUSED_PRESERVE src0_sel:WORD_1
  v_mfma_f32_16x16x32_f16 a[92:95], v[188:191], a[212:215], a[92:95]
  s_waitcnt lgkmcnt(2)
  ds_read_b128 a[212:215], v1 offset:21504
  v_rcp_f16_sdwa v218, v219 dst_sel:WORD_1 dst_unused:UNUSED_PRESERVE src0_sel:WORD_1
  v_pk_mul_f16 v200, v208, v209
  v_pk_mul_f16 v201, v211, v212
  v_pk_mul_f16 v204, v214, v215
  v_mfma_f32_16x16x32_f16 a[96:99], v[176:179], a[216:219], a[96:99]
  buffer_load_dwordx2 v[96:97], v15, s[8:11], s26 offen offset:0
  v_pk_mul_f16 v205, v217, v218
  v_cvt_pk_f16_f32 v208, v160, v161
  v_cvt_pk_f16_f32 v211, v162, v163
  v_mfma_f32_16x16x32_f16 a[100:103], v[180:183], a[216:219], a[100:103]
  v_cvt_pk_f16_f32 v214, v164, v165
  v_cvt_pk_f16_f32 v217, v166, v167
  v_pk_fma_f16 v209, v208, v208, s28
  v_pk_fma_f16 v212, v211, v211, s28
  v_pk_fma_f16 v215, v214, v214, s28
  v_mfma_f32_16x16x32_f16 a[104:107], v[184:187], a[216:219], a[104:107]
  v_pk_fma_f16 v218, v217, v217, s28
  v_pk_mul_f16 v209, v209, v208
  v_pk_mul_f16 v212, v212, v211
  v_pk_mul_f16 v215, v215, v214
  v_pk_mul_f16 v218, v218, v217
  v_mfma_f32_16x16x32_f16 a[108:111], v[188:191], a[216:219], a[108:111]
  s_waitcnt lgkmcnt(2)
  ds_read_b128 a[216:219], v1 offset:22528
  buffer_load_dwordx2 v[98:99], v15, s[8:11], s26 offen offset:768
  v_exp_f16 v210, v209
  v_mfma_f32_16x16x32_f16 a[112:115], v[176:179], a[220:223], a[112:115]
  v_exp_f16 v213, v212
  v_exp_f16 v216, v215
  v_exp_f16 v219, v218
  v_mfma_f32_16x16x32_f16 a[116:119], v[180:183], a[220:223], a[116:119]
  v_exp_f16_sdwa v210, v209 dst_sel:WORD_1 dst_unused:UNUSED_PRESERVE src0_sel:WORD_1
  v_exp_f16_sdwa v213, v212 dst_sel:WORD_1 dst_unused:UNUSED_PRESERVE src0_sel:WORD_1
  v_mfma_f32_16x16x32_f16 a[120:123], v[184:187], a[220:223], a[120:123]
  buffer_load_dwordx2 v[100:101], v15, s[8:11], s26 offen offset:1536
  v_exp_f16_sdwa v216, v215 dst_sel:WORD_1 dst_unused:UNUSED_PRESERVE src0_sel:WORD_1
  v_exp_f16_sdwa v219, v218 dst_sel:WORD_1 dst_unused:UNUSED_PRESERVE src0_sel:WORD_1
  v_mfma_f32_16x16x32_f16 a[124:127], v[188:191], a[220:223], a[124:127]
  s_waitcnt lgkmcnt(2)
  ds_read_b128 a[220:223], v1 offset:23552
  v_pk_fma_f16 v210, v210, s56, s56
  v_pk_fma_f16 v213, v213, s56, s56
  v_pk_fma_f16 v216, v216, s56, s56
  v_pk_fma_f16 v219, v219, s56, s56
  v_mfma_f32_16x16x32_f16 a[128:131], v[176:179], a[208:211], a[128:131]
  v_rcp_f16 v209, v210
  v_rcp_f16 v212, v213
  v_mfma_f32_16x16x32_f16 a[132:135], v[180:183], a[208:211], a[132:135]
  buffer_load_dwordx2 v[102:103], v15, s[8:11], s26 offen offset:2304
  v_rcp_f16 v215, v216
  v_rcp_f16 v218, v219
  v_mfma_f32_16x16x32_f16 a[136:139], v[184:187], a[208:211], a[136:139]
  v_rcp_f16_sdwa v209, v210 dst_sel:WORD_1 dst_unused:UNUSED_PRESERVE src0_sel:WORD_1
  v_rcp_f16_sdwa v212, v213 dst_sel:WORD_1 dst_unused:UNUSED_PRESERVE src0_sel:WORD_1
  v_rcp_f16_sdwa v215, v216 dst_sel:WORD_1 dst_unused:UNUSED_PRESERVE src0_sel:WORD_1
  v_mfma_f32_16x16x32_f16 a[140:143], v[188:191], a[208:211], a[140:143]
  s_waitcnt lgkmcnt(2)
  v_rcp_f16_sdwa v218, v219 dst_sel:WORD_1 dst_unused:UNUSED_PRESERVE src0_sel:WORD_1
  v_pk_mul_f16 v194, v208, v209
  v_pk_mul_f16 v195, v211, v212
  v_pk_mul_f16 v198, v214, v215
  v_mfma_f32_16x16x32_f16 a[144:147], v[176:179], a[212:215], a[144:147]
  buffer_load_dwordx2 v[104:105], v15, s[8:11], s27 offen offset:0
  v_pk_mul_f16 v199, v217, v218
  v_cvt_pk_f16_f32 v208, v168, v169
  v_cvt_pk_f16_f32 v211, v170, v171
  v_mfma_f32_16x16x32_f16 a[148:151], v[180:183], a[212:215], a[148:151]
  v_cvt_pk_f16_f32 v214, v172, v173
  v_cvt_pk_f16_f32 v217, v174, v175
  v_pk_fma_f16 v209, v208, v208, s28
  v_pk_fma_f16 v212, v211, v211, s28
  v_pk_fma_f16 v215, v214, v214, s28
  v_mfma_f32_16x16x32_f16 a[152:155], v[184:187], a[212:215], a[152:155]
  v_pk_fma_f16 v218, v217, v217, s28
  v_pk_mul_f16 v209, v209, v208
  v_pk_mul_f16 v212, v212, v211
  v_pk_mul_f16 v215, v215, v214
  v_pk_mul_f16 v218, v218, v217
  v_mfma_f32_16x16x32_f16 a[156:159], v[188:191], a[212:215], a[156:159]
  s_waitcnt lgkmcnt(1)
  buffer_load_dwordx2 v[106:107], v15, s[8:11], s27 offen offset:768
  v_exp_f16 v210, v209
  v_mfma_f32_16x16x32_f16 v[224:227], v[176:179], a[216:219], v[224:227]
  v_exp_f16 v213, v212
  v_exp_f16 v216, v215
  v_exp_f16 v219, v218
  v_mfma_f32_16x16x32_f16 v[228:231], v[180:183], a[216:219], v[228:231]
  v_exp_f16_sdwa v210, v209 dst_sel:WORD_1 dst_unused:UNUSED_PRESERVE src0_sel:WORD_1
  v_exp_f16_sdwa v213, v212 dst_sel:WORD_1 dst_unused:UNUSED_PRESERVE src0_sel:WORD_1
  v_mfma_f32_16x16x32_f16 v[232:235], v[184:187], a[216:219], v[232:235]
  buffer_load_dwordx2 v[108:109], v15, s[8:11], s27 offen offset:1536
  v_exp_f16_sdwa v216, v215 dst_sel:WORD_1 dst_unused:UNUSED_PRESERVE src0_sel:WORD_1
  v_exp_f16_sdwa v219, v218 dst_sel:WORD_1 dst_unused:UNUSED_PRESERVE src0_sel:WORD_1
  v_mfma_f32_16x16x32_f16 v[236:239], v[188:191], a[216:219], v[236:239]
  s_waitcnt lgkmcnt(0)
  v_pk_fma_f16 v210, v210, s56, s56
  v_pk_fma_f16 v213, v213, s56, s56
  v_pk_fma_f16 v216, v216, s56, s56
  v_pk_fma_f16 v219, v219, s56, s56
  v_rcp_f16 v209, v210
  v_mfma_f32_16x16x32_f16 v[240:243], v[176:179], a[220:223], v[240:243]
  v_rcp_f16 v212, v213
  v_rcp_f16 v215, v216
  v_mfma_f32_16x16x32_f16 v[244:247], v[180:183], a[220:223], v[244:247]
  buffer_load_dwordx2 v[110:111], v15, s[8:11], s27 offen offset:2304
  v_rcp_f16 v218, v219
  v_rcp_f16_sdwa v209, v210 dst_sel:WORD_1 dst_unused:UNUSED_PRESERVE src0_sel:WORD_1
  v_mfma_f32_16x16x32_f16 v[248:251], v[184:187], a[220:223], v[248:251]
  v_rcp_f16_sdwa v212, v213 dst_sel:WORD_1 dst_unused:UNUSED_PRESERVE src0_sel:WORD_1
  v_rcp_f16_sdwa v215, v216 dst_sel:WORD_1 dst_unused:UNUSED_PRESERVE src0_sel:WORD_1
  v_mfma_f32_16x16x32_f16 v[252:255], v[188:191], a[220:223], v[252:255]
  v_rcp_f16_sdwa v218, v219 dst_sel:WORD_1 dst_unused:UNUSED_PRESERVE src0_sel:WORD_1
  v_pk_mul_f16 v202, v208, v209
  v_pk_mul_f16 v203, v211, v212
  v_pk_mul_f16 v206, v214, v215
  v_pk_mul_f16 v207, v217, v218
  s_waitcnt vmcnt(18)
  s_barrier
  ds_read_b128 a[208:211], v1 offset:36864
  ds_read_b128 a[212:215], v1 offset:37888
  ds_read_b128 a[216:219], v1 offset:38912
  ds_read_b128 a[220:223], v1 offset:39936
  s_waitcnt lgkmcnt(3)
  v_mfma_f32_16x16x32_f16 a[0:3], v[192:195], a[208:211], a[0:3]
  buffer_load_dwordx4 v[16:19], v14, s[8:11], s24 offen offset:0
  v_mfma_f32_16x16x32_f16 a[4:7], v[196:199], a[208:211], a[4:7]
  v_lshrrev_b32 v112, 4, v1
  v_and_b32 v113, 15, v112
  v_mfma_f32_16x16x32_f16 a[8:11], v[200:203], a[208:211], a[8:11]
  v_lshrrev_b32 v114, 4, v112
  v_lshrrev_b32 v115, 3, v113
  v_lshlrev_b32 v115, 3, v115
  v_mfma_f32_16x16x32_f16 a[12:15], v[204:207], a[208:211], a[12:15]
  s_waitcnt lgkmcnt(2)
  ds_read_b128 a[208:211], v1 offset:40960
  buffer_load_dwordx4 v[20:23], v14, s[8:11], s24 offen offset:768
  v_mfma_f32_16x16x32_f16 a[16:19], v[192:195], a[212:215], a[16:19]
  v_lshrrev_b32 v116, 1, v114
  v_add_u32 v115, v115, v116
  v_mfma_f32_16x16x32_f16 a[20:23], v[196:199], a[212:215], a[20:23]
  v_mul_u32_u24 v115, 368, v115
  v_and_b32 v116, 7, v113
  v_mfma_f32_16x16x32_f16 a[24:27], v[200:203], a[212:215], a[24:27]
  buffer_load_dwordx4 v[24:27], v14, s[8:11], s24 offen offset:1536
  v_mfma_f32_16x16x32_f16 a[28:31], v[204:207], a[212:215], a[28:31]
  s_waitcnt lgkmcnt(2)
  ds_read_b128 a[212:215], v1 offset:41984
  v_lshlrev_b32 v116, 3, v116
  v_mfma_f32_16x16x32_f16 a[32:35], v[192:195], a[216:219], a[32:35]
  v_add_u32 v115, v115, v116
  v_and_b32 v116, 1, v114
  v_lshlrev_b32 v116, 4, v116
  v_mfma_f32_16x16x32_f16 a[36:39], v[196:199], a[216:219], a[36:39]
  buffer_load_dwordx4 v[28:31], v14, s[8:11], s24 offen offset:2304
  v_mfma_f32_16x16x32_f16 a[40:43], v[200:203], a[216:219], a[40:43]
  v_add_u32 v115, v115, v116
  s_mul_i32 s40, s32, 8096
  v_mfma_f32_16x16x32_f16 a[44:47], v[204:207], a[216:219], a[44:47]
  s_waitcnt lgkmcnt(2)
  ds_read_b128 a[216:219], v1 offset:43008
  s_add_u32 s41, s40, 98304
  v_mfma_f32_16x16x32_f16 a[48:51], v[192:195], a[220:223], a[48:51]
  buffer_load_dwordx4 v[32:35], v14, s[8:11], s25 offen offset:0
  v_mfma_f32_16x16x32_f16 a[52:55], v[196:199], a[220:223], a[52:55]
  v_add_u32 v160, s41, v115
  s_add_u32 s41, s40, 130688
  v_mfma_f32_16x16x32_f16 a[56:59], v[200:203], a[220:223], a[56:59]
  v_add_u32 v161, s41, v115
  s_add_u32 s41, s40, 0
  v_add_u32 v162, s41, v115
  v_mfma_f32_16x16x32_f16 a[60:63], v[204:207], a[220:223], a[60:63]
  s_waitcnt lgkmcnt(2)
  ds_read_b128 a[220:223], v1 offset:44032
  buffer_load_dwordx4 v[36:39], v14, s[8:11], s25 offen offset:768
  v_mfma_f32_16x16x32_f16 a[64:67], v[192:195], a[208:211], a[64:67]
  v_lshrrev_b32 v115, 2, v113
  v_sub_u32 v115, v114, v115
  v_mfma_f32_16x16x32_f16 a[68:71], v[196:199], a[208:211], a[68:71]
  v_and_b32 v116, 1, v113
  s_lshl_b32 s40, s32, 11
  v_mfma_f32_16x16x32_f16 a[72:75], v[200:203], a[208:211], a[72:75]
  buffer_load_dwordx4 v[40:43], v14, s[8:11], s25 offen offset:1536
  v_mfma_f32_16x16x32_f16 a[76:79], v[204:207], a[208:211], a[76:79]
  s_waitcnt lgkmcnt(2)
  ds_read_b128 a[208:211], v1 offset:45056
  s_add_u32 s40, s40, 49152
  v_mfma_f32_16x16x32_f16 a[80:83], v[192:195], a[212:215], a[80:83]
  v_add_u32 v163, 0, v115
  v_min_u32 v163, 7, v163
  v_lshl_add_u32 v163, v116, 2, v163
  v_mfma_f32_16x16x32_f16 a[84:87], v[196:199], a[212:215], a[84:87]
  buffer_load_dwordx4 v[44:47], v14, s[8:11], s25 offen offset:2304
  v_mfma_f32_16x16x32_f16 a[88:91], v[200:203], a[212:215], a[88:91]
  v_and_b32 v163, 7, v163
  v_lshlrev_b32 v163, 5, v163
  v_mfma_f32_16x16x32_f16 a[92:95], v[204:207], a[212:215], a[92:95]
  s_waitcnt lgkmcnt(2)
  ds_read_b128 a[212:215], v1 offset:46080
  v_lshl_add_u32 v163, v116, 8, v163
  v_mfma_f32_16x16x32_f16 a[96:99], v[192:195], a[216:219], a[96:99]
  buffer_load_dwordx4 a[160:163], v2, s[8:11], 0 offen offset:192
  v_mfma_f32_16x16x32_f16 a[100:103], v[196:199], a[216:219], a[100:103]
  v_bfe_u32 v112, v113, 1, 1
  v_lshl_add_u32 v163, v112, 4, v163
  v_mfma_f32_16x16x32_f16 a[104:107], v[200:203], a[216:219], a[104:107]
  v_add_u32 v163, s40, v163
  v_add_u32 v164, 4, v115
  v_min_u32 v164, 7, v164
  v_mfma_f32_16x16x32_f16 a[108:111], v[204:207], a[216:219], a[108:111]
  s_waitcnt lgkmcnt(2)
  ds_read_b128 a[216:219], v1 offset:47104
  buffer_load_dwordx4 a[164:167], v6, s[8:11], 0 offen offset:192
  v_mfma_f32_16x16x32_f16 a[112:115], v[192:195], a[220:223], a[112:115]
  v_lshl_add_u32 v164, v116, 2, v164
  v_and_b32 v164, 7, v164
  v_mfma_f32_16x16x32_f16 a[116:119], v[196:199], a[220:223], a[116:119]
  v_lshlrev_b32 v164, 5, v164
  v_lshl_add_u32 v164, v116, 8, v164
  v_mfma_f32_16x16x32_f16 a[120:123], v[200:203], a[220:223], a[120:123]
  buffer_load_dwordx4 a[168:171], v3, s[8:11], 0 offen offset:192
  v_mfma_f32_16x16x32_f16 a[124:127], v[204:207], a[220:223], a[124:127]
  s_waitcnt lgkmcnt(2)
  ds_read_b128 a[220:223], v1 offset:48128
  v_bfe_u32 v112, v113, 1, 1
  v_mfma_f32_16x16x32_f16 a[128:131], v[192:195], a[208:211], a[128:131]
  v_lshl_add_u32 v164, v112, 4, v164
  v_add_u32 v164, s40, v164
  v_add_u32 v165, 8, v115
  v_mfma_f32_16x16x32_f16 a[132:135], v[196:199], a[208:211], a[132:135]
  buffer_load_dwordx4 a[172:175], v7, s[8:11], 0 offen offset:192
  v_mfma_f32_16x16x32_f16 a[136:139], v[200:203], a[208:211], a[136:139]
  v_min_u32 v165, 7, v165
  v_lshl_add_u32 v165, v116, 2, v165
  v_mfma_f32_16x16x32_f16 a[140:143], v[204:207], a[208:211], a[140:143]
  s_waitcnt lgkmcnt(2)
  v_and_b32 v165, 7, v165
  v_lshlrev_b32 v165, 5, v165
  v_mfma_f32_16x16x32_f16 a[144:147], v[192:195], a[212:215], a[144:147]
  buffer_load_dwordx4 a[176:179], v4, s[8:11], 0 offen offset:192
  v_mfma_f32_16x16x32_f16 a[148:151], v[196:199], a[212:215], a[148:151]
  v_lshl_add_u32 v165, v116, 8, v165
  v_bfe_u32 v112, v113, 1, 1
  v_mfma_f32_16x16x32_f16 a[152:155], v[200:203], a[212:215], a[152:155]
  v_lshl_add_u32 v165, v112, 4, v165
  v_add_u32 v165, s40, v165
  v_mul_u32_u24 v166, 0x5555, v116
  v_mfma_f32_16x16x32_f16 a[156:159], v[204:207], a[212:215], a[156:159]
  s_waitcnt lgkmcnt(1)
  buffer_load_dwordx4 a[180:183], v8, s[8:11], 0 offen offset:192
  v_mfma_f32_16x16x32_f16 v[224:227], v[192:195], a[216:219], v[224:227]
  v_add_u32 v166, 0x8888, v166
  s_lshl_b32 s40, s32, 12
  v_mfma_f32_16x16x32_f16 v[228:231], v[196:199], a[216:219], v[228:231]
  s_add_u32 s40, s40, 32768
  v_add_u32 v167, s40, v1
  v_mfma_f32_16x16x32_f16 v[232:235], v[200:203], a[216:219], v[232:235]
  buffer_load_dwordx4 a[184:187], v5, s[8:11], 0 offen offset:192
  v_mfma_f32_16x16x32_f16 v[236:239], v[204:207], a[216:219], v[236:239]
  s_waitcnt lgkmcnt(0)
  s_lshl_b32 s40, s32, 10
  s_add_u32 s40, s40, 32768
  v_mfma_f32_16x16x32_f16 v[240:243], v[192:195], a[220:223], v[240:243]
  v_lshlrev_b32 v0, 12, v114
  v_lshl_add_u32 v0, v113, 4, v0
  v_add_u32 v0, s40, v0
  v_mfma_f32_16x16x32_f16 v[244:247], v[196:199], a[220:223], v[244:247]
  buffer_load_dwordx4 a[188:191], v9, s[8:11], 0 offen offset:192
  v_mfma_f32_16x16x32_f16 v[248:251], v[200:203], a[220:223], v[248:251]
  v_mov_b32 v140, 0
  v_mov_b32 v141, 0
  v_mfma_f32_16x16x32_f16 v[252:255], v[204:207], a[220:223], v[252:255]
  v_mov_b32 v142, 0
  v_mov_b32 v143, 0
  s_barrier
  s_add_u32 s37, s37, 128
  s_add_u32 s31, s31, 1
  s_cmp_lt_u32 s31, 4
  s_cbranch_scc1 tile_loop
  buffer_load_dwordx4 v[48:51], v14, s[8:11], s26 offen offset:0
  buffer_load_dwordx4 v[52:55], v14, s[8:11], s26 offen offset:768
  buffer_load_dwordx4 v[56:59], v14, s[8:11], s26 offen offset:1536
  buffer_load_dwordx4 v[60:63], v14, s[8:11], s26 offen offset:2304
  buffer_load_dwordx4 v[64:67], v14, s[8:11], s27 offen offset:0
  buffer_load_dwordx4 v[68:71], v14, s[8:11], s27 offen offset:768
  buffer_load_dwordx4 v[72:75], v14, s[8:11], s27 offen offset:1536
  buffer_load_dwordx4 v[76:79], v14, s[8:11], s27 offen offset:2304
  s_nop 7
  s_waitcnt vmcnt(23)
  v_accvgpr_read_b32 v112, a0
  v_accvgpr_read_b32 v113, a16
  v_accvgpr_read_b32 v114, a32
  v_accvgpr_read_b32 v115, a48
  v_accvgpr_read_b32 v116, a64
  v_accvgpr_read_b32 v117, a80
  v_accvgpr_read_b32 v118, a96
  v_accvgpr_read_b32 v119, a112
  v_accvgpr_read_b32 v120, a128
  v_accvgpr_read_b32 v121, a144
  v_dot2_f32_bf16 v112, v16, s33, v112
  v_dot2_f32_bf16 v113, v16, s34, v113
  v_dot2_f32_bf16 v114, v17, s33, v114
  v_dot2_f32_bf16 v115, v17, s34, v115
  v_dot2_f32_bf16 v116, v18, s33, v116
  v_dot2_f32_bf16 v117, v18, s34, v117
  v_dot2_f32_bf16 v118, v19, s33, v118
  v_dot2_f32_bf16 v119, v19, s34, v119
  v_dot2_f32_bf16 v120, v80, s33, v120
  v_dot2_f32_bf16 v121, v80, s34, v121
  v_dot2_f32_bf16 v122, v81, s33, v224
  v_dot2_f32_bf16 v123, v81, s34, v240
  v_cvt_pk_bf16_f32 v16, v112, v113
  v_cvt_pk_bf16_f32 v17, v114, v115
  v_cvt_pk_bf16_f32 v18, v116, v117
  v_cvt_pk_bf16_f32 v19, v118, v119
  v_cvt_pk_bf16_f32 v80, v120, v121
  v_cvt_pk_bf16_f32 v81, v122, v123
  buffer_store_dwordx4 v[16:19], v14, s[12:15], s24 offen offset:0
  buffer_store_dwordx2 v[80:81], v15, s[12:15], s24 offen offset:0
  s_waitcnt vmcnt(24)
  v_accvgpr_read_b32 v124, a1
  v_accvgpr_read_b32 v125, a17
  v_accvgpr_read_b32 v126, a33
  v_accvgpr_read_b32 v127, a49
  v_accvgpr_read_b32 v128, a65
  v_accvgpr_read_b32 v129, a81
  v_accvgpr_read_b32 v130, a97
  v_accvgpr_read_b32 v131, a113
  v_accvgpr_read_b32 v132, a129
  v_accvgpr_read_b32 v133, a145
  v_dot2_f32_bf16 v124, v20, s33, v124
  v_dot2_f32_bf16 v125, v20, s34, v125
  v_dot2_f32_bf16 v126, v21, s33, v126
  v_dot2_f32_bf16 v127, v21, s34, v127
  v_dot2_f32_bf16 v128, v22, s33, v128
  v_dot2_f32_bf16 v129, v22, s34, v129
  v_dot2_f32_bf16 v130, v23, s33, v130
  v_dot2_f32_bf16 v131, v23, s34, v131
  v_dot2_f32_bf16 v132, v82, s33, v132
  v_dot2_f32_bf16 v133, v82, s34, v133
  v_dot2_f32_bf16 v134, v83, s33, v225
  v_dot2_f32_bf16 v135, v83, s34, v241
  v_cvt_pk_bf16_f32 v20, v124, v125
  v_cvt_pk_bf16_f32 v21, v126, v127
  v_cvt_pk_bf16_f32 v22, v128, v129
  v_cvt_pk_bf16_f32 v23, v130, v131
  v_cvt_pk_bf16_f32 v82, v132, v133
  v_cvt_pk_bf16_f32 v83, v134, v135
  buffer_store_dwordx4 v[20:23], v14, s[12:15], s24 offen offset:768
  buffer_store_dwordx2 v[82:83], v15, s[12:15], s24 offen offset:768
  s_waitcnt vmcnt(25)
  v_accvgpr_read_b32 v136, a2
  v_accvgpr_read_b32 v137, a18
  v_accvgpr_read_b32 v138, a34
  v_accvgpr_read_b32 v139, a50
  v_accvgpr_read_b32 v140, a66
  v_accvgpr_read_b32 v141, a82
  v_accvgpr_read_b32 v142, a98
  v_accvgpr_read_b32 v143, a114
  v_accvgpr_read_b32 v144, a130
  v_accvgpr_read_b32 v145, a146
  v_dot2_f32_bf16 v136, v24, s33, v136
  v_dot2_f32_bf16 v137, v24, s34, v137
  v_dot2_f32_bf16 v138, v25, s33, v138
  v_dot2_f32_bf16 v139, v25, s34, v139
  v_dot2_f32_bf16 v140, v26, s33, v140
  v_dot2_f32_bf16 v141, v26, s34, v141
  v_dot2_f32_bf16 v142, v27, s33, v142
  v_dot2_f32_bf16 v143, v27, s34, v143
  v_dot2_f32_bf16 v144, v84, s33, v144
  v_dot2_f32_bf16 v145, v84, s34, v145
  v_dot2_f32_bf16 v146, v85, s33, v226
  v_dot2_f32_bf16 v147, v85, s34, v242
  v_cvt_pk_bf16_f32 v24, v136, v137
  v_cvt_pk_bf16_f32 v25, v138, v139
  v_cvt_pk_bf16_f32 v26, v140, v141
  v_cvt_pk_bf16_f32 v27, v142, v143
  v_cvt_pk_bf16_f32 v84, v144, v145
  v_cvt_pk_bf16_f32 v85, v146, v147
  buffer_store_dwordx4 v[24:27], v14, s[12:15], s24 offen offset:1536
  buffer_store_dwordx2 v[84:85], v15, s[12:15], s24 offen offset:1536
  s_waitcnt vmcnt(26)
  v_accvgpr_read_b32 v148, a3
  v_accvgpr_read_b32 v149, a19
  v_accvgpr_read_b32 v150, a35
  v_accvgpr_read_b32 v151, a51
  v_accvgpr_read_b32 v152, a67
  v_accvgpr_read_b32 v153, a83
  v_accvgpr_read_b32 v154, a99
  v_accvgpr_read_b32 v155, a115
  v_accvgpr_read_b32 v156, a131
  v_accvgpr_read_b32 v157, a147
  v_dot2_f32_bf16 v148, v28, s33, v148
  v_dot2_f32_bf16 v149, v28, s34, v149
  v_dot2_f32_bf16 v150, v29, s33, v150
  v_dot2_f32_bf16 v151, v29, s34, v151
  v_dot2_f32_bf16 v152, v30, s33, v152
  v_dot2_f32_bf16 v153, v30, s34, v153
  v_dot2_f32_bf16 v154, v31, s33, v154
  v_dot2_f32_bf16 v155, v31, s34, v155
  v_dot2_f32_bf16 v156, v86, s33, v156
  v_dot2_f32_bf16 v157, v86, s34, v157
  v_dot2_f32_bf16 v158, v87, s33, v227
  v_dot2_f32_bf16 v159, v87, s34, v243
  v_cvt_pk_bf16_f32 v28, v148, v149
  v_cvt_pk_bf16_f32 v29, v150, v151
  v_cvt_pk_bf16_f32 v30, v152, v153
  v_cvt_pk_bf16_f32 v31, v154, v155
  v_cvt_pk_bf16_f32 v86, v156, v157
  v_cvt_pk_bf16_f32 v87, v158, v159
  buffer_store_dwordx4 v[28:31], v14, s[12:15], s24 offen offset:2304
  buffer_store_dwordx2 v[86:87], v15, s[12:15], s24 offen offset:2304
  s_waitcnt vmcnt(27)
  v_accvgpr_read_b32 v112, a4
  v_accvgpr_read_b32 v113, a20
  v_accvgpr_read_b32 v114, a36
  v_accvgpr_read_b32 v115, a52
  v_accvgpr_read_b32 v116, a68
  v_accvgpr_read_b32 v117, a84
  v_accvgpr_read_b32 v118, a100
  v_accvgpr_read_b32 v119, a116
  v_accvgpr_read_b32 v120, a132
  v_accvgpr_read_b32 v121, a148
  v_dot2_f32_bf16 v112, v32, s33, v112
  v_dot2_f32_bf16 v113, v32, s34, v113
  v_dot2_f32_bf16 v114, v33, s33, v114
  v_dot2_f32_bf16 v115, v33, s34, v115
  v_dot2_f32_bf16 v116, v34, s33, v116
  v_dot2_f32_bf16 v117, v34, s34, v117
  v_dot2_f32_bf16 v118, v35, s33, v118
  v_dot2_f32_bf16 v119, v35, s34, v119
  v_dot2_f32_bf16 v120, v88, s33, v120
  v_dot2_f32_bf16 v121, v88, s34, v121
  v_dot2_f32_bf16 v122, v89, s33, v228
  v_dot2_f32_bf16 v123, v89, s34, v244
  v_cvt_pk_bf16_f32 v32, v112, v113
  v_cvt_pk_bf16_f32 v33, v114, v115
  v_cvt_pk_bf16_f32 v34, v116, v117
  v_cvt_pk_bf16_f32 v35, v118, v119
  v_cvt_pk_bf16_f32 v88, v120, v121
  v_cvt_pk_bf16_f32 v89, v122, v123
  buffer_store_dwordx4 v[32:35], v14, s[12:15], s25 offen offset:0
  buffer_store_dwordx2 v[88:89], v15, s[12:15], s25 offen offset:0
  s_waitcnt vmcnt(28)
  v_accvgpr_read_b32 v124, a5
  v_accvgpr_read_b32 v125, a21
  v_accvgpr_read_b32 v126, a37
  v_accvgpr_read_b32 v127, a53
  v_accvgpr_read_b32 v128, a69
  v_accvgpr_read_b32 v129, a85
  v_accvgpr_read_b32 v130, a101
  v_accvgpr_read_b32 v131, a117
  v_accvgpr_read_b32 v132, a133
  v_accvgpr_read_b32 v133, a149
  v_dot2_f32_bf16 v124, v36, s33, v124
  v_dot2_f32_bf16 v125, v36, s34, v125
  v_dot2_f32_bf16 v126, v37, s33, v126
  v_dot2_f32_bf16 v127, v37, s34, v127
  v_dot2_f32_bf16 v128, v38, s33, v128
  v_dot2_f32_bf16 v129, v38, s34, v129
  v_dot2_f32_bf16 v130, v39, s33, v130
  v_dot2_f32_bf16 v131, v39, s34, v131
  v_dot2_f32_bf16 v132, v90, s33, v132
  v_dot2_f32_bf16 v133, v90, s34, v133
  v_dot2_f32_bf16 v134, v91, s33, v229
  v_dot2_f32_bf16 v135, v91, s34, v245
  v_cvt_pk_bf16_f32 v36, v124, v125
  v_cvt_pk_bf16_f32 v37, v126, v127
  v_cvt_pk_bf16_f32 v38, v128, v129
  v_cvt_pk_bf16_f32 v39, v130, v131
  v_cvt_pk_bf16_f32 v90, v132, v133
  v_cvt_pk_bf16_f32 v91, v134, v135
  buffer_store_dwordx4 v[36:39], v14, s[12:15], s25 offen offset:768
  buffer_store_dwordx2 v[90:91], v15, s[12:15], s25 offen offset:768
  s_waitcnt vmcnt(29)
  v_accvgpr_read_b32 v136, a6
  v_accvgpr_read_b32 v137, a22
  v_accvgpr_read_b32 v138, a38
  v_accvgpr_read_b32 v139, a54
  v_accvgpr_read_b32 v140, a70
  v_accvgpr_read_b32 v141, a86
  v_accvgpr_read_b32 v142, a102
  v_accvgpr_read_b32 v143, a118
  v_accvgpr_read_b32 v144, a134
  v_accvgpr_read_b32 v145, a150
  v_dot2_f32_bf16 v136, v40, s33, v136
  v_dot2_f32_bf16 v137, v40, s34, v137
  v_dot2_f32_bf16 v138, v41, s33, v138
  v_dot2_f32_bf16 v139, v41, s34, v139
  v_dot2_f32_bf16 v140, v42, s33, v140
  v_dot2_f32_bf16 v141, v42, s34, v141
  v_dot2_f32_bf16 v142, v43, s33, v142
  v_dot2_f32_bf16 v143, v43, s34, v143
  v_dot2_f32_bf16 v144, v92, s33, v144
  v_dot2_f32_bf16 v145, v92, s34, v145
  v_dot2_f32_bf16 v146, v93, s33, v230
  v_dot2_f32_bf16 v147, v93, s34, v246
  v_cvt_pk_bf16_f32 v40, v136, v137
  v_cvt_pk_bf16_f32 v41, v138, v139
  v_cvt_pk_bf16_f32 v42, v140, v141
  v_cvt_pk_bf16_f32 v43, v142, v143
  v_cvt_pk_bf16_f32 v92, v144, v145
  v_cvt_pk_bf16_f32 v93, v146, v147
  buffer_store_dwordx4 v[40:43], v14, s[12:15], s25 offen offset:1536
  buffer_store_dwordx2 v[92:93], v15, s[12:15], s25 offen offset:1536
  s_waitcnt vmcnt(30)
  v_accvgpr_read_b32 v148, a7
  v_accvgpr_read_b32 v149, a23
  v_accvgpr_read_b32 v150, a39
  v_accvgpr_read_b32 v151, a55
  v_accvgpr_read_b32 v152, a71
  v_accvgpr_read_b32 v153, a87
  v_accvgpr_read_b32 v154, a103
  v_accvgpr_read_b32 v155, a119
  v_accvgpr_read_b32 v156, a135
  v_accvgpr_read_b32 v157, a151
  v_dot2_f32_bf16 v148, v44, s33, v148
  v_dot2_f32_bf16 v149, v44, s34, v149
  v_dot2_f32_bf16 v150, v45, s33, v150
  v_dot2_f32_bf16 v151, v45, s34, v151
  v_dot2_f32_bf16 v152, v46, s33, v152
  v_dot2_f32_bf16 v153, v46, s34, v153
  v_dot2_f32_bf16 v154, v47, s33, v154
  v_dot2_f32_bf16 v155, v47, s34, v155
  v_dot2_f32_bf16 v156, v94, s33, v156
  v_dot2_f32_bf16 v157, v94, s34, v157
  v_dot2_f32_bf16 v158, v95, s33, v231
  v_dot2_f32_bf16 v159, v95, s34, v247
  v_cvt_pk_bf16_f32 v44, v148, v149
  v_cvt_pk_bf16_f32 v45, v150, v151
  v_cvt_pk_bf16_f32 v46, v152, v153
  v_cvt_pk_bf16_f32 v47, v154, v155
  v_cvt_pk_bf16_f32 v94, v156, v157
  v_cvt_pk_bf16_f32 v95, v158, v159
  buffer_store_dwordx4 v[44:47], v14, s[12:15], s25 offen offset:2304
  buffer_store_dwordx2 v[94:95], v15, s[12:15], s25 offen offset:2304
  s_waitcnt vmcnt(23)
  v_accvgpr_read_b32 v112, a8
  v_accvgpr_read_b32 v113, a24
  v_accvgpr_read_b32 v114, a40
  v_accvgpr_read_b32 v115, a56
  v_accvgpr_read_b32 v116, a72
  v_accvgpr_read_b32 v117, a88
  v_accvgpr_read_b32 v118, a104
  v_accvgpr_read_b32 v119, a120
  v_accvgpr_read_b32 v120, a136
  v_accvgpr_read_b32 v121, a152
  v_dot2_f32_bf16 v112, v48, s33, v112
  v_dot2_f32_bf16 v113, v48, s34, v113
  v_dot2_f32_bf16 v114, v49, s33, v114
  v_dot2_f32_bf16 v115, v49, s34, v115
  v_dot2_f32_bf16 v116, v50, s33, v116
  v_dot2_f32_bf16 v117, v50, s34, v117
  v_dot2_f32_bf16 v118, v51, s33, v118
  v_dot2_f32_bf16 v119, v51, s34, v119
  v_dot2_f32_bf16 v120, v96, s33, v120
  v_dot2_f32_bf16 v121, v96, s34, v121
  v_dot2_f32_bf16 v122, v97, s33, v232
  v_dot2_f32_bf16 v123, v97, s34, v248
  v_cvt_pk_bf16_f32 v48, v112, v113
  v_cvt_pk_bf16_f32 v49, v114, v115
  v_cvt_pk_bf16_f32 v50, v116, v117
  v_cvt_pk_bf16_f32 v51, v118, v119
  v_cvt_pk_bf16_f32 v96, v120, v121
  v_cvt_pk_bf16_f32 v97, v122, v123
  buffer_store_dwordx4 v[48:51], v14, s[12:15], s26 offen offset:0
  buffer_store_dwordx2 v[96:97], v15, s[12:15], s26 offen offset:0
  s_waitcnt vmcnt(24)
  v_accvgpr_read_b32 v124, a9
  v_accvgpr_read_b32 v125, a25
  v_accvgpr_read_b32 v126, a41
  v_accvgpr_read_b32 v127, a57
  v_accvgpr_read_b32 v128, a73
  v_accvgpr_read_b32 v129, a89
  v_accvgpr_read_b32 v130, a105
  v_accvgpr_read_b32 v131, a121
  v_accvgpr_read_b32 v132, a137
  v_accvgpr_read_b32 v133, a153
  v_dot2_f32_bf16 v124, v52, s33, v124
  v_dot2_f32_bf16 v125, v52, s34, v125
  v_dot2_f32_bf16 v126, v53, s33, v126
  v_dot2_f32_bf16 v127, v53, s34, v127
  v_dot2_f32_bf16 v128, v54, s33, v128
  v_dot2_f32_bf16 v129, v54, s34, v129
  v_dot2_f32_bf16 v130, v55, s33, v130
  v_dot2_f32_bf16 v131, v55, s34, v131
  v_dot2_f32_bf16 v132, v98, s33, v132
  v_dot2_f32_bf16 v133, v98, s34, v133
  v_dot2_f32_bf16 v134, v99, s33, v233
  v_dot2_f32_bf16 v135, v99, s34, v249
  v_cvt_pk_bf16_f32 v52, v124, v125
  v_cvt_pk_bf16_f32 v53, v126, v127
  v_cvt_pk_bf16_f32 v54, v128, v129
  v_cvt_pk_bf16_f32 v55, v130, v131
  v_cvt_pk_bf16_f32 v98, v132, v133
  v_cvt_pk_bf16_f32 v99, v134, v135
  buffer_store_dwordx4 v[52:55], v14, s[12:15], s26 offen offset:768
  buffer_store_dwordx2 v[98:99], v15, s[12:15], s26 offen offset:768
  s_waitcnt vmcnt(25)
  v_accvgpr_read_b32 v136, a10
  v_accvgpr_read_b32 v137, a26
  v_accvgpr_read_b32 v138, a42
  v_accvgpr_read_b32 v139, a58
  v_accvgpr_read_b32 v140, a74
  v_accvgpr_read_b32 v141, a90
  v_accvgpr_read_b32 v142, a106
  v_accvgpr_read_b32 v143, a122
  v_accvgpr_read_b32 v144, a138
  v_accvgpr_read_b32 v145, a154
  v_dot2_f32_bf16 v136, v56, s33, v136
  v_dot2_f32_bf16 v137, v56, s34, v137
  v_dot2_f32_bf16 v138, v57, s33, v138
  v_dot2_f32_bf16 v139, v57, s34, v139
  v_dot2_f32_bf16 v140, v58, s33, v140
  v_dot2_f32_bf16 v141, v58, s34, v141
  v_dot2_f32_bf16 v142, v59, s33, v142
  v_dot2_f32_bf16 v143, v59, s34, v143
  v_dot2_f32_bf16 v144, v100, s33, v144
  v_dot2_f32_bf16 v145, v100, s34, v145
  v_dot2_f32_bf16 v146, v101, s33, v234
  v_dot2_f32_bf16 v147, v101, s34, v250
  v_cvt_pk_bf16_f32 v56, v136, v137
  v_cvt_pk_bf16_f32 v57, v138, v139
  v_cvt_pk_bf16_f32 v58, v140, v141
  v_cvt_pk_bf16_f32 v59, v142, v143
  v_cvt_pk_bf16_f32 v100, v144, v145
  v_cvt_pk_bf16_f32 v101, v146, v147
  buffer_store_dwordx4 v[56:59], v14, s[12:15], s26 offen offset:1536
  buffer_store_dwordx2 v[100:101], v15, s[12:15], s26 offen offset:1536
  s_waitcnt vmcnt(26)
  v_accvgpr_read_b32 v148, a11
  v_accvgpr_read_b32 v149, a27
  v_accvgpr_read_b32 v150, a43
  v_accvgpr_read_b32 v151, a59
  v_accvgpr_read_b32 v152, a75
  v_accvgpr_read_b32 v153, a91
  v_accvgpr_read_b32 v154, a107
  v_accvgpr_read_b32 v155, a123
  v_accvgpr_read_b32 v156, a139
  v_accvgpr_read_b32 v157, a155
  v_dot2_f32_bf16 v148, v60, s33, v148
  v_dot2_f32_bf16 v149, v60, s34, v149
  v_dot2_f32_bf16 v150, v61, s33, v150
  v_dot2_f32_bf16 v151, v61, s34, v151
  v_dot2_f32_bf16 v152, v62, s33, v152
  v_dot2_f32_bf16 v153, v62, s34, v153
  v_dot2_f32_bf16 v154, v63, s33, v154
  v_dot2_f32_bf16 v155, v63, s34, v155
  v_dot2_f32_bf16 v156, v102, s33, v156
  v_dot2_f32_bf16 v157, v102, s34, v157
  v_dot2_f32_bf16 v158, v103, s33, v235
  v_dot2_f32_bf16 v159, v103, s34, v251
  v_cvt_pk_bf16_f32 v60, v148, v149
  v_cvt_pk_bf16_f32 v61, v150, v151
  v_cvt_pk_bf16_f32 v62, v152, v153
  v_cvt_pk_bf16_f32 v63, v154, v155
  v_cvt_pk_bf16_f32 v102, v156, v157
  v_cvt_pk_bf16_f32 v103, v158, v159
  buffer_store_dwordx4 v[60:63], v14, s[12:15], s26 offen offset:2304
  buffer_store_dwordx2 v[102:103], v15, s[12:15], s26 offen offset:2304
  s_waitcnt vmcnt(27)
  v_accvgpr_read_b32 v112, a12
  v_accvgpr_read_b32 v113, a28
  v_accvgpr_read_b32 v114, a44
  v_accvgpr_read_b32 v115, a60
  v_accvgpr_read_b32 v116, a76
  v_accvgpr_read_b32 v117, a92
  v_accvgpr_read_b32 v118, a108
  v_accvgpr_read_b32 v119, a124
  v_accvgpr_read_b32 v120, a140
  v_accvgpr_read_b32 v121, a156
  v_dot2_f32_bf16 v112, v64, s33, v112
  v_dot2_f32_bf16 v113, v64, s34, v113
  v_dot2_f32_bf16 v114, v65, s33, v114
  v_dot2_f32_bf16 v115, v65, s34, v115
  v_dot2_f32_bf16 v116, v66, s33, v116
  v_dot2_f32_bf16 v117, v66, s34, v117
  v_dot2_f32_bf16 v118, v67, s33, v118
  v_dot2_f32_bf16 v119, v67, s34, v119
  v_dot2_f32_bf16 v120, v104, s33, v120
  v_dot2_f32_bf16 v121, v104, s34, v121
  v_dot2_f32_bf16 v122, v105, s33, v236
  v_dot2_f32_bf16 v123, v105, s34, v252
  v_cvt_pk_bf16_f32 v64, v112, v113
  v_cvt_pk_bf16_f32 v65, v114, v115
  v_cvt_pk_bf16_f32 v66, v116, v117
  v_cvt_pk_bf16_f32 v67, v118, v119
  v_cvt_pk_bf16_f32 v104, v120, v121
  v_cvt_pk_bf16_f32 v105, v122, v123
  buffer_store_dwordx4 v[64:67], v14, s[12:15], s27 offen offset:0
  buffer_store_dwordx2 v[104:105], v15, s[12:15], s27 offen offset:0
  s_waitcnt vmcnt(28)
  v_accvgpr_read_b32 v124, a13
  v_accvgpr_read_b32 v125, a29
  v_accvgpr_read_b32 v126, a45
  v_accvgpr_read_b32 v127, a61
  v_accvgpr_read_b32 v128, a77
  v_accvgpr_read_b32 v129, a93
  v_accvgpr_read_b32 v130, a109
  v_accvgpr_read_b32 v131, a125
  v_accvgpr_read_b32 v132, a141
  v_accvgpr_read_b32 v133, a157
  v_dot2_f32_bf16 v124, v68, s33, v124
  v_dot2_f32_bf16 v125, v68, s34, v125
  v_dot2_f32_bf16 v126, v69, s33, v126
  v_dot2_f32_bf16 v127, v69, s34, v127
  v_dot2_f32_bf16 v128, v70, s33, v128
  v_dot2_f32_bf16 v129, v70, s34, v129
  v_dot2_f32_bf16 v130, v71, s33, v130
  v_dot2_f32_bf16 v131, v71, s34, v131
  v_dot2_f32_bf16 v132, v106, s33, v132
  v_dot2_f32_bf16 v133, v106, s34, v133
  v_dot2_f32_bf16 v134, v107, s33, v237
  v_dot2_f32_bf16 v135, v107, s34, v253
  v_cvt_pk_bf16_f32 v68, v124, v125
  v_cvt_pk_bf16_f32 v69, v126, v127
  v_cvt_pk_bf16_f32 v70, v128, v129
  v_cvt_pk_bf16_f32 v71, v130, v131
  v_cvt_pk_bf16_f32 v106, v132, v133
  v_cvt_pk_bf16_f32 v107, v134, v135
  buffer_store_dwordx4 v[68:71], v14, s[12:15], s27 offen offset:768
  buffer_store_dwordx2 v[106:107], v15, s[12:15], s27 offen offset:768
  s_waitcnt vmcnt(29)
  v_accvgpr_read_b32 v136, a14
  v_accvgpr_read_b32 v137, a30
  v_accvgpr_read_b32 v138, a46
  v_accvgpr_read_b32 v139, a62
  v_accvgpr_read_b32 v140, a78
  v_accvgpr_read_b32 v141, a94
  v_accvgpr_read_b32 v142, a110
  v_accvgpr_read_b32 v143, a126
  v_accvgpr_read_b32 v144, a142
  v_accvgpr_read_b32 v145, a158
  v_dot2_f32_bf16 v136, v72, s33, v136
  v_dot2_f32_bf16 v137, v72, s34, v137
  v_dot2_f32_bf16 v138, v73, s33, v138
  v_dot2_f32_bf16 v139, v73, s34, v139
  v_dot2_f32_bf16 v140, v74, s33, v140
  v_dot2_f32_bf16 v141, v74, s34, v141
  v_dot2_f32_bf16 v142, v75, s33, v142
  v_dot2_f32_bf16 v143, v75, s34, v143
  v_dot2_f32_bf16 v144, v108, s33, v144
  v_dot2_f32_bf16 v145, v108, s34, v145
  v_dot2_f32_bf16 v146, v109, s33, v238
  v_dot2_f32_bf16 v147, v109, s34, v254
  v_cvt_pk_bf16_f32 v72, v136, v137
  v_cvt_pk_bf16_f32 v73, v138, v139
  v_cvt_pk_bf16_f32 v74, v140, v141
  v_cvt_pk_bf16_f32 v75, v142, v143
  v_cvt_pk_bf16_f32 v108, v144, v145
  v_cvt_pk_bf16_f32 v109, v146, v147
  buffer_store_dwordx4 v[72:75], v14, s[12:15], s27 offen offset:1536
  buffer_store_dwordx2 v[108:109], v15, s[12:15], s27 offen offset:1536
  s_waitcnt vmcnt(30)
  v_accvgpr_read_b32 v148, a15
  v_accvgpr_read_b32 v149, a31
  v_accvgpr_read_b32 v150, a47
  v_accvgpr_read_b32 v151, a63
  v_accvgpr_read_b32 v152, a79
  v_accvgpr_read_b32 v153, a95
  v_accvgpr_read_b32 v154, a111
  v_accvgpr_read_b32 v155, a127
  v_accvgpr_read_b32 v156, a143
  v_accvgpr_read_b32 v157, a159
  v_dot2_f32_bf16 v148, v76, s33, v148
  v_dot2_f32_bf16 v149, v76, s34, v149
  v_dot2_f32_bf16 v150, v77, s33, v150
  v_dot2_f32_bf16 v151, v77, s34, v151
  v_dot2_f32_bf16 v152, v78, s33, v152
  v_dot2_f32_bf16 v153, v78, s34, v153
  v_dot2_f32_bf16 v154, v79, s33, v154
  v_dot2_f32_bf16 v155, v79, s34, v155
  v_dot2_f32_bf16 v156, v110, s33, v156
  v_dot2_f32_bf16 v157, v110, s34, v157
  v_dot2_f32_bf16 v158, v111, s33, v239
  v_dot2_f32_bf16 v159, v111, s34, v255
  v_cvt_pk_bf16_f32 v76, v148, v149
  v_cvt_pk_bf16_f32 v77, v150, v151
  v_cvt_pk_bf16_f32 v78, v152, v153
  v_cvt_pk_bf16_f32 v79, v154, v155
  v_cvt_pk_bf16_f32 v110, v156, v157
  v_cvt_pk_bf16_f32 v111, v158, v159
  buffer_store_dwordx4 v[76:79], v14, s[12:15], s27 offen offset:2304
  buffer_store_dwordx2 v[110:111], v15, s[12:15], s27 offen offset:2304
main_end:
  s_endpgm
.section .rodata,"a"
.p2align 6
.amdhsa_kernel standalone__convnext_block__vision_kernel
  .amdhsa_next_free_vgpr 512
  .amdhsa_next_free_sgpr 102
  .amdhsa_accum_offset 256
  .amdhsa_group_segment_fixed_size 0
  .amdhsa_kernarg_size 56
  .amdhsa_user_sgpr_count 2
  .amdhsa_user_sgpr_kernarg_segment_ptr 1
  .amdhsa_system_sgpr_workgroup_id_x 1
  .amdhsa_float_denorm_mode_32 3
  .amdhsa_float_denorm_mode_16_64 3
.end_amdhsa_kernel
.text
```
